```python
import torch

def _softmax(x, axis=-1):
    return torch.softmax(x, dim=axis)
def _gelu(x):
    return torch.nn.functional.gelu(x, approximate="tanh")
def _silu(x):
    return torch.nn.functional.silu(x)
def _sigmoid(x):
    return torch.sigmoid(x)
def _layernorm(x, axis=-1, eps=1e-5):
    m = x.mean(dim=axis, keepdim=True)
    v = x.var(dim=axis, keepdim=True, unbiased=False)
    return (x - m) / torch.sqrt(v + eps)
def _scatter_add(tgt, idx, src, axis=0):
    return tgt.clone().index_add_(axis, idx, src)
def _segment_sum(src, seg, n):
    out = torch.zeros((n,) + src.shape[1:], dtype=src.dtype)
    return out.index_add_(0, seg, src)
def _pad(x, pw):
    flat = tuple(v for pair in reversed(pw) for v in pair)
    return torch.nn.functional.pad(x, flat)

kernel_name = 'interleave_layers__ssm_conv_s4d__glu_gated_reglu__prompt'

def setup_inputs():

    _w = (lambda a: (lambda t: t.to(torch.bfloat16) if t.is_floating_point() else t)(torch.as_tensor(a)))
    def _A_setup():
        Bsz, L, D, N = 1, 2048, 512, 128
        return {
            "u": _w((lambda *s: torch.randn(*s, dtype=torch.bfloat16) * 0.05)(Bsz, L, D)),
            "log_A_real": _w((lambda *s: torch.randn(*s, dtype=torch.bfloat16) * 3.2)(D, N) * 0.5),
            "A_imag": _w((lambda *s: torch.randn(*s, dtype=torch.bfloat16) * 0.05)(D, N) * 3.14),
            "C_real": _w((lambda *s: torch.randn(*s, dtype=torch.bfloat16) * 0.05)(D, N) / N ** 0.5),
            "C_imag": _w((lambda *s: torch.randn(*s, dtype=torch.bfloat16) * 0.05)(D, N) / N ** 0.5),
            "log_dt": _w((lambda *s: torch.randn(*s, dtype=torch.bfloat16) * 0.05)(D) * 0.5 - 4.0),
            "D_skip": _w((lambda *s: torch.randn(*s, dtype=torch.bfloat16) * 0.05)(D)),
        }
    _A_in = _A_setup()

    def _B_setup():
        B, S, D, F = 1, 2048, 512, 1792
        return {
            "x": _w((lambda *s: torch.randn(*s, dtype=torch.bfloat16) * 0.05)(B, S, D)),
            "W_gate": _w((lambda *s: torch.randn(*s, dtype=torch.bfloat16) * 0.4)(D, F) * (2.0 / D) ** 0.5),
            "W_up": _w((lambda *s: torch.randn(*s, dtype=torch.bfloat16) * 0.4)(D, F) * (2.0 / D) ** 0.5),
            "W_down": _w((lambda *s: torch.randn(*s, dtype=torch.bfloat16) * 0.4)(F, D) * (1.0 / F) ** 0.5),
        }
    _B_in = _B_setup()

    return {
        "A_u": _A_in["u"],
        "A_log_A_real": _A_in["log_A_real"],
        "A_A_imag": _A_in["A_imag"],
        "A_C_real": _A_in["C_real"],
        "A_C_imag": _A_in["C_imag"],
        "A_log_dt": _A_in["log_dt"],
        "A_D_skip": _A_in["D_skip"],
        "B_x": _B_in["x"],
        "B_W_gate": _B_in["W_gate"],
        "B_W_up": _B_in["W_up"],
        "B_W_down": _B_in["W_down"],
    }

def reference(A_u, A_log_A_real, A_A_imag, A_C_real, A_C_imag, A_log_dt, A_D_skip, B_x, B_W_gate, B_W_up, B_W_down):
    def _A_ref(u, log_A_real, A_imag, C_real, C_imag, log_dt, D_skip):
        L = u.shape[1]
        dt = torch.exp(log_dt)
        A = -torch.exp(log_A_real) + 1j * A_imag
        C = (C_real + 1j * C_imag) * dt[:, None]
        pos = (lambda x, dt: x.to(dt))(torch.arange(L), log_dt.dtype)
        P = torch.exp((A * dt[:, None])[:, :, None] * pos[None, None, :])
        K = 2.0 * torch.einsum("dn,dnl->dl", C, P).real
        L2 = 2 * L
        u_t = (lambda x, *d: x.permute(*d))(u, 0, 2, 1)
        Kf = (lambda x, *a, **k: torch.fft.rfft(x.float(), *a, **k))(K, L2)
        Uf = (lambda x, *a, **k: torch.fft.rfft(x.float(), *a, **k))(u_t, L2)
        y = (lambda x, *a, **k: torch.fft.irfft(x, *a, **k).to(torch.bfloat16))(Uf * Kf[None, :, :], L2)[:, :, :L]
        y = (lambda x, *d: x.permute(*d))(y, 0, 2, 1)
        return y + u * D_skip[None, None, :]

    def _B_ref(x, W_gate, W_up, W_down):
        gate = torch.einsum("bsd,df->bsf", x, W_gate)
        up = torch.einsum("bsd,df->bsf", x, W_up)
        gate = gate * (lambda x, dt: x.to(dt))(gate > 0, gate.dtype)
        h = gate * up
        return torch.einsum("bsf,fd->bsd", h, W_down)

    x = A_u
    x = x + _A_ref(_layernorm(x, axis=-1), A_log_A_real, A_A_imag, A_C_real, A_C_imag, A_log_dt, A_D_skip)
    x = x + _B_ref(_layernorm(x, axis=-1), B_W_gate, B_W_up, B_W_down)
    x = x + _A_ref(_layernorm(x, axis=-1), A_log_A_real, A_A_imag, A_C_real, A_C_imag, A_log_dt, A_D_skip)
    x = x + _B_ref(_layernorm(x, axis=-1), B_W_gate, B_W_up, B_W_down)
    return x
```

```asm
; @launch grid=(256,1,1) block=(256,1,1) lds=163840
.amdgcn_target "amdgcn-amd-amdhsa--gfx950"
.text
.globl interleave_layers__ssm_conv_s4d__glu_gated_reglu__prompt_kernel
.p2align 8
.type interleave_layers__ssm_conv_s4d__glu_gated_reglu__prompt_kernel,@function
interleave_layers__ssm_conv_s4d__glu_gated_reglu__prompt_kernel:
    s_cmp_ge_u32 s2, 256
    s_cbranch_scc1 L_end
    s_load_dwordx16 s[4:19], s[0:1], 0
    s_load_dwordx8 s[20:27], s[0:1], 64
    s_load_dwordx4 s[28:31], s[0:1], 96
    s_getpc_b64 s[38:39]
L_pc:
    s_lshr_b32 s67, s2, 3
    s_lshl_b32 s67, s67, 12
    v_lshl_add_u32 v4, v0, 6, s67
    v_min_u32 v4, L_tabend-L_pc-4, v4
    v_cmp_gt_u32 vcc, 64, v0
    s_nop 0
    s_and_saveexec_b64 s[40:41], vcc
    s_cbranch_execz L_nopf
    global_load_dword v196, v4, s[38:39]
L_nopf:
    s_mov_b64 exec, -1
    v_lshrrev_b32 v4, 6, v0
    v_and_b32 v1, 63, v0
    v_readfirstlane_b32 s44, v4
    s_lshl_b32 s68, s2, 9
    v_lshl_add_u32 v13, v0, 1, s68
    s_and_b32 s66, s2, 7
    s_lshr_b32 s67, s2, 3
    s_lshl_b32 s3, s66, 5
    s_add_u32 s3, s3, s67
    s_lshl_b32 s68, s3, 13
    s_lshl_b32 s69, s44, 11
    s_add_u32 s68, s68, s69
    v_lshl_add_u32 v10, v1, 4, s68
    s_add_u32 s72, s69, 114688
    s_lshr_b32 s68, s3, 3
    s_lshl_b32 s68, s68, 16
    s_lshl_b32 s69, s44, 14
    s_add_u32 s68, s68, s69
    s_and_b32 s69, s3, 7
    s_lshl_b32 s69, s69, 7
    s_add_u32 s68, s68, s69
    v_lshrrev_b32 v4, 3, v1
    v_and_b32 v5, 7, v1
    v_and_b32 v6, 2, v4
    v_xor_b32 v5, v5, v6
    v_lshl_add_u32 v6, v4, 10, s68
    v_lshl_add_u32 v8, v5, 4, v6
    v_xor_b32 v9, 64, v8
    v_add_u32 v9, 8192, v9
    s_lshl_b32 s71, s2, 2
    s_mov_b32 m0, s72
    s_waitcnt lgkmcnt(0)
    global_load_lds_dwordx4 v8, s[4:5]
    s_add_u32 m0, s72, 1024
    global_load_dwordx4 v[16:19], v10, s[4:5]
    global_load_lds_dwordx4 v9, s[4:5]
    global_load_dwordx4 v[20:23], v10, s[4:5] offset:1024
    s_mov_b32 s73, 0
    s_load_dwordx2 s[46:47], s[30:31], s73
    s_load_dword s75, s[14:15], s71
    s_load_dword s48, s[16:17], s71
    global_load_ushort v24, v13, s[6:7]
    global_load_ushort v25, v13, s[8:9]
    global_load_ushort v26, v13, s[10:11]
    global_load_ushort v27, v13, s[12:13]
    v_and_b32 v2, 15, v0
    v_bfe_u32 v3, v0, 4, 2
    s_add_u32 s32, s30, 0
    s_addc_u32 s33, s31, 0
    s_mov_b32 s34, 37748736
    s_mov_b32 s35, 0x20000
    v_lshlrev_b32 v4, 4, v0
    v_add_u32 v4, L_tab-L_pc, v4
    global_load_dwordx4 v[180:183], v4, s[38:39]
    global_load_dwordx2 v[184:185], v4, s[38:39] offset:16
    s_and_b32 s68, s66, 1
    s_lshl_b32 s68, s68, 2
    s_and_b32 s69, s67, 3
    s_add_u32 s52, s68, s69
    s_lshr_b32 s68, s66, 1
    s_lshl_b32 s68, s68, 3
    s_lshr_b32 s55, s67, 2
    s_add_u32 s53, s68, s55
    s_lshl_b32 s68, s66, 2
    s_add_u32 s54, s68, s69
    s_xor_b32 s65, s55, 0
    s_and_b32 s65, s65, 0
    s_mov_b32 s56, s24
    s_mov_b32 s57, s25
    s_mov_b32 s58, 1835008
    s_mov_b32 s59, 0x20000
    s_mul_i32 s60, s44, 458752
    s_lshl_b32 s61, s55, 7
    s_add_u32 s60, s60, s61
    s_mul_i32 s61, s65, 229376
    s_add_u32 s60, s60, s61
    s_mul_i32 s61, s44, 16384
    s_add_u32 s61, s61, 16384
    v_lshrrev_b32 v212, 3, v1
    v_and_b32 v211, 6, v212
    v_xor_b32 v211, v211, v1
    v_and_b32 v211, 7, v211
    v_lshlrev_b32 v211, 4, v211
    v_lshl_add_u32 v211, v212, 10, v211
    v_add_u32 v211, s60, v211
    s_lshr_b32 s68, s44, 1
    s_and_b32 s69, s44, 1
    v_lshlrev_b32 v231, 4, v0
    v_lshlrev_b32 v232, 4, v1
    s_mul_i32 s70, s68, 16640
    s_lshl_b32 s71, s69, 8
    s_sub_u32 s70, s70, s71
    s_add_u32 s70, s70, 114976
    v_and_b32 v4, 3, v2
    v_mul_u32_u24 v5, 4160, v4
    v_lshrrev_b32 v6, 2, v2
    v_lshlrev_b32 v7, 3, v6
    v_sub_u32 v5, v5, v7
    v_lshl_add_u32 v5, v3, 4, v5
    v_add_u32 v233, s70, v5
    s_mul_i32 s70, s68, 4608
    s_sub_u32 s72, s70, s71
    s_add_u32 s72, s72, 148224
    v_lshlrev_b32 v5, 5, v2
    v_lshl_add_u32 v7, v3, 4, v5
    v_add_u32 v234, s72, v7
    s_lshl_b32 s71, s69, 10
    s_add_u32 s70, s70, s71
    s_add_u32 s70, s70, 148448
    v_lshl_add_u32 v7, v3, 3, v5
    v_add_u32 v238, s70, v7
    v_lshrrev_b32 v5, 3, v0
    v_and_b32 v7, 7, v0
    v_lshlrev_b32 v5, 15, v5
    v_lshl_add_u32 v5, v7, 3, v5
    s_lshl_b32 s70, s2, 7
    v_add_u32 v235, s70, v5
    s_lshl_b32 s71, s68, 6
    s_add_u32 s70, s70, s71
    s_lshl_b32 s71, s69, 19
    s_add_u32 s70, s70, s71
    v_lshrrev_b32 v5, 1, v2
    v_lshlrev_b32 v5, 15, v5
    v_and_b32 v7, 1, v2
    v_lshl_add_u32 v5, v7, 5, v5
    v_add_u32 v5, s70, v5
    v_lshl_add_u32 v236, v3, 3, v5
    v_and_b32 v8, 1, v3
    v_lshrrev_b32 v9, 1, v3
    v_lshl_add_u32 v5, v8, 18, v5
    v_lshl_add_u32 v237, v9, 4, v5
    v_lshrrev_b32 v5, 2, v1
    v_lshlrev_b32 v7, 1, v8
    v_xor_b32 v7, v7, v4
    v_lshlrev_b32 v7, 4, v7
    v_lshl_add_u32 v239, v5, 6, v7
    s_lshl_b32 s70, s69, 15
    v_add_u32 v239, s70, v239
    s_lshl_b32 s91, s44, 11
    s_add_u32 s91, s91, 114688
    v_lshl_add_u32 v10, v3, 2, v6
    v_lshlrev_b32 v5, 6, v10
    v_lshl_add_u32 v5, v8, 5, v5
    v_lshl_add_u32 v5, v4, 3, v5
    v_add_u32 v240, s91, v5
    v_xor_b32 v241, 32, v240
    s_lshl_b32 s70, s54, 15
    s_lshl_b32 s71, s55, 12
    s_add_u32 s70, s70, s71
    s_lshl_b32 s71, s69, 11
    s_lshl_b32 s72, s68, 5
    s_add_u32 s71, s71, s72
    s_add_u32 s71, s71, s70
    v_lshrrev_b32 v5, 1, v1
    v_and_b32 v7, 1, v1
    v_lshlrev_b32 v5, 6, v5
    v_lshl_add_u32 v5, v7, 4, v5
    v_add_u32 v242, s71, v5
    v_lshlrev_b32 v5, 5, v10
    v_lshl_add_u32 v5, v4, 3, v5
    s_add_u32 s71, s91, 16384
    v_add_u32 v243, s71, v5
    s_mul_i32 s71, s68, 2176
    s_lshl_b32 s72, s69, 6
    s_add_u32 s71, s71, s72
    s_add_u32 s71, s71, 159488
    v_mul_u32_u24 v5, 136, v2
    v_lshl_add_u32 v5, v3, 3, v5
    v_add_u32 v244, s71, v5
    v_lshl_add_u32 v5, v3, 3, v6
    v_mul_u32_u24 v5, 136, v5
    v_lshl_add_u32 v5, v4, 3, v5
    s_lshl_b32 s71, s44, 5
    s_add_u32 s71, s71, 159488
    v_add_u32 v245, s71, v5
    s_lshl_b32 s71, s44, 10
    s_add_u32 s71, s71, s70
    v_lshlrev_b32 v5, 6, v2
    v_lshl_add_u32 v5, v3, 4, v5
    v_add_u32 v246, s71, v5
    s_lshl_b32 s71, s54, 7
    s_lshl_b32 s72, s68, 6
    s_add_u32 s71, s71, s72
    v_bfe_u32 v5, v2, 1, 1
    v_lshlrev_b32 v5, 12, v5
    v_lshl_add_u32 v5, v6, 4, v5
    v_and_b32 v7, 1, v2
    v_lshl_add_u32 v5, v7, 3, v5
    v_lshl_add_u32 v5, v3, 2, v5
    v_add_u32 v247, s71, v5
    s_and_b32 s80, s2, 7
    s_lshl_b32 s80, s80, 12
    s_lshl_b32 s85, s55, 2
    s_add_u32 s85, s85, s44
    s_mul_i32 s85, s85, 57344
    s_add_u32 s85, s85, 9437184
    s_mul_i32 s93, s65, 28672
    s_add_u32 s85, s85, s93
    s_lshl_b32 s93, s93, 1
    s_add_u32 m0, s61, 0
    s_mov_b32 s63, 0
    buffer_load_dwordx4 v211, s[56:59], s63 offen lds
    s_add_u32 m0, s61, 1024
    s_mov_b32 s63, 8192
    buffer_load_dwordx4 v211, s[56:59], s63 offen lds
    s_add_u32 m0, s61, 2048
    s_mov_b32 s63, 16384
    buffer_load_dwordx4 v211, s[56:59], s63 offen lds
    s_add_u32 m0, s61, 3072
    s_mov_b32 s63, 24576
    buffer_load_dwordx4 v211, s[56:59], s63 offen lds
    s_add_u32 m0, s61, 4096
    s_mov_b32 s63, 57344
    buffer_load_dwordx4 v211, s[56:59], s63 offen lds
    s_add_u32 m0, s61, 5120
    s_mov_b32 s63, 65536
    buffer_load_dwordx4 v211, s[56:59], s63 offen lds
    s_add_u32 m0, s61, 6144
    s_mov_b32 s63, 73728
    buffer_load_dwordx4 v211, s[56:59], s63 offen lds
    s_add_u32 m0, s61, 7168
    s_mov_b32 s63, 81920
    buffer_load_dwordx4 v211, s[56:59], s63 offen lds
    v_bfe_u32 v213, v1, 2, 2
    v_lshl_add_u32 v213, v3, 2, v213
    v_lshlrev_b32 v212, 7, v213
    v_bfe_u32 v213, v213, 1, 2
    v_lshl_add_u32 v212, v213, 5, v212
    v_and_b32 v213, 3, v1
    v_lshl_add_u32 v212, v213, 3, v212
    v_add_u32 v212, s61, v212
    v_xor_b32 v213, 32, v212
    v_xor_b32 v214, 64, v212
    v_xor_b32 v215, 96, v212
    v_bfe_u32 v4, v1, 2, 2
    v_and_b32 v5, 3, v1
    v_lshl_add_u32 v6, v3, 3, v4
    v_lshlrev_b32 v6, 7, v6
    v_lshl_add_u32 v6, v5, 3, v6
    v_lshrrev_b32 v7, 1, v4
    v_and_b32 v14, 1, v3
    v_lshl_add_u32 v7, v14, 1, v7
    v_xor_b32 v7, s44, v7
    v_lshl_add_u32 v6, v7, 5, v6
    v_add_u32 v28, 114688, v6
    v_lshl_add_u32 v36, v3, 2, v4
    v_lshlrev_b32 v6, 5, v36
    v_lshl_add_u32 v6, v5, 3, v6
    s_mul_i32 s68, s44, 1792
    s_add_u32 s68, s68, 107520
    v_add_u32 v29, s68, v6
    s_mul_i32 s68, s44, 3584
    s_add_u32 s68, s68, 108544
    v_add_u32 v30, s68, v6
    v_lshrrev_b32 v7, 1, v4
    v_mul_u32_u24 v7, 56, v7
    v_and_b32 v15, 1, v4
    v_add_u32 v7, v7, v15
    v_lshl_add_u32 v7, v14, 2, v7
    v_lshrrev_b32 v15, 1, v3
    v_lshl_add_u32 v7, v15, 1, v7
    v_lshlrev_b32 v7, 5, v7
    v_lshl_add_u32 v7, v5, 3, v7
    v_add_u32 v31, 109056, v7
    s_cmp_eq_u32 s44, 2
    s_cselect_b64 vcc, -1, 0
    v_cndmask_b32 v30, v30, v31, vcc
    s_cselect_b32 s68, 2, 1
    s_mul_i32 s68, s68, 1792
    v_add_u32 v31, s68, v30
    s_cmp_eq_u32 s44, 3
    s_cselect_b64 vcc, -1, 0
    v_add_u32 v7, 512, v29
    v_cndmask_b32 v30, v30, v29, vcc
    v_cndmask_b32 v31, v31, v7, vcc
    s_lshr_b32 s67, s3, 3
    s_and_b32 s66, s3, 7
    s_lshl_b32 s68, s67, 16
    s_lshl_b32 s69, s66, 12
    s_add_u32 s68, s68, s69
    s_lshl_b32 s69, s44, 10
    s_add_u32 s68, s68, s69
    s_add_u32 s68, s68, 1048576
    v_lshlrev_b32 v6, 6, v2
    v_lshl_add_u32 v6, v3, 4, v6
    v_add_u32 v32, s68, v6
    s_lshr_b32 s76, s54, 2
    s_and_b32 s68, s54, 3
    s_lshl_b32 s69, s55, 3
    s_add_u32 s69, s69, s76
    s_mul_i32 s69, s69, 7
    s_add_u32 s69, s69, s44
    s_lshl_b32 s69, s69, 12
    s_lshl_b32 s68, s68, 10
    s_add_u32 s69, s69, s68
    s_add_u32 s77, s69, 9437184
    s_lshl_b32 s68, s3, 1
    s_lshr_b32 s69, s44, 1
    s_add_u32 s68, s68, s69
    s_and_b32 s68, s68, 255
    s_lshl_b32 s68, s68, 4
    s_and_b32 s69, s44, 1
    s_lshl_b32 s69, s69, 12
    s_add_u32 s68, s68, s69
    s_lshr_b32 s69, s3, 7
    s_lshl_b32 s69, s69, 13
    s_add_u32 s68, s68, s69
    v_mov_b32 v34, s68
    v_mov_b32 v35, 0x3f803f80
    s_lshr_b32 s68, s44, 1
    s_mul_i32 s69, s68, 3584
    v_mul_u32_u24 v6, 112, v36
    v_lshl_add_u32 v6, v5, 3, v6
    v_add_u32 v6, s69, v6
    s_bitcmp1_b32 s44, 0
    s_cselect_b32 s69, 7200, 0
    v_add_u32 v37, s69, v6
    s_movk_i32 s70, 7168
    s_cselect_b32 s69, 64, s70
    v_add_u32 v38, s69, v6
    s_cselect_b32 s69, 7232, 32
    v_add_u32 v39, s69, v6
    s_cselect_b64 vcc, -1, 0
    v_cmp_lt_u32 s[86:87], 1, v5
    v_mov_b32 v7, 7248
    v_mov_b32 v15, 96
    v_cndmask_b32 v7, v15, v7, s[86:87]
    v_mov_b32 v15, 7200
    v_cndmask_b32 v7, v15, v7, vcc
    v_add_u32 v33, v7, v6
    s_lshl_b32 s69, s52, 1
    s_add_u32 s68, s68, s69
    s_mul_i32 s68, s68, 7168
    s_mul_i32 s69, s53, 114688
    s_add_u32 s68, s68, s69
    s_and_b32 s69, s44, 1
    s_mul_i32 s69, s69, 3072
    s_add_u32 s68, s68, s69
    s_add_u32 s78, s68, 12582912
    s_mul_i32 s68, s44, 8704
    s_add_u32 s68, s68, 114688
    v_lshl_add_u32 v176, v1, 2, s68
    v_mul_u32_u24 v6, 272, v2
    v_lshl_add_u32 v6, v3, 4, v6
    v_add_u32 v177, s68, v6
    s_lshr_b32 s68, s44, 1
    s_mul_i32 s69, s68, 3072
    s_add_u32 s69, s69, 149504
    v_lshlrev_b32 v6, 6, v2
    v_lshl_add_u32 v6, v3, 4, v6
    v_add_u32 v178, s69, v6
    s_lshl_b32 s68, s68, 2
    s_add_u32 s68, s68, 157696
    v_lshl_add_u32 v179, v6, 1, s68
    v_bfe_u32 v6, v1, 2, 1
    v_mov_b32 v8, 6136
    v_subrev_u32 v7, 0, v5
    v_cmp_gt_i32 vcc, 0, v7
    v_lshlrev_b32 v7, 7, v7
    s_nop 0
    v_cndmask_b32 v7, v7, v8, vcc
    v_lshl_add_u32 v7, v6, 2, v7
    v_add_u32 v192, 157696, v7
    v_subrev_u32 v7, 1, v5
    v_cmp_gt_i32 vcc, 0, v7
    v_lshlrev_b32 v7, 7, v7
    s_nop 0
    v_cndmask_b32 v7, v7, v8, vcc
    v_lshl_add_u32 v7, v6, 2, v7
    v_add_u32 v193, 157696, v7
    v_subrev_u32 v7, 2, v5
    v_cmp_gt_i32 vcc, 0, v7
    v_lshlrev_b32 v7, 7, v7
    s_nop 0
    v_cndmask_b32 v7, v7, v8, vcc
    v_lshl_add_u32 v7, v6, 2, v7
    v_add_u32 v194, 157696, v7
    v_subrev_u32 v7, 3, v5
    v_cmp_gt_i32 vcc, 0, v7
    v_lshlrev_b32 v7, 7, v7
    s_nop 0
    v_cndmask_b32 v7, v7, v8, vcc
    v_lshl_add_u32 v7, v6, 2, v7
    v_add_u32 v195, 157696, v7
    v_mov_b32 v220, v29
    v_mov_b32 v221, v30
    v_mov_b32 v222, v31
    v_mov_b32 v223, v37
    v_mov_b32 v224, v38
    v_mov_b32 v225, v39
    v_mov_b32 v226, v33
    s_add_u32 m0, s61, 8192
    s_mov_b32 s63, 114688
    buffer_load_dwordx4 v211, s[56:59], s63 offen lds
    s_add_u32 m0, s61, 9216
    s_mov_b32 s63, 122880
    buffer_load_dwordx4 v211, s[56:59], s63 offen lds
    s_add_u32 m0, s61, 10240
    s_mov_b32 s63, 131072
    buffer_load_dwordx4 v211, s[56:59], s63 offen lds
    s_add_u32 m0, s61, 11264
    s_mov_b32 s63, 139264
    buffer_load_dwordx4 v211, s[56:59], s63 offen lds
    s_add_u32 m0, s61, 12288
    s_mov_b32 s63, 172032
    buffer_load_dwordx4 v211, s[56:59], s63 offen lds
    s_add_u32 m0, s61, 13312
    s_mov_b32 s63, 180224
    buffer_load_dwordx4 v211, s[56:59], s63 offen lds
    s_add_u32 m0, s61, 14336
    s_mov_b32 s63, 188416
    buffer_load_dwordx4 v211, s[56:59], s63 offen lds
    s_add_u32 m0, s61, 15360
    s_mov_b32 s63, 196608
    buffer_load_dwordx4 v211, s[56:59], s63 offen lds
    s_waitcnt lgkmcnt(0)
    s_mul_i32 s46, s46, 1664525
    s_add_u32 s46, s46, 1013904223
    s_mul_i32 s47, s47, 22695477
    s_add_u32 s47, s47, 1
    s_and_b32 s50, s48, 0xffff0000
    s_lshl_b32 s48, s48, 16
    s_lshr_b32 s68, s44, 1
    s_lshl_b32 s68, s68, 4
    s_lshr_b32 s75, s75, s68
    s_lshl_b32 s75, s75, 16
    s_waitcnt vmcnt(22)
    v_dot2_f32_bf16 v52, v16, v35, 0
    v_dot2_f32_bf16 v53, v16, v16, 0
    v_dot2_f32_bf16 v52, v17, v35, v52
    v_dot2_f32_bf16 v53, v17, v17, v53
    v_dot2_f32_bf16 v52, v18, v35, v52
    v_dot2_f32_bf16 v53, v18, v18, v53
    v_dot2_f32_bf16 v52, v19, v35, v52
    v_dot2_f32_bf16 v53, v19, v19, v53
    v_dot2_f32_bf16 v54, v20, v35, 0
    v_dot2_f32_bf16 v55, v20, v20, 0
    v_dot2_f32_bf16 v54, v21, v35, v54
    v_dot2_f32_bf16 v55, v21, v21, v55
    v_dot2_f32_bf16 v54, v22, v35, v54
    v_dot2_f32_bf16 v55, v22, v22, v55
    v_dot2_f32_bf16 v54, v23, v35, v54
    v_dot2_f32_bf16 v55, v23, v23, v55
    v_add_f32_dpp v52, v52, v52 row_ror:8 row_mask:0xf bank_mask:0xf
    v_add_f32_dpp v53, v53, v53 row_ror:8 row_mask:0xf bank_mask:0xf
    v_add_f32_dpp v54, v54, v54 row_ror:8 row_mask:0xf bank_mask:0xf
    v_add_f32_dpp v55, v55, v55 row_ror:8 row_mask:0xf bank_mask:0xf
    v_add_f32_dpp v52, v52, v52 row_ror:4 row_mask:0xf bank_mask:0xf
    v_add_f32_dpp v53, v53, v53 row_ror:4 row_mask:0xf bank_mask:0xf
    v_add_f32_dpp v54, v54, v54 row_ror:4 row_mask:0xf bank_mask:0xf
    v_add_f32_dpp v55, v55, v55 row_ror:4 row_mask:0xf bank_mask:0xf
    v_add_f32_dpp v52, v52, v52 row_ror:2 row_mask:0xf bank_mask:0xf
    v_add_f32_dpp v53, v53, v53 row_ror:2 row_mask:0xf bank_mask:0xf
    v_add_f32_dpp v54, v54, v54 row_ror:2 row_mask:0xf bank_mask:0xf
    v_add_f32_dpp v55, v55, v55 row_ror:2 row_mask:0xf bank_mask:0xf
    v_add_f32_dpp v52, v52, v52 row_ror:1 row_mask:0xf bank_mask:0xf
    v_add_f32_dpp v53, v53, v53 row_ror:1 row_mask:0xf bank_mask:0xf
    v_add_f32_dpp v54, v54, v54 row_ror:1 row_mask:0xf bank_mask:0xf
    v_add_f32_dpp v55, v55, v55 row_ror:1 row_mask:0xf bank_mask:0xf
    s_barrier
    ds_read_b64_tr_b16 v[60:61], v28 offset:0
    ds_read_b64_tr_b16 v[62:63], v28 offset:512
    ds_read_b64_tr_b16 v[64:65], v28 offset:4096
    ds_read_b64_tr_b16 v[66:67], v28 offset:4608
    v_mov_b32 v56, v52
    v_mov_b32 v57, v53
    v_mov_b32 v58, v54
    v_mov_b32 v59, v55
    v_permlane16_swap_b32 v52, v56
    v_permlane16_swap_b32 v53, v57
    v_permlane16_swap_b32 v54, v58
    v_permlane16_swap_b32 v55, v59
    v_add_f32 v52, v52, v56
    v_add_f32 v53, v53, v57
    v_add_f32 v54, v54, v58
    v_add_f32 v55, v55, v59
    v_mov_b32 v56, v52
    v_mov_b32 v57, v53
    v_mov_b32 v58, v54
    v_mov_b32 v59, v55
    v_permlane32_swap_b32 v52, v56
    v_permlane32_swap_b32 v53, v57
    v_permlane32_swap_b32 v54, v58
    v_permlane32_swap_b32 v55, v59
    v_add_f32 v52, v52, v56
    v_add_f32 v53, v53, v57
    v_add_f32 v54, v54, v58
    v_add_f32 v55, v55, v59
    s_mov_b32 s68, 32768
    s_waitcnt lgkmcnt(2)
    buffer_store_dwordx4 v[60:63], v32, s[32:35], 0 offen sc1
    s_waitcnt lgkmcnt(0)
    buffer_store_dwordx4 v[64:67], v32, s[32:35], s68 offen sc1
    s_barrier
    s_mov_b64 exec, 1
    s_mov_b32 s68, 327680
    buffer_store_dwordx4 v[52:55], v34, s[32:35], s68 offen sc1
    s_mov_b64 exec, -1
    s_add_u32 s79, s80, 65536
    s_waitcnt vmcnt(21)
    v_mov_b32 v4, s75
    v_mul_f32 v4, 0x3fb8aa3b, v4
    v_lshlrev_b32 v24, 16, v24
    v_exp_f32 v4, v4
    v_mul_f32 v24, 0x3fb8aa3b, v24
    v_lshlrev_b32 v25, 16, v25
    v_exp_f32 v24, v24
    v_cvt_pk_bf16_f32 v4, v4, v4
    v_lshlrev_b32 v26, 16, v26
    v_lshlrev_b32 v4, 16, v4
    v_cvt_pk_bf16_f32 v24, v24, v24
    v_lshlrev_b32 v27, 16, v27
    v_lshlrev_b32 v24, 16, v24
    v_mul_f32 v25, v25, v4
    v_mul_f32 v24, v24, v4
    v_mul_f32 v25, 0x3e22f983, v25
    v_mul_f32 v24, 0xbfb8aa3b, v24
    v_add_f32 v4, v4, v4
    v_mul_f32 v40, v26, v4
    v_mul_f32 v41, v27, v4
    v_mul_f32 v4, 0x41000000, v24
    v_mul_f32 v6, 0x43000000, v24
    v_exp_f32 v8, v24
    v_mul_f32 v5, 0x41000000, v25
    v_mul_f32 v7, 0x43000000, v25
    v_fract_f32 v9, v25
    v_exp_f32 v4, v4
    v_exp_f32 v6, v6
    v_cos_f32 v96, v9
    v_fract_f32 v5, v5
    v_fract_f32 v7, v7
    v_sin_f32 v97, v9
    v_cos_f32 v44, v5
    v_cos_f32 v112, v7
    v_mul_f32 v96, v96, v8
    v_sin_f32 v45, v5
    v_sin_f32 v113, v7
    v_mul_f32 v97, v97, v8
    v_mul_f32 v44, v44, v4
    v_mul_f32 v112, v112, v6
    v_mul_f32 v45, v45, v4
    v_mul_f32 v113, v113, v6
    v_cvt_pk_bf16_f32 v144, v40, -v41
    v_pk_mul_f32 v[48:49], v[112:113], v[112:113] op_sel:[0,0] op_sel_hi:[0,1]
    v_pk_mul_f32 v[50:51], v[96:97], v[96:97] op_sel:[0,0] op_sel_hi:[0,1]
    ds_write_b32 v176, v144 offset:0
    v_pk_fma_f32 v[114:115], v[112:113], v[112:113], v[48:49] op_sel:[1,1,0] op_sel_hi:[1,0,1] neg_lo:[1,0,0]
    v_pk_fma_f32 v[98:99], v[96:97], v[96:97], v[50:51] op_sel:[1,1,0] op_sel_hi:[1,0,1] neg_lo:[1,0,0]
    v_pk_mul_f32 v[46:47], v[40:41], v[44:45] op_sel:[0,0] op_sel_hi:[0,1]
    v_pk_mul_f32 v[48:49], v[114:115], v[112:113] op_sel:[0,0] op_sel_hi:[0,1]
    v_pk_mul_f32 v[50:51], v[98:99], v[96:97] op_sel:[0,0] op_sel_hi:[0,1]
    v_pk_fma_f32 v[42:43], v[40:41], v[44:45], v[46:47] op_sel:[1,1,0] op_sel_hi:[1,0,1] neg_lo:[1,0,0]
    v_pk_fma_f32 v[116:117], v[114:115], v[112:113], v[48:49] op_sel:[1,1,0] op_sel_hi:[1,0,1] neg_lo:[1,0,0]
    v_pk_fma_f32 v[100:101], v[98:99], v[96:97], v[50:51] op_sel:[1,1,0] op_sel_hi:[1,0,1] neg_lo:[1,0,0]
    v_cvt_pk_bf16_f32 v145, v42, -v43
    v_pk_mul_f32 v[48:49], v[116:117], v[112:113] op_sel:[0,0] op_sel_hi:[0,1]
    v_pk_mul_f32 v[50:51], v[100:101], v[96:97] op_sel:[0,0] op_sel_hi:[0,1]
    ds_write_b32 v176, v145 offset:272
    v_pk_fma_f32 v[118:119], v[116:117], v[112:113], v[48:49] op_sel:[1,1,0] op_sel_hi:[1,0,1] neg_lo:[1,0,0]
    v_pk_fma_f32 v[102:103], v[100:101], v[96:97], v[50:51] op_sel:[1,1,0] op_sel_hi:[1,0,1] neg_lo:[1,0,0]
    v_pk_mul_f32 v[46:47], v[42:43], v[44:45] op_sel:[0,0] op_sel_hi:[0,1]
    v_pk_mul_f32 v[48:49], v[118:119], v[112:113] op_sel:[0,0] op_sel_hi:[0,1]
    v_pk_mul_f32 v[50:51], v[102:103], v[96:97] op_sel:[0,0] op_sel_hi:[0,1]
    v_pk_fma_f32 v[40:41], v[42:43], v[44:45], v[46:47] op_sel:[1,1,0] op_sel_hi:[1,0,1] neg_lo:[1,0,0]
    v_pk_fma_f32 v[120:121], v[118:119], v[112:113], v[48:49] op_sel:[1,1,0] op_sel_hi:[1,0,1] neg_lo:[1,0,0]
    v_pk_fma_f32 v[104:105], v[102:103], v[96:97], v[50:51] op_sel:[1,1,0] op_sel_hi:[1,0,1] neg_lo:[1,0,0]
    v_cvt_pk_bf16_f32 v146, v40, -v41
    v_pk_mul_f32 v[48:49], v[120:121], v[112:113] op_sel:[0,0] op_sel_hi:[0,1]
    v_pk_mul_f32 v[50:51], v[104:105], v[96:97] op_sel:[0,0] op_sel_hi:[0,1]
    ds_write_b32 v176, v146 offset:544
    v_pk_fma_f32 v[122:123], v[120:121], v[112:113], v[48:49] op_sel:[1,1,0] op_sel_hi:[1,0,1] neg_lo:[1,0,0]
    v_pk_fma_f32 v[106:107], v[104:105], v[96:97], v[50:51] op_sel:[1,1,0] op_sel_hi:[1,0,1] neg_lo:[1,0,0]
    v_pk_mul_f32 v[46:47], v[40:41], v[44:45] op_sel:[0,0] op_sel_hi:[0,1]
    v_pk_mul_f32 v[48:49], v[122:123], v[112:113] op_sel:[0,0] op_sel_hi:[0,1]
    v_pk_mul_f32 v[50:51], v[106:107], v[96:97] op_sel:[0,0] op_sel_hi:[0,1]
    v_pk_fma_f32 v[42:43], v[40:41], v[44:45], v[46:47] op_sel:[1,1,0] op_sel_hi:[1,0,1] neg_lo:[1,0,0]
    v_pk_fma_f32 v[124:125], v[122:123], v[112:113], v[48:49] op_sel:[1,1,0] op_sel_hi:[1,0,1] neg_lo:[1,0,0]
    v_pk_fma_f32 v[108:109], v[106:107], v[96:97], v[50:51] op_sel:[1,1,0] op_sel_hi:[1,0,1] neg_lo:[1,0,0]
    v_cvt_pk_bf16_f32 v147, v42, -v43
    v_pk_mul_f32 v[48:49], v[124:125], v[112:113] op_sel:[0,0] op_sel_hi:[0,1]
    ds_write_b32 v176, v147 offset:816
    v_pk_fma_f32 v[126:127], v[124:125], v[112:113], v[48:49] op_sel:[1,1,0] op_sel_hi:[1,0,1] neg_lo:[1,0,0]
    v_pk_mul_f32 v[46:47], v[42:43], v[44:45] op_sel:[0,0] op_sel_hi:[0,1]
    v_cvt_pk_bf16_f32 v152, v126, v127
    v_pk_fma_f32 v[40:41], v[42:43], v[44:45], v[46:47] op_sel:[1,1,0] op_sel_hi:[1,0,1] neg_lo:[1,0,0]
    ds_write_b32 v176, v152 offset:4352
    v_cvt_pk_bf16_f32 v148, v40, -v41
    v_pk_mul_f32 v[48:49], v[126:127], v[112:113] op_sel:[0,0] op_sel_hi:[0,1]
    ds_write_b32 v176, v148 offset:1088
    v_pk_fma_f32 v[128:129], v[126:127], v[112:113], v[48:49] op_sel:[1,1,0] op_sel_hi:[1,0,1] neg_lo:[1,0,0]
    v_pk_mul_f32 v[46:47], v[40:41], v[44:45] op_sel:[0,0] op_sel_hi:[0,1]
    v_cvt_pk_bf16_f32 v153, v128, v129
    v_pk_fma_f32 v[42:43], v[40:41], v[44:45], v[46:47] op_sel:[1,1,0] op_sel_hi:[1,0,1] neg_lo:[1,0,0]
    ds_write_b32 v176, v153 offset:4624
    v_cvt_pk_bf16_f32 v149, v42, -v43
    v_pk_mul_f32 v[48:49], v[128:129], v[112:113] op_sel:[0,0] op_sel_hi:[0,1]
    ds_write_b32 v176, v149 offset:1360
    v_pk_fma_f32 v[130:131], v[128:129], v[112:113], v[48:49] op_sel:[1,1,0] op_sel_hi:[1,0,1] neg_lo:[1,0,0]
    v_pk_mul_f32 v[46:47], v[42:43], v[44:45] op_sel:[0,0] op_sel_hi:[0,1]
    v_cvt_pk_bf16_f32 v154, v130, v131
    v_pk_fma_f32 v[40:41], v[42:43], v[44:45], v[46:47] op_sel:[1,1,0] op_sel_hi:[1,0,1] neg_lo:[1,0,0]
    ds_write_b32 v176, v154 offset:4896
    v_cvt_pk_bf16_f32 v150, v40, -v41
    v_pk_mul_f32 v[48:49], v[130:131], v[112:113] op_sel:[0,0] op_sel_hi:[0,1]
    ds_write_b32 v176, v150 offset:1632
    v_pk_fma_f32 v[132:133], v[130:131], v[112:113], v[48:49] op_sel:[1,1,0] op_sel_hi:[1,0,1] neg_lo:[1,0,0]
    v_pk_mul_f32 v[46:47], v[40:41], v[44:45] op_sel:[0,0] op_sel_hi:[0,1]
    v_cvt_pk_bf16_f32 v155, v132, v133
    v_pk_fma_f32 v[42:43], v[40:41], v[44:45], v[46:47] op_sel:[1,1,0] op_sel_hi:[1,0,1] neg_lo:[1,0,0]
    ds_write_b32 v176, v155 offset:5168
    v_cvt_pk_bf16_f32 v151, v42, -v43
    v_pk_mul_f32 v[48:49], v[132:133], v[112:113] op_sel:[0,0] op_sel_hi:[0,1]
    ds_write_b32 v176, v151 offset:1904
    v_pk_fma_f32 v[134:135], v[132:133], v[112:113], v[48:49] op_sel:[1,1,0] op_sel_hi:[1,0,1] neg_lo:[1,0,0]
    v_pk_mul_f32 v[46:47], v[42:43], v[44:45] op_sel:[0,0] op_sel_hi:[0,1]
    v_cvt_pk_bf16_f32 v156, v134, v135
    v_pk_fma_f32 v[40:41], v[42:43], v[44:45], v[46:47] op_sel:[1,1,0] op_sel_hi:[1,0,1] neg_lo:[1,0,0]
    ds_write_b32 v176, v156 offset:5440
    v_cvt_pk_bf16_f32 v144, v40, -v41
    v_pk_mul_f32 v[48:49], v[134:135], v[112:113] op_sel:[0,0] op_sel_hi:[0,1]
    ds_write_b32 v176, v144 offset:2176
    v_pk_fma_f32 v[136:137], v[134:135], v[112:113], v[48:49] op_sel:[1,1,0] op_sel_hi:[1,0,1] neg_lo:[1,0,0]
    v_pk_mul_f32 v[46:47], v[40:41], v[44:45] op_sel:[0,0] op_sel_hi:[0,1]
    v_cvt_pk_bf16_f32 v157, v136, v137
    v_pk_fma_f32 v[42:43], v[40:41], v[44:45], v[46:47] op_sel:[1,1,0] op_sel_hi:[1,0,1] neg_lo:[1,0,0]
    ds_write_b32 v176, v157 offset:5712
    v_cvt_pk_bf16_f32 v145, v42, -v43
    v_pk_mul_f32 v[48:49], v[136:137], v[112:113] op_sel:[0,0] op_sel_hi:[0,1]
    ds_write_b32 v176, v145 offset:2448
    v_pk_fma_f32 v[138:139], v[136:137], v[112:113], v[48:49] op_sel:[1,1,0] op_sel_hi:[1,0,1] neg_lo:[1,0,0]
    v_pk_mul_f32 v[46:47], v[42:43], v[44:45] op_sel:[0,0] op_sel_hi:[0,1]
    v_cvt_pk_bf16_f32 v158, v138, v139
    v_pk_fma_f32 v[40:41], v[42:43], v[44:45], v[46:47] op_sel:[1,1,0] op_sel_hi:[1,0,1] neg_lo:[1,0,0]
    ds_write_b32 v176, v158 offset:5984
    v_cvt_pk_bf16_f32 v146, v40, -v41
    v_pk_mul_f32 v[48:49], v[138:139], v[112:113] op_sel:[0,0] op_sel_hi:[0,1]
    ds_write_b32 v176, v146 offset:2720
    v_pk_fma_f32 v[140:141], v[138:139], v[112:113], v[48:49] op_sel:[1,1,0] op_sel_hi:[1,0,1] neg_lo:[1,0,0]
    v_pk_mul_f32 v[46:47], v[40:41], v[44:45] op_sel:[0,0] op_sel_hi:[0,1]
    v_cvt_pk_bf16_f32 v159, v140, v141
    v_pk_fma_f32 v[42:43], v[40:41], v[44:45], v[46:47] op_sel:[1,1,0] op_sel_hi:[1,0,1] neg_lo:[1,0,0]
    ds_write_b32 v176, v159 offset:6256
    v_cvt_pk_bf16_f32 v147, v42, -v43
    v_pk_mul_f32 v[48:49], v[140:141], v[112:113] op_sel:[0,0] op_sel_hi:[0,1]
    ds_write_b32 v176, v147 offset:2992
    v_pk_fma_f32 v[142:143], v[140:141], v[112:113], v[48:49] op_sel:[1,1,0] op_sel_hi:[1,0,1] neg_lo:[1,0,0]
    v_pk_mul_f32 v[46:47], v[42:43], v[44:45] op_sel:[0,0] op_sel_hi:[0,1]
    v_cvt_pk_bf16_f32 v152, v142, v143
    v_pk_fma_f32 v[40:41], v[42:43], v[44:45], v[46:47] op_sel:[1,1,0] op_sel_hi:[1,0,1] neg_lo:[1,0,0]
    ds_write_b32 v176, v152 offset:6528
    v_cvt_pk_bf16_f32 v148, v40, -v41
    ds_write_b32 v176, v148 offset:3264
    v_pk_mul_f32 v[46:47], v[40:41], v[44:45] op_sel:[0,0] op_sel_hi:[0,1]
    v_pk_fma_f32 v[42:43], v[40:41], v[44:45], v[46:47] op_sel:[1,1,0] op_sel_hi:[1,0,1] neg_lo:[1,0,0]
    v_cvt_pk_bf16_f32 v149, v42, -v43
    ds_write_b32 v176, v149 offset:3536
    v_pk_mul_f32 v[46:47], v[42:43], v[44:45] op_sel:[0,0] op_sel_hi:[0,1]
    v_pk_fma_f32 v[40:41], v[42:43], v[44:45], v[46:47] op_sel:[1,1,0] op_sel_hi:[1,0,1] neg_lo:[1,0,0]
    v_cvt_pk_bf16_f32 v150, v40, -v41
    ds_write_b32 v176, v150 offset:3808
    v_pk_mul_f32 v[46:47], v[40:41], v[44:45] op_sel:[0,0] op_sel_hi:[0,1]
    v_pk_fma_f32 v[42:43], v[40:41], v[44:45], v[46:47] op_sel:[1,1,0] op_sel_hi:[1,0,1] neg_lo:[1,0,0]
    v_cvt_pk_bf16_f32 v151, v42, -v43
    ds_write_b32 v176, v151 offset:4080
    s_waitcnt lgkmcnt(0)
    ds_read_b128 v[52:55], v177 offset:0
    ds_read_b128 v[68:71], v177 offset:4352
    ds_read_b128 v[56:59], v177 offset:64
    ds_read_b128 v[72:75], v177 offset:4416
    ds_read_b128 v[60:63], v177 offset:128
    ds_read_b128 v[76:79], v177 offset:4480
    ds_read_b128 v[64:67], v177 offset:192
    ds_read_b128 v[80:83], v177 offset:4544
    s_waitcnt vmcnt(19)
    v_mov_b32 v6, 157696
    v_add_u32_sdwa v200, v6, v180 dst_sel:DWORD dst_unused:UNUSED_PAD src0_sel:DWORD src1_sel:WORD_0
    v_add_u32_sdwa v201, v6, v180 dst_sel:DWORD dst_unused:UNUSED_PAD src0_sel:DWORD src1_sel:WORD_1
    v_add_u32_sdwa v202, v6, v181 dst_sel:DWORD dst_unused:UNUSED_PAD src0_sel:DWORD src1_sel:WORD_0
    v_add_u32_sdwa v203, v6, v181 dst_sel:DWORD dst_unused:UNUSED_PAD src0_sel:DWORD src1_sel:WORD_1
    v_add_u32_sdwa v204, v6, v182 dst_sel:DWORD dst_unused:UNUSED_PAD src0_sel:DWORD src1_sel:WORD_0
    v_add_u32_sdwa v205, v6, v182 dst_sel:DWORD dst_unused:UNUSED_PAD src0_sel:DWORD src1_sel:WORD_1
    v_add_u32_sdwa v206, v6, v183 dst_sel:DWORD dst_unused:UNUSED_PAD src0_sel:DWORD src1_sel:WORD_0
    v_add_u32_sdwa v207, v6, v183 dst_sel:DWORD dst_unused:UNUSED_PAD src0_sel:DWORD src1_sel:WORD_1
    v_add_u32_sdwa v208, v6, v184 dst_sel:DWORD dst_unused:UNUSED_PAD src0_sel:DWORD src1_sel:WORD_0
    v_add_u32_sdwa v209, v6, v184 dst_sel:DWORD dst_unused:UNUSED_PAD src0_sel:DWORD src1_sel:WORD_1
    v_add_u32_sdwa v210, v6, v185 dst_sel:DWORD dst_unused:UNUSED_PAD src0_sel:DWORD src1_sel:WORD_0
    v_mov_b32 v46, 1.0
    v_mov_b32 v47, 0
    s_waitcnt lgkmcnt(0)
    v_mfma_f32_16x16x32_bf16 v[172:175], v[52:55], v[68:71], 0
    v_mfma_f32_16x16x32_bf16 v[172:175], v[56:59], v[72:75], v[172:175]
    v_mfma_f32_16x16x32_bf16 v[172:175], v[60:63], v[76:79], v[172:175]
    v_mfma_f32_16x16x32_bf16 v[172:175], v[64:67], v[80:83], v[172:175]
    v_cvt_pk_bf16_f32 v144, v46, v47
    v_cvt_pk_bf16_f32 v147, v96, v97
    v_cvt_pk_bf16_f32 v150, v98, v99
    ds_write_b32 v176, v144 offset:0
    ds_write_b32 v176, v147 offset:272
    ds_write_b32 v176, v150 offset:544
    v_cvt_pk_bf16_f32 v145, v100, v101
    v_cvt_pk_bf16_f32 v148, v102, v103
    v_cvt_pk_bf16_f32 v151, v104, v105
    ds_write_b32 v176, v145 offset:816
    ds_write_b32 v176, v148 offset:1088
    ds_write_b32 v176, v151 offset:1360
    v_cvt_pk_bf16_f32 v146, v106, v107
    v_cvt_pk_bf16_f32 v149, v108, v109
    v_cvt_pk_bf16_f32 v152, v112, v113
    ds_write_b32 v176, v146 offset:1632
    ds_write_b32 v176, v149 offset:1904
    ds_write_b32 v176, v152 offset:2176
    v_pk_mul_f32 v[6:7], v[96:97], v[112:113] op_sel:[0,0] op_sel_hi:[0,1]
    v_pk_mul_f32 v[10:11], v[98:99], v[112:113] op_sel:[0,0] op_sel_hi:[0,1]
    s_mul_i32 s68, s52, 229376
    s_mul_i32 s69, s53, 112
    s_add_u32 s68, s68, s69
    s_and_b32 s70, s44, 1
    s_mul_i32 s70, s70, 192
    s_movk_i32 s69, 9363
    s_movk_i32 s76, 3472
    s_cmp_lt_u32 s44, 2
    s_cselect_b32 s36, s20, s22
    s_cselect_b32 s37, s21, s23
    s_cselect_b32 s73, 0, 7168
    s_lshl_b32 s74, s70, 4
    s_add_u32 s73, s73, s74
    v_add_u32 v189, s70, v1
    v_mul_u32_u24 v187, s69, v189
    v_lshl_add_u32 v186, v189, 4, s68
    v_lshrrev_b32 v187, 16, v187
    s_add_u32 m0, s73, 0
    v_mad_u32_u24 v186, v187, s76, v186
    global_load_lds_dwordx4 v186, s[36:37]
    v_add_u32 v189, 64, v189
    v_mul_u32_u24 v187, s69, v189
    v_lshl_add_u32 v186, v189, 4, s68
    v_lshrrev_b32 v187, 16, v187
    s_add_u32 m0, s73, 1024
    v_mad_u32_u24 v186, v187, s76, v186
    global_load_lds_dwordx4 v186, s[36:37]
    v_add_u32 v189, 64, v189
    v_mul_u32_u24 v187, s69, v189
    v_lshl_add_u32 v186, v189, 4, s68
    v_lshrrev_b32 v187, 16, v187
    s_add_u32 m0, s73, 2048
    v_mad_u32_u24 v186, v187, s76, v186
    global_load_lds_dwordx4 v186, s[36:37]
    v_add_u32 v189, 64, v189
    v_mul_u32_u24 v187, s69, v189
    v_lshl_add_u32 v186, v189, 4, s68
    v_lshrrev_b32 v187, 16, v187
    s_add_u32 m0, s73, 3072
    v_mad_u32_u24 v186, v187, s76, v186
    global_load_lds_dwordx4 v186, s[36:37]
    v_pk_mul_f32 v[14:15], v[100:101], v[112:113] op_sel:[0,0] op_sel_hi:[0,1]
    v_pk_fma_f32 v[4:5], v[96:97], v[112:113], v[6:7] op_sel:[1,1,0] op_sel_hi:[1,0,1] neg_lo:[1,0,0]
    v_pk_fma_f32 v[8:9], v[98:99], v[112:113], v[10:11] op_sel:[1,1,0] op_sel_hi:[1,0,1] neg_lo:[1,0,0]
    v_pk_fma_f32 v[12:13], v[100:101], v[112:113], v[14:15] op_sel:[1,1,0] op_sel_hi:[1,0,1] neg_lo:[1,0,0]
    v_cvt_pk_bf16_f32 v144, v4, v5
    v_cvt_pk_bf16_f32 v147, v8, v9
    v_cvt_pk_bf16_f32 v150, v12, v13
    ds_write_b32 v176, v144 offset:2448
    ds_write_b32 v176, v147 offset:2720
    ds_write_b32 v176, v150 offset:2992
    v_pk_mul_f32 v[6:7], v[102:103], v[112:113] op_sel:[0,0] op_sel_hi:[0,1]
    v_pk_mul_f32 v[10:11], v[104:105], v[112:113] op_sel:[0,0] op_sel_hi:[0,1]
    v_pk_mul_f32 v[14:15], v[106:107], v[112:113] op_sel:[0,0] op_sel_hi:[0,1]
    v_pk_fma_f32 v[4:5], v[102:103], v[112:113], v[6:7] op_sel:[1,1,0] op_sel_hi:[1,0,1] neg_lo:[1,0,0]
    v_pk_fma_f32 v[8:9], v[104:105], v[112:113], v[10:11] op_sel:[1,1,0] op_sel_hi:[1,0,1] neg_lo:[1,0,0]
    v_pk_fma_f32 v[12:13], v[106:107], v[112:113], v[14:15] op_sel:[1,1,0] op_sel_hi:[1,0,1] neg_lo:[1,0,0]
    v_cvt_pk_bf16_f32 v145, v4, v5
    v_cvt_pk_bf16_f32 v148, v8, v9
    v_cvt_pk_bf16_f32 v151, v12, v13
    ds_write_b32 v176, v145 offset:3264
    ds_write_b32 v176, v148 offset:3536
    ds_write_b32 v176, v151 offset:3808
    v_pk_mul_f32 v[6:7], v[108:109], v[112:113] op_sel:[0,0] op_sel_hi:[0,1]
    v_cvt_pk_bf16_f32 v149, v114, v115
    v_pk_mul_f32 v[14:15], v[98:99], v[114:115] op_sel:[0,0] op_sel_hi:[0,1]
    v_pk_fma_f32 v[4:5], v[108:109], v[112:113], v[6:7] op_sel:[1,1,0] op_sel_hi:[1,0,1] neg_lo:[1,0,0]
    ds_write_b32 v176, v149 offset:4352
    v_pk_fma_f32 v[12:13], v[98:99], v[114:115], v[14:15] op_sel:[1,1,0] op_sel_hi:[1,0,1] neg_lo:[1,0,0]
    s_waitcnt vmcnt(4)
    s_barrier
    s_cmp_lg_u32 s44, 1
    s_cbranch_scc1 nosig_1
    s_lshl_b32 s67, s2, 4
    s_add_u32 s67, s67, 65536
    v_lshl_add_u32 v18, v1, 12, s67
    v_mov_b32 v16, s46
    v_mov_b32 v17, s47
    s_mov_b64 exec, 0xff
    buffer_store_dwordx2 v[16:17], v18, s[32:35], 0 offen sc1
    s_mov_b64 exec, -1
nosig_1:
    s_and_b32 s68, s2, 7
    s_mul_i32 s68, s68, 229376
    s_lshr_b32 s69, s2, 3
    s_lshl_b32 s69, s69, 5
    s_add_u32 s68, s68, s69
    s_lshl_b32 s69, s44, 15
    s_add_u32 s68, s68, s69
    v_lshrrev_b32 v187, 1, v1
    v_and_b32 v188, 1, v1
    v_lshl_add_u32 v187, v187, 10, s68
    v_lshl_add_u32 v190, v188, 4, v187
    s_cmp_eq_u32 s44, 3
    s_cselect_b32 s70, 0, 4
    s_lshl_b32 s69, s70, 15
    v_add_u32 v191, s69, v190
    s_lshl_b32 s73, s44, 10
    s_add_u32 m0, s73, 107520
    s_lshl_b32 s74, s70, 10
    global_load_lds_dwordx4 v190, s[24:25]
    s_add_u32 m0, m0, s74
    s_nop 0
    global_load_lds_dwordx4 v191, s[24:25]
    v_cvt_pk_bf16_f32 v146, v4, v5
    v_pk_mul_f32 v[10:11], v[106:107], v[114:115] op_sel:[0,0] op_sel_hi:[0,1]
    v_cvt_pk_bf16_f32 v152, v12, v13
    ds_write_b32 v176, v146 offset:4080
    v_pk_fma_f32 v[8:9], v[106:107], v[114:115], v[10:11] op_sel:[1,1,0] op_sel_hi:[1,0,1] neg_lo:[1,0,0]
    ds_write_b32 v176, v152 offset:4624
    v_pk_mul_f32 v[6:7], v[102:103], v[114:115] op_sel:[0,0] op_sel_hi:[0,1]
    v_cvt_pk_bf16_f32 v147, v8, v9
    v_cvt_pk_bf16_f32 v150, v116, v117
    v_pk_fma_f32 v[4:5], v[102:103], v[114:115], v[6:7] op_sel:[1,1,0] op_sel_hi:[1,0,1] neg_lo:[1,0,0]
    ds_write_b32 v176, v147 offset:5168
    ds_write_b32 v176, v150 offset:5440
    v_cvt_pk_bf16_f32 v144, v4, v5
    v_pk_mul_f32 v[10:11], v[102:103], v[116:117] op_sel:[0,0] op_sel_hi:[0,1]
    v_pk_mul_f32 v[14:15], v[106:107], v[116:117] op_sel:[0,0] op_sel_hi:[0,1]
    ds_write_b32 v176, v144 offset:4896
    v_pk_fma_f32 v[8:9], v[102:103], v[116:117], v[10:11] op_sel:[1,1,0] op_sel_hi:[1,0,1] neg_lo:[1,0,0]
    v_pk_fma_f32 v[12:13], v[106:107], v[116:117], v[14:15] op_sel:[1,1,0] op_sel_hi:[1,0,1] neg_lo:[1,0,0]
    v_pk_mul_f32 v[6:7], v[98:99], v[116:117] op_sel:[0,0] op_sel_hi:[0,1]
    v_cvt_pk_bf16_f32 v148, v8, v9
    v_cvt_pk_bf16_f32 v151, v12, v13
    v_pk_fma_f32 v[4:5], v[98:99], v[116:117], v[6:7] op_sel:[1,1,0] op_sel_hi:[1,0,1] neg_lo:[1,0,0]
    ds_write_b32 v176, v148 offset:5984
    ds_write_b32 v176, v151 offset:6256
    v_cvt_pk_bf16_f32 v145, v4, v5
    v_pk_mul_f32 v[10:11], v[102:103], v[118:119] op_sel:[0,0] op_sel_hi:[0,1]
    v_cvt_pk_bf16_f32 v152, v120, v121
    ds_write_b32 v176, v145 offset:5712
    v_pk_fma_f32 v[8:9], v[102:103], v[118:119], v[10:11] op_sel:[1,1,0] op_sel_hi:[1,0,1] neg_lo:[1,0,0]
    ds_write_b32 v176, v152 offset:7072
    v_cvt_pk_bf16_f32 v146, v118, v119
    v_cvt_pk_bf16_f32 v149, v8, v9
    v_pk_mul_f32 v[14:15], v[102:103], v[122:123] op_sel:[0,0] op_sel_hi:[0,1]
    ds_write_b32 v176, v146 offset:6528
    ds_write_b32 v176, v149 offset:6800
    v_pk_fma_f32 v[12:13], v[102:103], v[122:123], v[14:15] op_sel:[1,1,0] op_sel_hi:[1,0,1] neg_lo:[1,0,0]
    v_pk_mul_f32 v[6:7], v[102:103], v[120:121] op_sel:[0,0] op_sel_hi:[0,1]
    v_cvt_pk_bf16_f32 v147, v122, v123
    v_cvt_pk_bf16_f32 v150, v12, v13
    v_pk_fma_f32 v[4:5], v[102:103], v[120:121], v[6:7] op_sel:[1,1,0] op_sel_hi:[1,0,1] neg_lo:[1,0,0]
    ds_write_b32 v176, v147 offset:7616
    ds_write_b32 v176, v150 offset:7888
    v_cvt_pk_bf16_f32 v144, v4, v5
    v_pk_mul_f32 v[10:11], v[102:103], v[124:125] op_sel:[0,0] op_sel_hi:[0,1]
    ds_write_b32 v176, v144 offset:7344
    v_pk_fma_f32 v[8:9], v[102:103], v[124:125], v[10:11] op_sel:[1,1,0] op_sel_hi:[1,0,1] neg_lo:[1,0,0]
    v_cvt_pk_bf16_f32 v145, v124, v125
    v_cvt_pk_bf16_f32 v148, v8, v9
    ds_write_b32 v176, v145 offset:8160
    ds_write_b32 v176, v148 offset:8432
    s_waitcnt lgkmcnt(0)
    ds_read_b128 v[96:99], v177 offset:0
    ds_read_b128 v[112:115], v177 offset:4352
    ds_read_b128 v[100:103], v177 offset:64
    ds_read_b128 v[116:119], v177 offset:4416
    ds_read_b128 v[104:107], v177 offset:128
    ds_read_b128 v[120:123], v177 offset:4480
    ds_read_b128 v[108:111], v177 offset:192
    ds_read_b128 v[124:127], v177 offset:4544
    s_waitcnt lgkmcnt(6)
    v_mfma_f32_16x16x32_bf16 v[164:167], v[52:55], v[96:99], 0
    v_mfma_f32_16x16x32_bf16 v[168:171], v[52:55], v[112:115], 0
    s_waitcnt lgkmcnt(4)
    v_mfma_f32_16x16x32_bf16 v[164:167], v[56:59], v[100:103], v[164:167]
    v_mfma_f32_16x16x32_bf16 v[168:171], v[56:59], v[116:119], v[168:171]
    s_waitcnt lgkmcnt(2)
    v_mfma_f32_16x16x32_bf16 v[164:167], v[60:63], v[104:107], v[164:167]
    v_mfma_f32_16x16x32_bf16 v[168:171], v[60:63], v[120:123], v[168:171]
    s_waitcnt lgkmcnt(0)
    v_mfma_f32_16x16x32_bf16 v[164:167], v[64:67], v[108:111], v[164:167]
    v_mfma_f32_16x16x32_bf16 v[168:171], v[64:67], v[124:127], v[168:171]
    s_bitcmp1_b32 s44, 0
    s_cbranch_scc1 L_kg_odd1
    s_nop 4
    ds_write_b128 v178, v[164:167] offset:0
    ds_write_b128 v178, v[168:171] offset:1024
    ds_write_b128 v178, v[172:175] offset:2048
    s_waitcnt lgkmcnt(0)
L_kg_odd1:
    s_barrier
    s_bitcmp1_b32 s44, 0
    s_cbranch_scc0 L_kg_even2
    ds_read_b128 v[52:55], v178 offset:0
    ds_read_b128 v[56:59], v178 offset:1024
    ds_read_b128 v[60:63], v178 offset:2048
    s_waitcnt lgkmcnt(0)
    v_pk_add_f32 v[164:165], v[164:165], v[52:53]
    v_pk_add_f32 v[166:167], v[166:167], v[54:55]
    v_pk_add_f32 v[168:169], v[168:169], v[56:57]
    v_pk_add_f32 v[170:171], v[170:171], v[58:59]
    v_pk_add_f32 v[172:173], v[172:173], v[60:61]
    v_pk_add_f32 v[174:175], v[174:175], v[62:63]
    v_writelane_b32 v175, 0, 63
    ds_write_b32 v179, v164 offset:0
    ds_write_b32 v179, v165 offset:8
    ds_write_b32 v179, v166 offset:16
    ds_write_b32 v179, v167 offset:24
    ds_write_b32 v179, v168 offset:2048
    ds_write_b32 v179, v169 offset:2056
    ds_write_b32 v179, v170 offset:2064
    ds_write_b32 v179, v171 offset:2072
    ds_write_b32 v179, v172 offset:4096
    ds_write_b32 v179, v173 offset:4104
    ds_write_b32 v179, v174 offset:4112
    ds_write_b32 v179, v175 offset:4120
    s_waitcnt lgkmcnt(0)
L_kg_even2:
    s_barrier
    ds_read_b64 v[60:61], v200
    ds_read_b64 v[62:63], v201
    ds_read_b64 v[64:65], v202
    ds_read_b64 v[66:67], v203
    ds_read_b64 v[68:69], v204
    ds_read_b64 v[70:71], v205
    ds_read_b64 v[72:73], v206
    ds_read_b64 v[74:75], v207
    ds_read_b64 v[76:77], v208
    ds_read_b64 v[78:79], v209
    ds_read_b64 v[80:81], v210
    ds_read_b32 v84, v192
    ds_read_b32 v85, v193
    ds_read_b32 v86, v194
    ds_read_b32 v87, v195
    v_add_u32 v95, 114688, v231
    v_mov_b32 v4, 0
    v_mov_b32 v5, 0
    v_mov_b32 v6, 0
    v_mov_b32 v7, 0
    s_and_b32 s68, s44, 1
    s_mul_i32 s68, s68, 4608
    s_add_u32 s68, s68, 147968
    v_add_u32 v8, s68, v232
    s_mov_b64 exec, 0x3fffffff
    ds_write_b128 v8, v[4:7]
    s_mov_b64 exec, -1
    buffer_load_dwordx2 v[12:13], v231, s[32:35], s79 offen sc1
    s_waitcnt lgkmcnt(0)
    v_cvt_pk_bf16_f32 v96, v66, v68
    v_cvt_pk_bf16_f32 v97, v70, v72
    v_cvt_pk_bf16_f32 v98, v74, v76
    v_cvt_pk_bf16_f32 v99, v78, v80
    ds_write_b128 v95, v[96:99] offset:0
    v_cvt_pk_bf16_f32 v100, v64, v66
    v_cvt_pk_bf16_f32 v101, v68, v70
    v_cvt_pk_bf16_f32 v102, v72, v74
    v_cvt_pk_bf16_f32 v103, v76, v78
    ds_write_b128 v95, v[100:103] offset:4160
    v_cvt_pk_bf16_f32 v104, v62, v64
    v_cvt_pk_bf16_f32 v105, v66, v68
    v_cvt_pk_bf16_f32 v106, v70, v72
    v_cvt_pk_bf16_f32 v107, v74, v76
    ds_write_b128 v95, v[104:107] offset:8320
    v_cvt_pk_bf16_f32 v108, v60, v62
    v_cvt_pk_bf16_f32 v109, v64, v66
    v_cvt_pk_bf16_f32 v110, v68, v70
    v_cvt_pk_bf16_f32 v111, v72, v74
    ds_write_b128 v95, v[108:111] offset:12480
    s_waitcnt vmcnt(0)
    v_cmp_ne_u64 s[86:87], s[46:47], v[12:13]
    s_nop 0
    s_cmp_eq_u64 s[86:87], 0
    s_cbranch_scc0 slow_2
ok_3:
    s_barrier
    s_mov_b32 s68, 327680
    s_mov_b32 s69, 331776
    s_mov_b32 s70, 1048576
    s_mov_b32 s71, 1310720
    buffer_load_dwordx4 v[192:195], v231, s[32:35], s68 offen sc1
    buffer_load_dwordx4 v[196:199], v231, s[32:35], s69 offen sc1
    buffer_load_dwordx2 v[200:201], v235, s[32:35], s70 offen sc1
    buffer_load_dwordx2 v[202:203], v235, s[32:35], s70 offen offset:64 sc1
    buffer_load_dwordx2 v[204:205], v236, s[32:35], s70 offen sc1
    buffer_load_dwordx2 v[206:207], v236, s[32:35], s71 offen sc1
    ds_read_b64_tr_b16 v[128:129], v220 offset:0
    ds_read_b64_tr_b16 v[130:131], v220 offset:512
    ds_read_b64_tr_b16 v[132:133], v221 offset:0
    ds_read_b64_tr_b16 v[134:135], v222 offset:0
    ds_read_b64_tr_b16 v[136:137], v223 offset:0
    ds_read_b64_tr_b16 v[138:139], v223 offset:1792
    ds_read_b64_tr_b16 v[140:141], v224 offset:0
    ds_read_b64_tr_b16 v[142:143], v224 offset:1792
    ds_read_b64_tr_b16 v[144:145], v225 offset:0
    ds_read_b64_tr_b16 v[146:147], v225 offset:1792
    ds_read_b64_tr_b16 v[148:149], v226 offset:0
    ds_read_b64_tr_b16 v[150:151], v226 offset:1792
    s_cmp_eq_u32 s44, 3
    s_cselect_b32 s69, 0, 16384
    s_add_u32 s69, s77, s69
    s_waitcnt lgkmcnt(10)
    buffer_store_dwordx4 v[128:131], v232, s[32:35], s77 offen sc1
    s_waitcnt lgkmcnt(8)
    buffer_store_dwordx4 v[132:135], v232, s[32:35], s69 offen sc1
    s_waitcnt lgkmcnt(6)
    buffer_store_dwordx4 v[136:139], v232, s[32:35], s78 offen offset:0 sc1
    s_waitcnt lgkmcnt(4)
    buffer_store_dwordx4 v[140:143], v232, s[32:35], s78 offen offset:1024 sc1
    s_waitcnt lgkmcnt(2)
    buffer_store_dwordx4 v[144:147], v232, s[32:35], s78 offen offset:2048 sc1
    s_waitcnt lgkmcnt(0)
    buffer_store_dwordx4 v[148:151], v232, s[32:35], s78 offen offset:3072 sc1
    v_mov_b32 v56, 0
    v_mov_b32 v57, 0
    v_mov_b32 v58, 0
    v_mov_b32 v59, 0
    s_mov_b64 exec, 1
    s_mov_b32 s68, 344064
    buffer_store_dwordx4 v[56:59], v34, s[32:35], s68 offen sc1
    s_mov_b64 exec, -1
    v_cvt_pk_bf16_f32 v112, v67, v69
    v_cvt_pk_bf16_f32 v113, v71, v73
    v_cvt_pk_bf16_f32 v114, v75, v77
    v_cvt_pk_bf16_f32 v115, v79, v81
    ds_write_b128 v95, v[112:115] offset:16640
    v_cvt_pk_bf16_f32 v116, v65, v67
    v_cvt_pk_bf16_f32 v117, v69, v71
    v_cvt_pk_bf16_f32 v118, v73, v75
    v_cvt_pk_bf16_f32 v119, v77, v79
    ds_write_b128 v95, v[116:119] offset:20800
    v_cvt_pk_bf16_f32 v120, v63, v65
    v_cvt_pk_bf16_f32 v121, v67, v69
    v_cvt_pk_bf16_f32 v122, v71, v73
    v_cvt_pk_bf16_f32 v123, v75, v77
    ds_write_b128 v95, v[120:123] offset:24960
    v_cvt_pk_bf16_f32 v124, v61, v63
    v_cvt_pk_bf16_f32 v125, v65, v67
    v_cvt_pk_bf16_f32 v126, v69, v71
    v_cvt_pk_bf16_f32 v127, v73, v75
    ds_write_b128 v95, v[124:127] offset:29120
    v_cvt_pk_bf16_f32 v228, v84, v85
    v_cvt_pk_bf16_f32 v229, v86, v87
    v_and_b32 v4, 3, v1
    v_bfe_u32 v5, v1, 2, 1
    v_mul_u32_u24 v4, 4160, v4
    v_mul_u32_u24 v5, 16640, v5
    v_add3_u32 v8, v4, v5, 0
    v_add_u32 v8, 118784, v8
    v_mov_b32 v6, 0
    v_mov_b32 v7, 0
    s_mov_b64 exec, 0xff
    ds_write_b64 v8, v[228:229]
    ds_write_b64 v8, v[6:7] offset:8
    ds_write_b64 v8, v[6:7] offset:16
    ds_write_b64 v8, v[6:7] offset:24
    s_mov_b64 exec, -1
    s_waitcnt lgkmcnt(0)
    s_barrier
    ds_read_b64 v[48:49], v233 offset:3776
    ds_read_b64 v[50:51], v233 offset:3784
    ds_read_b64 v[52:53], v233 offset:3264
    ds_read_b64 v[54:55], v233 offset:3272
    ds_read_b64 v[56:57], v233 offset:2752
    ds_read_b64 v[58:59], v233 offset:2760
    ds_read_b64 v[60:61], v233 offset:2240
    ds_read_b64 v[62:63], v233 offset:2248
    ds_read_b64 v[64:65], v233 offset:3712
    ds_read_b64 v[66:67], v233 offset:3720
    ds_read_b64 v[68:69], v233 offset:3200
    ds_read_b64 v[70:71], v233 offset:3208
    ds_read_b64 v[72:73], v233 offset:2688
    ds_read_b64 v[74:75], v233 offset:2696
    ds_read_b64 v[76:77], v233 offset:2176
    ds_read_b64 v[78:79], v233 offset:2184
    ds_read_b64 v[80:81], v233 offset:3648
    ds_read_b64 v[82:83], v233 offset:3656
    ds_read_b64 v[84:85], v233 offset:3136
    ds_read_b64 v[86:87], v233 offset:3144
    ds_read_b64 v[88:89], v233 offset:2624
    ds_read_b64 v[90:91], v233 offset:2632
    ds_read_b64 v[92:93], v233 offset:2112
    ds_read_b64 v[94:95], v233 offset:2120
    ds_read_b64 v[96:97], v233 offset:3584
    ds_read_b64 v[98:99], v233 offset:3592
    ds_read_b64 v[100:101], v233 offset:3072
    ds_read_b64 v[102:103], v233 offset:3080
    ds_read_b64 v[104:105], v233 offset:2560
    ds_read_b64 v[106:107], v233 offset:2568
    ds_read_b64 v[108:109], v233 offset:2048
    ds_read_b64 v[110:111], v233 offset:2056
    s_cmp_lt_u32 s44, 2
    s_cselect_b32 s40, s48, s50
    s_lshl_b32 s89, s44, 11
    s_add_u32 s89, s89, 157184
    s_xor_b32 s90, s44, 1
    s_lshl_b32 s90, s90, 11
    s_add_u32 s90, s90, 157184
    s_cmp_eq_u32 s44, 3
    s_cselect_b32 s89, 155104, s89
    s_cmp_eq_u32 s44, 2
    s_cselect_b32 s90, 155104, s90
    s_add_u32 s64, s80, 294912
    s_waitcnt vmcnt(7)
    v_mov_b32 v4, 0
    v_mov_b32 v5, 0x3727c5ac
    s_mov_b32 s72, 0x3b000000
    s_mov_b32 s73, 0x3b000000
    v_lshrrev_b32 v6, 1, v231
    v_add_u32 v6, 148448, v6
    v_pk_fma_f32 v[192:193], v[192:193], s[72:73], v[4:5]
    v_pk_fma_f32 v[194:195], v[194:195], s[72:73], v[4:5]
    v_pk_fma_f32 v[196:197], v[196:197], s[72:73], v[4:5]
    v_pk_fma_f32 v[198:199], v[198:199], s[72:73], v[4:5]
    v_fma_f32 v193, -v192, v192, v193
    v_fma_f32 v195, -v194, v194, v195
    v_fma_f32 v197, -v196, v196, v197
    v_fma_f32 v199, -v198, v198, v199
    v_max_f32 v193, v5, v193
    v_max_f32 v195, v5, v195
    v_max_f32 v197, v5, v197
    v_max_f32 v199, v5, v199
    v_rsq_f32 v112, v193
    v_lshlrev_b32 v120, 16, v200
    v_and_b32 v121, 0xffff0000, v200
    v_rsq_f32 v113, v195
    v_lshlrev_b32 v122, 16, v201
    v_and_b32 v123, 0xffff0000, v201
    v_rsq_f32 v114, v197
    v_lshlrev_b32 v124, 16, v202
    v_and_b32 v125, 0xffff0000, v202
    v_rsq_f32 v115, v199
    v_lshlrev_b32 v126, 16, v203
    v_and_b32 v127, 0xffff0000, v203
    v_mul_f32 v116, -v192, v112
    v_mul_f32 v117, -v194, v113
    v_mul_f32 v118, -v196, v114
    v_mul_f32 v119, -v198, v115
    v_pk_fma_f32 v[120:121], v[120:121], v[112:113], v[116:117]
    v_pk_fma_f32 v[122:123], v[122:123], v[114:115], v[118:119]
    v_cvt_pk_bf16_f32 v128, v120, v121
    v_cvt_pk_bf16_f32 v129, v122, v123
    ds_write_b64 v6, v[128:129] offset:0
    v_pk_fma_f32 v[124:125], v[124:125], v[112:113], v[116:117]
    v_pk_fma_f32 v[126:127], v[126:127], v[114:115], v[118:119]
    v_cvt_pk_bf16_f32 v130, v124, v125
    v_cvt_pk_bf16_f32 v131, v126, v127
    ds_write_b64 v6, v[130:131] offset:4608
    ds_read_b64_tr_b16 a[0:1], v212 offset:0
    ds_read_b64_tr_b16 a[2:3], v212 offset:2048
    ds_read_b64_tr_b16 a[4:5], v213 offset:0
    ds_read_b64_tr_b16 a[6:7], v213 offset:2048
    ds_read_b64_tr_b16 a[8:9], v214 offset:0
    ds_read_b64_tr_b16 a[10:11], v214 offset:2048
    ds_read_b64_tr_b16 a[12:13], v215 offset:0
    ds_read_b64_tr_b16 a[14:15], v215 offset:2048
    ds_read_b64_tr_b16 a[16:17], v212 offset:4096
    ds_read_b64_tr_b16 a[18:19], v212 offset:6144
    ds_read_b64_tr_b16 a[20:21], v213 offset:4096
    ds_read_b64_tr_b16 a[22:23], v213 offset:6144
    ds_read_b64_tr_b16 a[24:25], v214 offset:4096
    ds_read_b64_tr_b16 a[26:27], v214 offset:6144
    ds_read_b64_tr_b16 a[28:29], v215 offset:4096
    ds_read_b64_tr_b16 a[30:31], v215 offset:6144
    ds_read_b64_tr_b16 a[32:33], v212 offset:8192
    ds_read_b64_tr_b16 a[34:35], v212 offset:10240
    ds_read_b64_tr_b16 a[36:37], v213 offset:8192
    ds_read_b64_tr_b16 a[38:39], v213 offset:10240
    ds_read_b64_tr_b16 a[40:41], v214 offset:8192
    ds_read_b64_tr_b16 a[42:43], v214 offset:10240
    ds_read_b64_tr_b16 a[44:45], v215 offset:8192
    ds_read_b64_tr_b16 a[46:47], v215 offset:10240
    ds_read_b64_tr_b16 a[48:49], v212 offset:12288
    ds_read_b64_tr_b16 a[50:51], v212 offset:14336
    ds_read_b64_tr_b16 a[52:53], v213 offset:12288
    ds_read_b64_tr_b16 a[54:55], v213 offset:14336
    ds_read_b64_tr_b16 a[56:57], v214 offset:12288
    ds_read_b64_tr_b16 a[58:59], v214 offset:14336
    ds_read_b64_tr_b16 a[60:61], v215 offset:12288
    ds_read_b64_tr_b16 a[62:63], v215 offset:14336
    s_waitcnt lgkmcnt(0)
    s_waitcnt vmcnt(1)
    s_barrier
    s_cmp_lg_u32 s44, 1
    s_cbranch_scc1 nosig_4
    s_lshl_b32 s67, s2, 4
    s_add_u32 s67, s67, 294912
    v_lshl_add_u32 v6, v1, 12, s67
    v_mov_b32 v4, s46
    v_mov_b32 v5, s47
    s_mov_b64 exec, 0xff
    buffer_store_dwordx2 v[4:5], v6, s[32:35], 0 offen sc1
    s_mov_b64 exec, -1
nosig_4:
    ds_read_b128 v[112:115], v234 offset:192
    ds_read_b128 v[116:119], v234 offset:704
    ds_read_b128 v[120:123], v234 offset:1216
    ds_read_b128 v[124:127], v234 offset:1728
    ds_read_b128 v[128:131], v234 offset:128
    s_waitcnt lgkmcnt(4)
    v_mfma_f32_16x16x32_bf16 v[16:19], v[48:51], v[112:115], 0
    ds_read_b128 v[132:135], v234 offset:640
    ds_read_b128 v[136:139], v234 offset:1152
    v_mfma_f32_16x16x32_bf16 v[20:23], v[52:55], v[112:115], 0
    ds_read_b128 v[140:143], v234 offset:1664
    ds_read_b128 v[144:147], v234 offset:64
    s_waitcnt lgkmcnt(7)
    v_mfma_f32_16x16x32_bf16 v[20:23], v[48:51], v[116:119], v[20:23]
    ds_read_b128 v[148:151], v234 offset:576
    ds_read_b128 v[152:155], v234 offset:1088
    v_mfma_f32_16x16x32_bf16 v[24:27], v[52:55], v[116:119], 0
    ds_read_b128 v[156:159], v234 offset:1600
    ds_read_b128 v[160:163], v234 offset:0
    v_mfma_f32_16x16x32_bf16 v[24:27], v[56:59], v[112:115], v[24:27]
    ds_read_b128 v[164:167], v234 offset:512
    ds_read_b128 v[168:171], v234 offset:1024
    s_waitcnt lgkmcnt(12)
    v_mfma_f32_16x16x32_bf16 v[24:27], v[48:51], v[120:123], v[24:27]
    ds_read_b128 v[172:175], v234 offset:1536
    ds_read_b64 v[8:9], v238 offset:0
    v_mfma_f32_16x16x32_bf16 v[28:31], v[56:59], v[116:119], 0
    ds_read_b64 v[10:11], v238 offset:512
    ds_read_b64 v[176:177], v233 offset:1728
    v_mfma_f32_16x16x32_bf16 v[28:31], v[52:55], v[120:123], v[28:31]
    ds_read_b64 v[178:179], v233 offset:1736
    ds_read_b64 v[180:181], v233 offset:1216
    v_mfma_f32_16x16x32_bf16 v[28:31], v[60:63], v[112:115], v[28:31]
    ds_read_b64 v[182:183], v233 offset:1224
    ds_read_b64 v[184:185], v233 offset:704
    s_waitcnt lgkmcnt(15)
    v_mfma_f32_16x16x32_bf16 v[28:31], v[48:51], v[124:127], v[28:31]
    ds_read_b64 v[186:187], v233 offset:712
    ds_read_b64 v[188:189], v233 offset:192
    v_mfma_f32_16x16x32_bf16 v[16:19], v[64:67], v[128:131], v[16:19]
    ds_read_b64 v[190:191], v233 offset:200
    v_lshlrev_b32 v208, 16, v204
    v_mfma_f32_16x16x32_bf16 v[20:23], v[68:71], v[128:131], v[20:23]
    v_and_b32 v209, 0xffff0000, v204
    v_lshlrev_b32 v210, 16, v205
    v_mfma_f32_16x16x32_bf16 v[20:23], v[64:67], v[132:135], v[20:23]
    v_and_b32 v211, 0xffff0000, v205
    v_lshlrev_b32 v212, 16, v206
    v_mfma_f32_16x16x32_bf16 v[24:27], v[68:71], v[132:135], v[24:27]
    v_and_b32 v213, 0xffff0000, v206
    v_lshlrev_b32 v214, 16, v207
    v_mfma_f32_16x16x32_bf16 v[24:27], v[72:75], v[128:131], v[24:27]
    v_and_b32 v215, 0xffff0000, v207
    s_waitcnt lgkmcnt(8)
    v_mfma_f32_16x16x32_bf16 v[24:27], v[64:67], v[136:139], v[24:27]
    v_lshlrev_b32 v12, 16, v8
    v_and_b32 v13, 0xffff0000, v8
    v_mfma_f32_16x16x32_bf16 v[28:31], v[72:75], v[132:135], v[28:31]
    v_fmac_f32 v208, s40, v12
    v_fmac_f32 v209, s40, v13
    v_mfma_f32_16x16x32_bf16 v[28:31], v[68:71], v[136:139], v[28:31]
    v_lshlrev_b32 v12, 16, v9
    v_and_b32 v13, 0xffff0000, v9
    v_mfma_f32_16x16x32_bf16 v[28:31], v[76:79], v[128:131], v[28:31]
    v_fmac_f32 v210, s40, v12
    v_fmac_f32 v211, s40, v13
    v_mfma_f32_16x16x32_bf16 v[28:31], v[64:67], v[140:143], v[28:31]
    v_lshlrev_b32 v12, 16, v10
    v_and_b32 v13, 0xffff0000, v10
    v_mfma_f32_16x16x32_bf16 v[16:19], v[80:83], v[144:147], v[16:19]
    v_fmac_f32 v212, s40, v12
    v_fmac_f32 v213, s40, v13
    v_mfma_f32_16x16x32_bf16 v[20:23], v[84:87], v[144:147], v[20:23]
    v_lshlrev_b32 v12, 16, v11
    v_and_b32 v13, 0xffff0000, v11
    v_mfma_f32_16x16x32_bf16 v[20:23], v[80:83], v[148:151], v[20:23]
    v_fmac_f32 v214, s40, v12
    v_fmac_f32 v215, s40, v13
    v_mfma_f32_16x16x32_bf16 v[24:27], v[84:87], v[148:151], v[24:27]
    v_mfma_f32_16x16x32_bf16 v[24:27], v[88:91], v[144:147], v[24:27]
    v_mfma_f32_16x16x32_bf16 v[24:27], v[80:83], v[152:155], v[24:27]
    v_mfma_f32_16x16x32_bf16 v[28:31], v[88:91], v[148:151], v[28:31]
    v_mfma_f32_16x16x32_bf16 v[28:31], v[84:87], v[152:155], v[28:31]
    v_mfma_f32_16x16x32_bf16 v[28:31], v[92:95], v[144:147], v[28:31]
    v_mfma_f32_16x16x32_bf16 v[28:31], v[80:83], v[156:159], v[28:31]
    v_mfma_f32_16x16x32_bf16 v[16:19], v[96:99], v[160:163], v[16:19]
    v_mfma_f32_16x16x32_bf16 v[20:23], v[100:103], v[160:163], v[20:23]
    v_mfma_f32_16x16x32_bf16 v[20:23], v[96:99], v[164:167], v[20:23]
    v_mfma_f32_16x16x32_bf16 v[24:27], v[100:103], v[164:167], v[24:27]
    v_mfma_f32_16x16x32_bf16 v[24:27], v[104:107], v[160:163], v[24:27]
    v_mfma_f32_16x16x32_bf16 v[24:27], v[96:99], v[168:171], v[24:27]
    v_mfma_f32_16x16x32_bf16 v[28:31], v[104:107], v[164:167], v[28:31]
    v_mfma_f32_16x16x32_bf16 v[28:31], v[100:103], v[168:171], v[28:31]
    v_mfma_f32_16x16x32_bf16 v[28:31], v[108:111], v[160:163], v[28:31]
    v_mfma_f32_16x16x32_bf16 v[28:31], v[96:99], v[172:175], v[28:31]
    v_add_u32 v15, 114688, v231
    ds_read_b128 a[224:227], v15 offset:0
    ds_read_b128 a[228:231], v15 offset:4160
    ds_read_b128 a[232:235], v15 offset:8320
    ds_read_b128 a[236:239], v15 offset:12480
    ds_read_b128 a[240:243], v15 offset:16640
    ds_read_b128 a[244:247], v15 offset:20800
    ds_read_b128 a[248:251], v15 offset:24960
    ds_read_b128 a[252:255], v15 offset:29120
    v_add_u32 v14, s89, v232
    s_bitcmp1_b32 s44, 0
    s_cbranch_scc1 xodd_5
    s_nop 3
    ds_write_b128 v14, v[24:27] offset:0
    ds_write_b128 v14, v[28:31] offset:1024
    v_add_f32 v208, v208, v16
    v_add_f32 v209, v209, v17
    v_add_f32 v210, v210, v18
    v_add_f32 v211, v211, v19
    v_add_f32 v212, v212, v20
    v_add_f32 v213, v213, v21
    v_add_f32 v214, v214, v22
    v_add_f32 v215, v215, v23
    s_branch xdone_6
xodd_5:
    s_nop 3
    ds_write_b128 v14, v[16:19] offset:0
    ds_write_b128 v14, v[20:23] offset:1024
    v_add_f32 v208, v208, v24
    v_add_f32 v209, v209, v25
    v_add_f32 v210, v210, v26
    v_add_f32 v211, v211, v27
    v_add_f32 v212, v212, v28
    v_add_f32 v213, v213, v29
    v_add_f32 v214, v214, v30
    v_add_f32 v215, v215, v31
xdone_6:
    s_waitcnt lgkmcnt(0)
    s_barrier
    v_mfma_f32_16x16x32_bf16 v[32:35], v[52:55], v[124:127], 0
    v_add_u32 v14, s90, v232
    ds_read_b128 v[4:7], v14
    v_mfma_f32_16x16x32_bf16 v[32:35], v[56:59], v[120:123], v[32:35]
    ds_read_b128 v[8:11], v14 offset:1024
    s_mov_b32 s72, 3145728
    v_mfma_f32_16x16x32_bf16 v[36:39], v[56:59], v[124:127], 0
    v_mfma_f32_16x16x32_bf16 v[32:35], v[60:63], v[116:119], v[32:35]
    v_mfma_f32_16x16x32_bf16 v[36:39], v[60:63], v[120:123], v[36:39]
    ds_read_b64 v[192:193], v233 offset:1664
    v_mfma_f32_16x16x32_bf16 v[40:43], v[60:63], v[124:127], 0
    ds_read_b64 v[194:195], v233 offset:1672
    s_waitcnt lgkmcnt(2)
    v_add_f32 v208, v208, v4
    v_mfma_f32_16x16x32_bf16 v[32:35], v[176:179], v[112:115], v[32:35]
    ds_read_b64 v[196:197], v233 offset:1152
    v_add_f32 v209, v209, v5
    v_add_f32 v210, v210, v6
    v_mfma_f32_16x16x32_bf16 v[36:39], v[176:179], v[116:119], v[36:39]
    ds_read_b64 v[198:199], v233 offset:1160
    v_add_f32 v211, v211, v7
    v_add_f32 v212, v212, v8
    v_mfma_f32_16x16x32_bf16 v[40:43], v[176:179], v[120:123], v[40:43]
    ds_read_b64 v[200:201], v233 offset:640
    v_add_f32 v213, v213, v9
    v_add_f32 v214, v214, v10
    v_mfma_f32_16x16x32_bf16 v[44:47], v[176:179], v[124:127], 0
    ds_read_b64 v[202:203], v233 offset:648
    v_add_f32 v215, v215, v11
    v_cvt_pk_bf16_f32 v4, v208, v209
    v_mfma_f32_16x16x32_bf16 v[36:39], v[180:183], v[112:115], v[36:39]
    ds_read_b64 v[204:205], v233 offset:128
    buffer_load_dwordx2 v[12:13], v231, s[32:35], s64 offen sc1
    v_cvt_pk_bf16_f32 v5, v210, v211
    v_mfma_f32_16x16x32_bf16 v[40:43], v[180:183], v[116:119], v[40:43]
    ds_read_b64 v[206:207], v233 offset:136
    v_cvt_pk_bf16_f32 v6, v212, v213
    v_cvt_pk_bf16_f32 v7, v214, v215
    v_mfma_f32_16x16x32_bf16 v[44:47], v[180:183], v[120:123], v[44:47]
    v_mfma_f32_16x16x32_bf16 v[40:43], v[184:187], v[112:115], v[40:43]
    v_permlane16_swap_b32 v4, v6
    v_permlane16_swap_b32 v5, v7
    v_mfma_f32_16x16x32_bf16 v[44:47], v[184:187], v[116:119], v[44:47]
    buffer_store_dwordx4 v[4:7], v237, s[32:35], s72 offen sc1
    v_mfma_f32_16x16x32_bf16 v[44:47], v[188:191], v[112:115], v[44:47]
    v_mfma_f32_16x16x32_bf16 v[32:35], v[68:71], v[140:143], v[32:35]
    s_lshl_b32 s83, s52, 2
    s_add_u32 s83, s83, s44
    v_mfma_f32_16x16x32_bf16 v[32:35], v[72:75], v[136:139], v[32:35]
    s_lshl_b32 s81, s83, 5
    s_add_u32 s81, s81, s53
    v_mfma_f32_16x16x32_bf16 v[36:39], v[72:75], v[140:143], v[36:39]
    ds_read_b64 v[176:177], v233 offset:1600
    s_lshr_b32 s83, s83, 1
    v_mfma_f32_16x16x32_bf16 v[32:35], v[76:79], v[132:135], v[32:35]
    ds_read_b64 v[178:179], v233 offset:1608
    s_lshl_b32 s83, s83, 16
    v_mfma_f32_16x16x32_bf16 v[36:39], v[76:79], v[136:139], v[36:39]
    ds_read_b64 v[180:181], v233 offset:1088
    s_mov_b32 s68, 335872
    s_mov_b32 s69, 339968
    s_mov_b32 s70, 2097152
    s_mov_b32 s71, 2359296
    buffer_load_dwordx4 v[112:115], v231, s[32:35], s68 offen sc1
    buffer_load_dwordx4 v[116:119], v231, s[32:35], s69 offen sc1
    buffer_load_dwordx2 v[120:121], v235, s[32:35], s70 offen sc1
    buffer_load_dwordx2 v[122:123], v235, s[32:35], s70 offen offset:64 sc1
    buffer_load_dwordx2 v[216:217], v236, s[32:35], s70 offen sc1
    buffer_load_dwordx2 v[218:219], v236, s[32:35], s71 offen sc1
    v_mfma_f32_16x16x32_bf16 v[40:43], v[76:79], v[140:143], v[40:43]
    ds_read_b64 v[182:183], v233 offset:1096
    s_add_u32 s83, s83, 3145728
    s_waitcnt lgkmcnt(10)
    v_mfma_f32_16x16x32_bf16 v[32:35], v[192:195], v[128:131], v[32:35]
    ds_read_b64 v[184:185], v233 offset:576
    v_mfma_f32_16x16x32_bf16 v[36:39], v[192:195], v[132:135], v[36:39]
    ds_read_b64 v[186:187], v233 offset:584
    v_mfma_f32_16x16x32_bf16 v[40:43], v[192:195], v[136:139], v[40:43]
    ds_read_b64 v[188:189], v233 offset:64
    v_mfma_f32_16x16x32_bf16 v[44:47], v[192:195], v[140:143], v[44:47]
    ds_read_b64 v[190:191], v233 offset:72
    s_waitcnt lgkmcnt(12)
    v_mfma_f32_16x16x32_bf16 v[36:39], v[196:199], v[128:131], v[36:39]
    s_lshr_b32 s74, s53, 2
    s_and_b32 s74, s74, 6
    v_mfma_f32_16x16x32_bf16 v[40:43], v[196:199], v[132:135], v[40:43]
    s_lshl_b32 s82, s44, 1
    s_add_u32 s74, s74, s82
    v_mfma_f32_16x16x32_bf16 v[44:47], v[196:199], v[136:139], v[44:47]
    s_and_b32 s74, s74, 7
    s_lshl_b32 s82, s74, 12
    s_waitcnt lgkmcnt(10)
    v_mfma_f32_16x16x32_bf16 v[40:43], v[200:203], v[128:131], v[40:43]
    s_add_u32 s82, s82, s83
    s_add_u32 s74, s44, 0
    v_mfma_f32_16x16x32_bf16 v[44:47], v[200:203], v[132:135], v[44:47]
    s_and_b32 s74, s74, 3
    s_mul_i32 s74, s74, 28672
    s_waitcnt lgkmcnt(8)
    v_mfma_f32_16x16x32_bf16 v[44:47], v[204:207], v[128:131], v[44:47]
    v_add_u32 v221, s74, v232
    s_add_u32 s74, s44, 1
    v_mfma_f32_16x16x32_bf16 v[32:35], v[84:87], v[156:159], v[32:35]
    s_and_b32 s74, s74, 3
    s_mul_i32 s74, s74, 28672
    v_mfma_f32_16x16x32_bf16 v[32:35], v[88:91], v[152:155], v[32:35]
    v_add_u32 v222, s74, v232
    s_add_u32 s74, s44, 2
    v_mfma_f32_16x16x32_bf16 v[36:39], v[88:91], v[156:159], v[36:39]
    ds_read_b64 v[192:193], v233 offset:1536
    s_and_b32 s74, s74, 3
    v_mfma_f32_16x16x32_bf16 v[32:35], v[92:95], v[148:151], v[32:35]
    ds_read_b64 v[194:195], v233 offset:1544
    s_mul_i32 s74, s74, 28672
    v_mfma_f32_16x16x32_bf16 v[36:39], v[92:95], v[152:155], v[36:39]
    ds_read_b64 v[196:197], v233 offset:1024
    v_add_u32 v223, s74, v232
    v_mfma_f32_16x16x32_bf16 v[40:43], v[92:95], v[156:159], v[40:43]
    ds_read_b64 v[198:199], v233 offset:1032
    s_add_u32 s74, s44, 3
    s_waitcnt lgkmcnt(10)
    v_mfma_f32_16x16x32_bf16 v[32:35], v[176:179], v[144:147], v[32:35]
    ds_read_b64 v[200:201], v233 offset:512
    s_and_b32 s74, s74, 3
    v_mfma_f32_16x16x32_bf16 v[36:39], v[176:179], v[148:151], v[36:39]
    ds_read_b64 v[202:203], v233 offset:520
    s_mul_i32 s74, s74, 28672
    v_mfma_f32_16x16x32_bf16 v[40:43], v[176:179], v[152:155], v[40:43]
    ds_read_b64 v[204:205], v233 offset:0
    v_add_u32 v227, s74, v232
    v_mfma_f32_16x16x32_bf16 v[44:47], v[176:179], v[156:159], v[44:47]
    ds_read_b64 v[206:207], v233 offset:8
    s_bfe_u32 s74, s53, 65538
    s_waitcnt lgkmcnt(12)
    v_mfma_f32_16x16x32_bf16 v[36:39], v[180:183], v[144:147], v[36:39]
    s_lshl_b32 s75, s74, 5
    v_xor_b32 v226, s75, v240
    v_mfma_f32_16x16x32_bf16 v[40:43], v[180:183], v[148:151], v[40:43]
    s_lshr_b32 s75, s81, 5
    s_lshl_b32 s75, s75, 12
    v_mfma_f32_16x16x32_bf16 v[44:47], v[180:183], v[152:155], v[44:47]
    s_waitcnt vmcnt(7)
    v_cmp_ne_u64 s[86:87], s[46:47], v[12:13]
    s_nop 0
    s_cmp_eq_u64 s[86:87], 0
    s_cbranch_scc0 slow_7
ok_8:
    s_barrier
    s_mul_i32 s36, s53, 114688
    s_add_u32 s36, s36, 12582912
    s_lshr_b32 s37, s53, 2
    s_and_b32 s37, s37, 6
    s_lshl_b32 s37, s37, 1
    s_lshl_b32 s38, s44, 2
    s_add_u32 s37, s37, s38
    s_mul_i32 s38, s44, 28672
    s_and_b32 s56, s52, 0
    s_waitcnt lgkmcnt(10)
    v_mfma_f32_16x16x32_bf16 v[40:43], v[184:187], v[144:147], v[40:43]
    s_add_u32 s57, s56, 0
    s_and_b32 s57, s57, 3
    s_add_u32 s39, s37, s57
    s_and_b32 s39, s39, 15
    s_mul_i32 s39, s39, 7168
    s_add_u32 s39, s39, s36
    s_mul_i32 s57, s57, 7168
    s_add_u32 s57, s57, s38
    s_add_u32 m0, s57, 0
    s_nop 0
    buffer_load_dwordx4 v232, s[32:35], s39 offen offset:0 sc1 lds
    v_mfma_f32_16x16x32_bf16 v[44:47], v[184:187], v[148:151], v[44:47]
    v_and_b32 v224, 31, v1
    v_lshrrev_b32 v225, 5, v1
    s_waitcnt lgkmcnt(8)
    v_mfma_f32_16x16x32_bf16 v[44:47], v[188:191], v[144:147], v[44:47]
    s_add_u32 m0, s57, 0
    s_nop 0
    buffer_load_dwordx4 v232, s[32:35], s39 offen offset:1024 sc1 lds
    v_mfma_f32_16x16x32_bf16 v[32:35], v[100:103], v[172:175], v[32:35]
    v_lshlrev_b32 v225, 10, v225
    v_lshl_add_u32 v224, v224, 4, v225
    v_mfma_f32_16x16x32_bf16 v[32:35], v[104:107], v[168:171], v[32:35]
    s_add_u32 m0, s57, 0
    s_nop 0
    buffer_load_dwordx4 v232, s[32:35], s39 offen offset:2048 sc1 lds
    v_mfma_f32_16x16x32_bf16 v[36:39], v[104:107], v[172:175], v[36:39]
    v_add_u32 v224, s75, v224
    s_lshl_b32 s74, s74, 8
    v_mfma_f32_16x16x32_bf16 v[32:35], v[108:111], v[164:167], v[32:35]
    s_add_u32 m0, s57, 0
    s_nop 0
    buffer_load_dwordx4 v232, s[32:35], s39 offen offset:3072 sc1 lds
    v_mfma_f32_16x16x32_bf16 v[36:39], v[108:111], v[168:171], v[36:39]
    s_add_u32 s75, s75, s74
    s_lshr_b32 s74, s53, 2
    v_mfma_f32_16x16x32_bf16 v[40:43], v[108:111], v[172:175], v[40:43]
    s_and_b32 s74, s74, 6
    s_lshl_b32 s76, s44, 1
    s_waitcnt lgkmcnt(6)
    v_mfma_f32_16x16x32_bf16 v[32:35], v[192:195], v[160:163], v[32:35]
    s_add_u32 s39, s39, 4096
    s_add_u32 m0, s57, 4096
    s_nop 0
    buffer_load_dwordx4 v232, s[32:35], s39 offen offset:0 sc1 lds
    v_mfma_f32_16x16x32_bf16 v[36:39], v[192:195], v[164:167], v[36:39]
    s_add_u32 s74, s74, s76
    s_and_b32 s74, s74, 7
    v_mfma_f32_16x16x32_bf16 v[40:43], v[192:195], v[168:171], v[40:43]
    s_waitcnt vmcnt(11)
    s_barrier
    s_cmp_lg_u32 s44, 1
    s_cbranch_scc1 nosig_9
    s_lshl_b32 s67, s2, 4
    s_add_u32 s67, s67, 98304
    v_lshl_add_u32 v6, v1, 12, s67
    v_mov_b32 v4, s46
    v_mov_b32 v5, s47
    s_mov_b64 exec, 0xff
    buffer_store_dwordx2 v[4:5], v6, s[32:35], 0 offen sc1
    s_mov_b64 exec, -1
nosig_9:
    s_add_u32 m0, s57, 4096
    s_nop 0
    buffer_load_dwordx4 v232, s[32:35], s39 offen offset:1024 sc1 lds
    v_mfma_f32_16x16x32_bf16 v[44:47], v[192:195], v[172:175], v[44:47]
    s_lshl_b32 s74, s74, 8
    s_add_u32 s75, s75, s74
    s_waitcnt lgkmcnt(4)
    v_mfma_f32_16x16x32_bf16 v[36:39], v[196:199], v[160:163], v[36:39]
    s_add_u32 m0, s57, 4096
    s_nop 0
    buffer_load_dwordx4 v232, s[32:35], s39 offen offset:2048 sc1 lds
    v_mfma_f32_16x16x32_bf16 v[40:43], v[196:199], v[164:167], v[40:43]
    v_lshl_add_u32 v225, v2, 4, s75
    s_mov_b32 s62, 524288
    v_mfma_f32_16x16x32_bf16 v[44:47], v[196:199], v[168:171], v[44:47]
    s_add_u32 s57, s56, 1
    s_and_b32 s57, s57, 3
    s_add_u32 s39, s37, s57
    s_and_b32 s39, s39, 15
    s_mul_i32 s39, s39, 7168
    s_add_u32 s39, s39, s36
    s_mul_i32 s57, s57, 7168
    s_add_u32 s57, s57, s38
    s_add_u32 m0, s57, 0
    s_nop 0
    buffer_load_dwordx4 v232, s[32:35], s39 offen offset:0 sc1 lds
    s_waitcnt lgkmcnt(2)
    v_mfma_f32_16x16x32_bf16 v[40:43], v[200:203], v[160:163], v[40:43]
    v_mfma_f32_16x16x32_bf16 v[44:47], v[200:203], v[164:167], v[44:47]
    s_waitcnt lgkmcnt(0)
    v_mfma_f32_16x16x32_bf16 v[44:47], v[204:207], v[160:163], v[44:47]
    s_waitcnt vmcnt(10)
    v_mov_b32 v4, 0
    v_mov_b32 v5, 0x3727c5ac
    s_mov_b32 s72, 0x3b000000
    s_mov_b32 s73, 0x3b000000
    v_lshrrev_b32 v6, 1, v231
    v_add_u32 v6, 150496, v6
    v_pk_fma_f32 v[112:113], v[112:113], s[72:73], v[4:5]
    v_pk_fma_f32 v[114:115], v[114:115], s[72:73], v[4:5]
    v_pk_fma_f32 v[116:117], v[116:117], s[72:73], v[4:5]
    v_pk_fma_f32 v[118:119], v[118:119], s[72:73], v[4:5]
    v_fma_f32 v113, -v112, v112, v113
    v_fma_f32 v115, -v114, v114, v115
    v_fma_f32 v117, -v116, v116, v117
    v_fma_f32 v119, -v118, v118, v119
    v_max_f32 v113, v5, v113
    v_max_f32 v115, v5, v115
    v_max_f32 v117, v5, v117
    v_max_f32 v119, v5, v119
    v_rsq_f32 v128, v113
    v_lshlrev_b32 v136, 16, v120
    v_and_b32 v137, 0xffff0000, v120
    v_rsq_f32 v129, v115
    v_lshlrev_b32 v138, 16, v121
    v_and_b32 v139, 0xffff0000, v121
    v_rsq_f32 v130, v117
    v_lshlrev_b32 v140, 16, v122
    v_and_b32 v141, 0xffff0000, v122
    v_rsq_f32 v131, v119
    v_lshlrev_b32 v142, 16, v123
    v_and_b32 v143, 0xffff0000, v123
    v_mul_f32 v132, -v112, v128
    v_mul_f32 v133, -v114, v129
    v_mul_f32 v134, -v116, v130
    v_mul_f32 v135, -v118, v131
    v_pk_fma_f32 v[136:137], v[136:137], v[128:129], v[132:133]
    v_pk_fma_f32 v[138:139], v[138:139], v[130:131], v[134:135]
    v_cvt_pk_bf16_f32 v144, v136, v137
    v_cvt_pk_bf16_f32 v145, v138, v139
    ds_write_b64 v6, v[144:145] offset:0
    v_pk_fma_f32 v[140:141], v[140:141], v[128:129], v[132:133]
    v_pk_fma_f32 v[142:143], v[142:143], v[130:131], v[134:135]
    v_cvt_pk_bf16_f32 v146, v140, v141
    v_cvt_pk_bf16_f32 v147, v142, v143
    ds_write_b64 v6, v[146:147] offset:4608
    s_waitcnt lgkmcnt(0)
    s_barrier
    s_add_u32 m0, s57, 0
    s_nop 0
    buffer_load_dwordx4 v232, s[32:35], s39 offen offset:1024 sc1 lds
    s_add_u32 m0, s57, 0
    s_nop 0
    buffer_load_dwordx4 v232, s[32:35], s39 offen offset:2048 sc1 lds
    ds_read_b128 v[112:115], v234 offset:2240
    ds_read_b128 v[116:119], v234 offset:2752
    ds_read_b128 v[120:123], v234 offset:3264
    ds_read_b128 v[124:127], v234 offset:3776
    s_add_u32 s73, s80, 98304
    s_waitcnt lgkmcnt(3)
    v_mfma_f32_16x16x32_bf16 v[32:35], v[48:51], v[112:115], v[32:35]
    s_add_u32 m0, s57, 0
    s_nop 0
    buffer_load_dwordx4 v232, s[32:35], s39 offen offset:3072 sc1 lds
    v_mfma_f32_16x16x32_bf16 v[36:39], v[52:55], v[112:115], v[36:39]
    s_add_u32 s39, s39, 4096
    s_add_u32 m0, s57, 4096
    s_nop 0
    buffer_load_dwordx4 v232, s[32:35], s39 offen offset:0 sc1 lds
    v_mfma_f32_16x16x32_bf16 v[40:43], v[56:59], v[112:115], v[40:43]
    ds_read_b128 v[128:131], v234 offset:2176
    ds_read_b128 v[132:135], v234 offset:2688
    v_mfma_f32_16x16x32_bf16 v[44:47], v[60:63], v[112:115], v[44:47]
    s_add_u32 m0, s57, 4096
    s_nop 0
    buffer_load_dwordx4 v232, s[32:35], s39 offen offset:1024 sc1 lds
    s_waitcnt lgkmcnt(4)
    v_mfma_f32_16x16x32_bf16 v[36:39], v[48:51], v[116:119], v[36:39]
    ds_read_b128 v[136:139], v234 offset:3200
    ds_read_b128 v[140:143], v234 offset:3712
    v_mfma_f32_16x16x32_bf16 v[40:43], v[52:55], v[116:119], v[40:43]
    s_add_u32 m0, s57, 4096
    s_nop 0
    buffer_load_dwordx4 v232, s[32:35], s39 offen offset:2048 sc1 lds
    v_mfma_f32_16x16x32_bf16 v[44:47], v[56:59], v[116:119], v[44:47]
    ds_read_b128 v[144:147], v234 offset:2112
    ds_read_b128 v[148:151], v234 offset:2624
    s_waitcnt lgkmcnt(7)
    v_mfma_f32_16x16x32_bf16 v[40:43], v[48:51], v[120:123], v[40:43]
    s_add_u32 s57, s56, 2
    s_and_b32 s57, s57, 3
    s_add_u32 s39, s37, s57
    s_and_b32 s39, s39, 15
    s_mul_i32 s39, s39, 7168
    s_add_u32 s39, s39, s36
    s_mul_i32 s57, s57, 7168
    s_add_u32 s57, s57, s38
    s_add_u32 m0, s57, 0
    s_nop 0
    buffer_load_dwordx4 v232, s[32:35], s39 offen offset:0 sc1 lds
    v_mfma_f32_16x16x32_bf16 v[44:47], v[52:55], v[120:123], v[44:47]
    ds_read_b128 v[152:155], v234 offset:3136
    ds_read_b128 v[156:159], v234 offset:3648
    s_waitcnt lgkmcnt(8)
    v_mfma_f32_16x16x32_bf16 v[44:47], v[48:51], v[124:127], v[44:47]
    s_add_u32 m0, s57, 0
    s_nop 0
    buffer_load_dwordx4 v232, s[32:35], s39 offen offset:1024 sc1 lds
    s_waitcnt lgkmcnt(7)
    v_mfma_f32_16x16x32_bf16 v[32:35], v[64:67], v[128:131], v[32:35]
    ds_read_b128 v[160:163], v234 offset:2048
    ds_read_b128 v[164:167], v234 offset:2560
    v_mfma_f32_16x16x32_bf16 v[36:39], v[68:71], v[128:131], v[36:39]
    s_add_u32 m0, s57, 0
    s_nop 0
    buffer_load_dwordx4 v232, s[32:35], s39 offen offset:2048 sc1 lds
    v_mfma_f32_16x16x32_bf16 v[40:43], v[72:75], v[128:131], v[40:43]
    ds_read_b128 v[168:171], v234 offset:3072
    ds_read_b128 v[172:175], v234 offset:3584
    v_mfma_f32_16x16x32_bf16 v[44:47], v[76:79], v[128:131], v[44:47]
    s_add_u32 m0, s57, 0
    s_nop 0
    buffer_load_dwordx4 v232, s[32:35], s39 offen offset:3072 sc1 lds
    s_waitcnt lgkmcnt(10)
    v_mfma_f32_16x16x32_bf16 v[36:39], v[64:67], v[132:135], v[36:39]
    s_add_u32 s39, s39, 4096
    s_add_u32 m0, s57, 4096
    s_nop 0
    buffer_load_dwordx4 v232, s[32:35], s39 offen offset:0 sc1 lds
    v_mfma_f32_16x16x32_bf16 v[40:43], v[68:71], v[132:135], v[40:43]
    ds_read_b64 v[8:9], v238 offset:2048
    ds_read_b64 v[10:11], v238 offset:2560
    v_mfma_f32_16x16x32_bf16 v[44:47], v[72:75], v[132:135], v[44:47]
    s_add_u32 m0, s57, 4096
    s_nop 0
    buffer_load_dwordx4 v232, s[32:35], s39 offen offset:1024 sc1 lds
    s_waitcnt lgkmcnt(11)
    v_mfma_f32_16x16x32_bf16 v[40:43], v[64:67], v[136:139], v[40:43]
    s_waitcnt vmcnt(20)
    v_lshlrev_b32 v208, 16, v216
    v_mfma_f32_16x16x32_bf16 v[44:47], v[68:71], v[136:139], v[44:47]
    s_add_u32 m0, s57, 4096
    s_nop 0
    buffer_load_dwordx4 v232, s[32:35], s39 offen offset:2048 sc1 lds
    s_waitcnt lgkmcnt(10)
    v_mfma_f32_16x16x32_bf16 v[44:47], v[64:67], v[140:143], v[44:47]
    v_and_b32 v209, 0xffff0000, v216
    v_lshlrev_b32 v210, 16, v217
    s_waitcnt lgkmcnt(9)
    v_mfma_f32_16x16x32_bf16 v[32:35], v[80:83], v[144:147], v[32:35]
    buffer_load_dwordx2 v[14:15], v231, s[32:35], s73 offen sc1
    s_add_u32 s57, s56, 3
    s_and_b32 s57, s57, 3
    s_add_u32 s39, s37, s57
    s_and_b32 s39, s39, 15
    s_mul_i32 s39, s39, 7168
    s_add_u32 s39, s39, s36
    s_mul_i32 s57, s57, 7168
    s_add_u32 s57, s57, s38
    s_add_u32 m0, s57, 0
    s_nop 0
    buffer_load_dwordx4 v232, s[32:35], s39 offen offset:0 sc1 lds
    v_mfma_f32_16x16x32_bf16 v[36:39], v[84:87], v[144:147], v[36:39]
    v_and_b32 v211, 0xffff0000, v217
    v_lshlrev_b32 v212, 16, v218
    v_mfma_f32_16x16x32_bf16 v[40:43], v[88:91], v[144:147], v[40:43]
    s_add_u32 m0, s57, 0
    s_nop 0
    buffer_load_dwordx4 v232, s[32:35], s39 offen offset:1024 sc1 lds
    v_mfma_f32_16x16x32_bf16 v[44:47], v[92:95], v[144:147], v[44:47]
    v_and_b32 v213, 0xffff0000, v218
    v_lshlrev_b32 v214, 16, v219
    s_waitcnt lgkmcnt(8)
    v_mfma_f32_16x16x32_bf16 v[36:39], v[80:83], v[148:151], v[36:39]
    s_add_u32 m0, s57, 0
    s_nop 0
    buffer_load_dwordx4 v232, s[32:35], s39 offen offset:2048 sc1 lds
    v_mfma_f32_16x16x32_bf16 v[40:43], v[84:87], v[148:151], v[40:43]
    v_and_b32 v215, 0xffff0000, v219
    s_waitcnt lgkmcnt(0)
    v_mfma_f32_16x16x32_bf16 v[44:47], v[88:91], v[148:151], v[44:47]
    s_add_u32 m0, s57, 0
    s_nop 0
    buffer_load_dwordx4 v232, s[32:35], s39 offen offset:3072 sc1 lds
    v_mfma_f32_16x16x32_bf16 v[40:43], v[80:83], v[152:155], v[40:43]
    s_add_u32 s39, s39, 4096
    s_add_u32 m0, s57, 4096
    s_nop 0
    buffer_load_dwordx4 v232, s[32:35], s39 offen offset:0 sc1 lds
    v_mfma_f32_16x16x32_bf16 v[44:47], v[84:87], v[152:155], v[44:47]
    v_lshlrev_b32 v12, 16, v8
    v_and_b32 v13, 0xffff0000, v8
    v_mfma_f32_16x16x32_bf16 v[44:47], v[80:83], v[156:159], v[44:47]
    s_add_u32 m0, s57, 4096
    s_nop 0
    buffer_load_dwordx4 v232, s[32:35], s39 offen offset:1024 sc1 lds
    v_mfma_f32_16x16x32_bf16 v[32:35], v[96:99], v[160:163], v[32:35]
    v_fmac_f32 v208, s40, v12
    v_fmac_f32 v209, s40, v13
    v_mfma_f32_16x16x32_bf16 v[36:39], v[100:103], v[160:163], v[36:39]
    s_add_u32 m0, s57, 4096
    s_nop 0
    buffer_load_dwordx4 v232, s[32:35], s39 offen offset:2048 sc1 lds
    v_mfma_f32_16x16x32_bf16 v[40:43], v[104:107], v[160:163], v[40:43]
    v_lshlrev_b32 v12, 16, v9
    v_and_b32 v13, 0xffff0000, v9
    v_mfma_f32_16x16x32_bf16 v[44:47], v[108:111], v[160:163], v[44:47]
    s_add_u32 s85, s85, 16384
    buffer_load_dwordx4 a[64:67], v232, s[32:35], s85 offen offset:0 sc1
    v_mfma_f32_16x16x32_bf16 v[36:39], v[96:99], v[164:167], v[36:39]
    v_fmac_f32 v210, s40, v12
    v_fmac_f32 v211, s40, v13
    v_mfma_f32_16x16x32_bf16 v[40:43], v[100:103], v[164:167], v[40:43]
    buffer_load_dwordx4 a[68:71], v232, s[32:35], s85 offen offset:1024 sc1
    v_mfma_f32_16x16x32_bf16 v[44:47], v[104:107], v[164:167], v[44:47]
    v_lshlrev_b32 v12, 16, v10
    v_and_b32 v13, 0xffff0000, v10
    v_mfma_f32_16x16x32_bf16 v[40:43], v[96:99], v[168:171], v[40:43]
    buffer_load_dwordx4 a[72:75], v232, s[32:35], s85 offen offset:2048 sc1
    v_mfma_f32_16x16x32_bf16 v[44:47], v[100:103], v[168:171], v[44:47]
    v_fmac_f32 v212, s40, v12
    v_fmac_f32 v213, s40, v13
    v_mfma_f32_16x16x32_bf16 v[44:47], v[96:99], v[172:175], v[44:47]
    v_lshlrev_b32 v12, 16, v11
    v_and_b32 v13, 0xffff0000, v11
    v_fmac_f32 v214, s40, v12
    v_fmac_f32 v215, s40, v13
    v_mov_b32 v200, 0x3f803f80
    v_mov_b32 v201, 0x3f803f80
    v_mov_b32 v202, 0x3f803f80
    v_mov_b32 v203, 0x3f803f80
    s_waitcnt vmcnt(10)
    v_cmp_ne_u64 s[86:87], s[46:47], v[14:15]
    s_nop 0
    s_cmp_eq_u64 s[86:87], 0
    s_cbranch_scc0 slow_10
ok_11:
    s_add_u32 s89, s91, 24576
    s_xor_b32 s90, s89, 2048
    v_add_u32 v14, s89, v232
    s_bitcmp1_b32 s44, 0
    s_cbranch_scc1 xodd_12
    s_nop 3
    ds_write_b128 v14, v[40:43] offset:0
    ds_write_b128 v14, v[44:47] offset:1024
    v_add_f32 v208, v208, v32
    v_add_f32 v209, v209, v33
    v_add_f32 v210, v210, v34
    v_add_f32 v211, v211, v35
    v_add_f32 v212, v212, v36
    v_add_f32 v213, v213, v37
    v_add_f32 v214, v214, v38
    v_add_f32 v215, v215, v39
    s_branch xdone_13
xodd_12:
    s_nop 3
    ds_write_b128 v14, v[32:35] offset:0
    ds_write_b128 v14, v[36:39] offset:1024
    v_add_f32 v208, v208, v40
    v_add_f32 v209, v209, v41
    v_add_f32 v210, v210, v42
    v_add_f32 v211, v211, v43
    v_add_f32 v212, v212, v44
    v_add_f32 v213, v213, v45
    v_add_f32 v214, v214, v46
    v_add_f32 v215, v215, v47
xdone_13:
    s_waitcnt lgkmcnt(0)
    s_barrier
    v_add_u32 v14, s90, v232
    ds_read_b128 v[4:7], v14
    ds_read_b128 v[8:11], v14 offset:1024
    s_mov_b32 s72, 4194304
    s_add_u32 m0, s91, 0
    s_nop 0
    buffer_load_dwordx4 v239, s[32:35], s82 offen sc1 lds
    buffer_load_dwordx4 v239, s[32:35], s82 offen offset:1024 sc1 lds
    s_add_u32 s82, s82, 2048
    s_bitset0_b32 s82, 15
    s_add_u32 m0, s91, 8192
    s_nop 0
    buffer_load_dwordx4 v239, s[32:35], s82 offen sc1 lds
    buffer_load_dwordx4 v239, s[32:35], s82 offen offset:1024 sc1 lds
    s_add_u32 s82, s82, 2048
    s_bitset0_b32 s82, 15
    s_waitcnt lgkmcnt(0)
    s_add_u32 m0, s91, 16384
    v_add_f32 v208, v208, v4
    buffer_load_dwordx4 v239, s[32:35], s82 offen sc1 lds
    v_add_f32 v209, v209, v5
    buffer_load_dwordx4 v239, s[32:35], s82 offen offset:1024 sc1 lds
    v_add_f32 v210, v210, v6
    s_add_u32 s82, s82, 2048
    v_add_f32 v211, v211, v7
    s_bitset0_b32 s82, 15
    v_add_f32 v212, v212, v8
    s_add_u32 m0, s91, 32768
    v_add_f32 v213, v213, v9
    buffer_load_dwordx4 v239, s[32:35], s82 offen sc1 lds
    v_add_f32 v214, v214, v10
    buffer_load_dwordx4 v239, s[32:35], s82 offen offset:1024 sc1 lds
    v_add_f32 v215, v215, v11
    s_add_u32 s82, s82, 2048
    v_cvt_pk_bf16_f32 v4, v208, v209
    s_bitset0_b32 s82, 15
    v_cvt_pk_bf16_f32 v5, v210, v211
    v_cvt_pk_bf16_f32 v6, v212, v213
    v_cvt_pk_bf16_f32 v7, v214, v215
    s_nop 0
    v_permlane16_swap_b32 v4, v6
    v_permlane16_swap_b32 v5, v7
    buffer_store_dwordx4 v[4:7], v237, s[32:35], s72 offen sc1
    s_waitcnt vmcnt(12)
    s_barrier
    s_add_u32 m0, s91, 24576
    s_nop 0
    buffer_load_dwordx4 v239, s[32:35], s82 offen sc1 lds
    buffer_load_dwordx4 v239, s[32:35], s82 offen offset:1024 sc1 lds
    s_add_u32 s82, s82, 2048
    s_bitset0_b32 s82, 15
    s_add_u32 m0, s91, 40960
    s_nop 0
    buffer_load_dwordx4 v239, s[32:35], s82 offen sc1 lds
    buffer_load_dwordx4 v239, s[32:35], s82 offen offset:1024 sc1 lds
    s_add_u32 s82, s82, 2048
    s_bitset0_b32 s82, 15
    ds_read_b128 v[160:163], v221 offset:0
    ds_read_b128 v[164:167], v221 offset:1024
    ds_read_b128 v[168:171], v221 offset:2048
    ds_read_b128 v[172:175], v221 offset:3072
    ds_read_b128 v[176:179], v221 offset:4096
    ds_read_b128 v[180:183], v221 offset:5120
    ds_read_b128 v[184:187], v221 offset:6144
    s_add_u32 s73, s80, 131072
    s_waitcnt vmcnt(11)
    ds_read_b64_tr_b16 v[144:145], v240 offset:0
    ds_read_b64_tr_b16 v[146:147], v240 offset:1024
    ds_read_b64_tr_b16 v[148:149], v241 offset:0
    ds_read_b64_tr_b16 v[150:151], v241 offset:1024
    ds_read_b64_tr_b16 v[188:189], v226 offset:0
    ds_read_b64_tr_b16 v[190:191], v226 offset:1024
    s_waitcnt lgkmcnt(2)
    v_mfma_f32_16x16x32_bf16 v[16:19], v[160:163], v[144:147], 0
    s_waitcnt lgkmcnt(0)
    v_mfma_f32_16x16x32_bf16 v[192:195], v[188:191], v[188:191], 0
    v_mfma_f32_16x16x32_bf16 v[196:199], v[200:203], v[188:191], 0
    s_add_u32 m0, s91, 0
    v_mfma_f32_16x16x32_bf16 v[20:23], v[160:163], v[148:151], 0
    v_mfma_f32_16x16x32_bf16 v[96:99], v[200:203], v[160:163], 0
    buffer_load_dwordx4 v239, s[32:35], s82 offen sc1 lds
    v_mfma_f32_16x16x32_bf16 v[24:27], v[164:167], v[144:147], 0
    ds_read_b128 v[160:163], v221 offset:7168
    v_mfma_f32_16x16x32_bf16 v[28:31], v[164:167], v[148:151], 0
    v_mfma_f32_16x16x32_bf16 v[100:103], v[200:203], v[164:167], 0
    s_waitcnt vmcnt(10)
    ds_read_b64_tr_b16 v[152:153], v240 offset:8192
    v_mfma_f32_16x16x32_bf16 v[32:35], v[168:171], v[144:147], 0
    ds_read_b128 v[164:167], v221 offset:8192
    ds_read_b64_tr_b16 v[188:189], v226 offset:8192
    v_mfma_f32_16x16x32_bf16 v[36:39], v[168:171], v[148:151], 0
    v_mfma_f32_16x16x32_bf16 v[104:107], v[200:203], v[168:171], 0
    ds_read_b64_tr_b16 v[154:155], v240 offset:9216
    buffer_load_dwordx4 a[76:79], v232, s[32:35], s85 offen offset:3072 sc1
    s_add_u32 s85, s85, 4096
    buffer_load_dwordx4 a[80:83], v232, s[32:35], s85 offen offset:0 sc1
    v_mfma_f32_16x16x32_bf16 v[40:43], v[172:175], v[144:147], 0
    ds_read_b128 v[168:171], v221 offset:9216
    ds_read_b64_tr_b16 v[190:191], v226 offset:9216
    v_mfma_f32_16x16x32_bf16 v[44:47], v[172:175], v[148:151], 0
    v_mfma_f32_16x16x32_bf16 v[108:111], v[200:203], v[172:175], 0
    ds_read_b64_tr_b16 v[156:157], v241 offset:8192
    v_mfma_f32_16x16x32_bf16 v[48:51], v[176:179], v[144:147], 0
    ds_read_b128 v[172:175], v221 offset:10240
    v_mfma_f32_16x16x32_bf16 v[52:55], v[176:179], v[148:151], 0
    v_mfma_f32_16x16x32_bf16 v[112:115], v[200:203], v[176:179], 0
    ds_read_b64_tr_b16 v[158:159], v241 offset:9216
    v_mfma_f32_16x16x32_bf16 v[56:59], v[180:183], v[144:147], 0
    ds_read_b128 v[176:179], v221 offset:11264
    v_mfma_f32_16x16x32_bf16 v[60:63], v[180:183], v[148:151], 0
    v_mfma_f32_16x16x32_bf16 v[116:119], v[200:203], v[180:183], 0
    buffer_load_dwordx4 v239, s[32:35], s82 offen offset:1024 sc1 lds
    v_mfma_f32_16x16x32_bf16 v[64:67], v[184:187], v[144:147], 0
    ds_read_b128 v[180:183], v221 offset:12288
    s_add_u32 s82, s82, 2048
    v_mfma_f32_16x16x32_bf16 v[68:71], v[184:187], v[148:151], 0
    v_mfma_f32_16x16x32_bf16 v[120:123], v[200:203], v[184:187], 0
    s_bitset0_b32 s82, 15
    s_waitcnt lgkmcnt(2)
    v_mfma_f32_16x16x32_bf16 v[16:19], v[160:163], v[152:155], v[16:19]
    v_mfma_f32_16x16x32_bf16 v[192:195], v[188:191], v[188:191], v[192:195]
    v_mfma_f32_16x16x32_bf16 v[196:199], v[200:203], v[188:191], v[196:199]
    ds_read_b128 v[184:187], v221 offset:13312
    s_add_u32 m0, s91, 8192
    v_mfma_f32_16x16x32_bf16 v[20:23], v[160:163], v[156:159], v[20:23]
    v_mfma_f32_16x16x32_bf16 v[96:99], v[200:203], v[160:163], v[96:99]
    buffer_load_dwordx4 v239, s[32:35], s82 offen sc1 lds
    v_mfma_f32_16x16x32_bf16 v[24:27], v[164:167], v[152:155], v[24:27]
    ds_read_b128 v[160:163], v221 offset:14336
    v_mfma_f32_16x16x32_bf16 v[28:31], v[164:167], v[156:159], v[28:31]
    v_mfma_f32_16x16x32_bf16 v[100:103], v[200:203], v[164:167], v[100:103]
    s_waitcnt vmcnt(12)
    ds_read_b64_tr_b16 v[144:145], v240 offset:16384
    v_mfma_f32_16x16x32_bf16 v[32:35], v[168:171], v[152:155], v[32:35]
    ds_read_b128 v[164:167], v221 offset:15360
    ds_read_b64_tr_b16 v[188:189], v226 offset:16384
    v_mfma_f32_16x16x32_bf16 v[36:39], v[168:171], v[156:159], v[36:39]
    v_mfma_f32_16x16x32_bf16 v[104:107], v[200:203], v[168:171], v[104:107]
    ds_read_b64_tr_b16 v[146:147], v240 offset:17408
    buffer_load_dwordx4 a[84:87], v232, s[32:35], s85 offen offset:1024 sc1
    buffer_load_dwordx4 a[88:91], v232, s[32:35], s85 offen offset:2048 sc1
    v_mfma_f32_16x16x32_bf16 v[40:43], v[172:175], v[152:155], v[40:43]
    ds_read_b128 v[168:171], v221 offset:16384
    ds_read_b64_tr_b16 v[190:191], v226 offset:17408
    v_mfma_f32_16x16x32_bf16 v[44:47], v[172:175], v[156:159], v[44:47]
    v_mfma_f32_16x16x32_bf16 v[108:111], v[200:203], v[172:175], v[108:111]
    ds_read_b64_tr_b16 v[148:149], v241 offset:16384
    s_waitcnt lgkmcnt(8)
    v_mfma_f32_16x16x32_bf16 v[48:51], v[176:179], v[152:155], v[48:51]
    ds_read_b128 v[172:175], v221 offset:17408
    v_mfma_f32_16x16x32_bf16 v[52:55], v[176:179], v[156:159], v[52:55]
    v_mfma_f32_16x16x32_bf16 v[112:115], v[200:203], v[176:179], v[112:115]
    ds_read_b64_tr_b16 v[150:151], v241 offset:17408
    v_mfma_f32_16x16x32_bf16 v[56:59], v[180:183], v[152:155], v[56:59]
    ds_read_b128 v[176:179], v221 offset:18432
    v_mfma_f32_16x16x32_bf16 v[60:63], v[180:183], v[156:159], v[60:63]
    v_mfma_f32_16x16x32_bf16 v[116:119], v[200:203], v[180:183], v[116:119]
    buffer_load_dwordx4 v239, s[32:35], s82 offen offset:1024 sc1 lds
    v_mfma_f32_16x16x32_bf16 v[64:67], v[184:187], v[152:155], v[64:67]
    ds_read_b128 v[180:183], v221 offset:19456
    s_add_u32 s82, s82, 2048
    v_mfma_f32_16x16x32_bf16 v[68:71], v[184:187], v[156:159], v[68:71]
    v_mfma_f32_16x16x32_bf16 v[120:123], v[200:203], v[184:187], v[120:123]
    s_bitset0_b32 s82, 15
    s_waitcnt lgkmcnt(2)
    v_mfma_f32_16x16x32_bf16 v[16:19], v[160:163], v[144:147], v[16:19]
    v_mfma_f32_16x16x32_bf16 v[192:195], v[188:191], v[188:191], v[192:195]
    v_mfma_f32_16x16x32_bf16 v[196:199], v[200:203], v[188:191], v[196:199]
    ds_read_b128 v[184:187], v221 offset:20480
    s_add_u32 m0, s91, 16384
    v_mfma_f32_16x16x32_bf16 v[20:23], v[160:163], v[148:151], v[20:23]
    v_mfma_f32_16x16x32_bf16 v[96:99], v[200:203], v[160:163], v[96:99]
    buffer_load_dwordx4 v239, s[32:35], s82 offen sc1 lds
    v_mfma_f32_16x16x32_bf16 v[24:27], v[164:167], v[144:147], v[24:27]
    ds_read_b128 v[160:163], v221 offset:21504
    v_mfma_f32_16x16x32_bf16 v[28:31], v[164:167], v[148:151], v[28:31]
    v_mfma_f32_16x16x32_bf16 v[100:103], v[200:203], v[164:167], v[100:103]
    s_waitcnt vmcnt(14)
    ds_read_b64_tr_b16 v[152:153], v240 offset:32768
    v_mfma_f32_16x16x32_bf16 v[32:35], v[168:171], v[144:147], v[32:35]
    ds_read_b128 v[164:167], v221 offset:22528
    ds_read_b64_tr_b16 v[188:189], v226 offset:32768
    s_waitcnt vmcnt(13)
    s_barrier
    s_cmp_lg_u32 s44, 1
    s_cbranch_scc1 nosig_14
    s_lshl_b32 s67, s2, 4
    s_add_u32 s67, s67, 131072
    v_lshl_add_u32 v14, v1, 12, s67
    v_mov_b32 v12, s46
    v_mov_b32 v13, s47
    s_mov_b64 exec, 0xff
    buffer_store_dwordx2 v[12:13], v14, s[32:35], 0 offen sc1
    s_mov_b64 exec, -1
nosig_14:
    v_mfma_f32_16x16x32_bf16 v[36:39], v[168:171], v[148:151], v[36:39]
    v_mfma_f32_16x16x32_bf16 v[104:107], v[200:203], v[168:171], v[104:107]
    ds_read_b64_tr_b16 v[154:155], v240 offset:33792
    buffer_load_dwordx4 a[92:95], v232, s[32:35], s85 offen offset:3072 sc1
    s_add_u32 s85, s85, 4096
    buffer_load_dwordx4 a[96:99], v232, s[32:35], s85 offen offset:0 sc1
    v_mfma_f32_16x16x32_bf16 v[40:43], v[172:175], v[144:147], v[40:43]
    ds_read_b128 v[168:171], v221 offset:23552
    ds_read_b64_tr_b16 v[190:191], v226 offset:33792
    v_mfma_f32_16x16x32_bf16 v[44:47], v[172:175], v[148:151], v[44:47]
    v_mfma_f32_16x16x32_bf16 v[108:111], v[200:203], v[172:175], v[108:111]
    ds_read_b64_tr_b16 v[156:157], v241 offset:32768
    s_waitcnt lgkmcnt(8)
    v_mfma_f32_16x16x32_bf16 v[48:51], v[176:179], v[144:147], v[48:51]
    ds_read_b128 v[172:175], v221 offset:24576
    v_mfma_f32_16x16x32_bf16 v[52:55], v[176:179], v[148:151], v[52:55]
    v_mfma_f32_16x16x32_bf16 v[112:115], v[200:203], v[176:179], v[112:115]
    ds_read_b64_tr_b16 v[158:159], v241 offset:33792
    v_mfma_f32_16x16x32_bf16 v[56:59], v[180:183], v[144:147], v[56:59]
    ds_read_b128 v[176:179], v221 offset:25600
    v_mfma_f32_16x16x32_bf16 v[60:63], v[180:183], v[148:151], v[60:63]
    v_mfma_f32_16x16x32_bf16 v[116:119], v[200:203], v[180:183], v[116:119]
    buffer_load_dwordx4 v239, s[32:35], s82 offen offset:1024 sc1 lds
    v_mfma_f32_16x16x32_bf16 v[64:67], v[184:187], v[144:147], v[64:67]
    ds_read_b128 v[180:183], v221 offset:26624
    s_add_u32 s82, s82, 2048
    v_mfma_f32_16x16x32_bf16 v[68:71], v[184:187], v[148:151], v[68:71]
    v_mfma_f32_16x16x32_bf16 v[120:123], v[200:203], v[184:187], v[120:123]
    s_bitset0_b32 s82, 15
    s_waitcnt lgkmcnt(2)
    v_mfma_f32_16x16x32_bf16 v[16:19], v[160:163], v[152:155], v[16:19]
    v_mfma_f32_16x16x32_bf16 v[192:195], v[188:191], v[188:191], v[192:195]
    v_mfma_f32_16x16x32_bf16 v[196:199], v[200:203], v[188:191], v[196:199]
    ds_read_b128 v[184:187], v221 offset:27648
    s_add_u32 m0, s91, 32768
    v_mfma_f32_16x16x32_bf16 v[20:23], v[160:163], v[156:159], v[20:23]
    v_mfma_f32_16x16x32_bf16 v[96:99], v[200:203], v[160:163], v[96:99]
    buffer_load_dwordx4 v239, s[32:35], s82 offen sc1 lds
    v_mfma_f32_16x16x32_bf16 v[24:27], v[164:167], v[152:155], v[24:27]
    ds_read_b128 v[160:163], v222 offset:0
    v_mfma_f32_16x16x32_bf16 v[28:31], v[164:167], v[156:159], v[28:31]
    v_mfma_f32_16x16x32_bf16 v[100:103], v[200:203], v[164:167], v[100:103]
    s_waitcnt vmcnt(15)
    ds_read_b64_tr_b16 v[144:145], v240 offset:24576
    v_mfma_f32_16x16x32_bf16 v[32:35], v[168:171], v[152:155], v[32:35]
    ds_read_b128 v[164:167], v222 offset:1024
    v_mfma_f32_16x16x32_bf16 v[36:39], v[168:171], v[156:159], v[36:39]
    v_mfma_f32_16x16x32_bf16 v[104:107], v[200:203], v[168:171], v[104:107]
    ds_read_b64_tr_b16 v[146:147], v240 offset:25600
    buffer_load_dwordx4 a[100:103], v232, s[32:35], s85 offen offset:1024 sc1
    buffer_load_dwordx4 a[104:107], v232, s[32:35], s85 offen offset:2048 sc1
    v_mfma_f32_16x16x32_bf16 v[40:43], v[172:175], v[152:155], v[40:43]
    ds_read_b128 v[168:171], v222 offset:2048
    v_mfma_f32_16x16x32_bf16 v[44:47], v[172:175], v[156:159], v[44:47]
    v_mfma_f32_16x16x32_bf16 v[108:111], v[200:203], v[172:175], v[108:111]
    ds_read_b64_tr_b16 v[148:149], v241 offset:24576
    s_waitcnt lgkmcnt(6)
    v_mfma_f32_16x16x32_bf16 v[48:51], v[176:179], v[152:155], v[48:51]
    ds_read_b128 v[172:175], v222 offset:3072
    s_mov_b32 s42, 0x22222222
    v_mfma_f32_16x16x32_bf16 v[52:55], v[176:179], v[156:159], v[52:55]
    v_mfma_f32_16x16x32_bf16 v[112:115], v[200:203], v[176:179], v[112:115]
    ds_read_b64_tr_b16 v[150:151], v241 offset:25600
    s_mov_b32 s43, 0x22222222
    v_mfma_f32_16x16x32_bf16 v[56:59], v[180:183], v[152:155], v[56:59]
    ds_read_b128 v[176:179], v222 offset:4096
    v_cndmask_b32 v192, v192, v193, s[42:43]
    v_mfma_f32_16x16x32_bf16 v[60:63], v[180:183], v[156:159], v[60:63]
    v_mfma_f32_16x16x32_bf16 v[116:119], v[200:203], v[180:183], v[116:119]
    buffer_load_dwordx4 v239, s[32:35], s82 offen offset:1024 sc1 lds
    s_mov_b32 s42, 0x44444444
    v_mfma_f32_16x16x32_bf16 v[64:67], v[184:187], v[152:155], v[64:67]
    ds_read_b128 v[180:183], v222 offset:5120
    s_add_u32 s82, s82, 2048
    v_mfma_f32_16x16x32_bf16 v[68:71], v[184:187], v[156:159], v[68:71]
    v_mfma_f32_16x16x32_bf16 v[120:123], v[200:203], v[184:187], v[120:123]
    s_bitset0_b32 s82, 15
    s_waitcnt lgkmcnt(2)
    v_mfma_f32_16x16x32_bf16 v[16:19], v[160:163], v[144:147], v[16:19]
    ds_read_b128 v[184:187], v222 offset:6144
    s_add_u32 m0, s91, 24576
    v_mfma_f32_16x16x32_bf16 v[20:23], v[160:163], v[148:151], v[20:23]
    buffer_load_dwordx4 v239, s[32:35], s82 offen sc1 lds
    s_mov_b32 s43, 0x44444444
    v_mfma_f32_16x16x32_bf16 v[24:27], v[164:167], v[144:147], v[24:27]
    ds_read_b128 v[160:163], v222 offset:7168
    v_cndmask_b32 v192, v192, v194, s[42:43]
    v_mfma_f32_16x16x32_bf16 v[28:31], v[164:167], v[148:151], v[28:31]
    s_waitcnt vmcnt(17)
    ds_read_b64_tr_b16 v[152:153], v240 offset:40960
    v_mfma_f32_16x16x32_bf16 v[32:35], v[168:171], v[144:147], v[32:35]
    ds_read_b128 v[164:167], v222 offset:8192
    s_mov_b32 s42, 0x88888888
    v_mfma_f32_16x16x32_bf16 v[36:39], v[168:171], v[148:151], v[36:39]
    ds_read_b64_tr_b16 v[154:155], v240 offset:41984
    buffer_load_dwordx4 a[108:111], v232, s[32:35], s85 offen offset:3072 sc1
    s_sub_u32 s85, s85, s93
    s_add_u32 s85, s85, 4096
    buffer_load_dwordx4 a[112:115], v232, s[32:35], s85 offen offset:0 sc1
    v_mfma_f32_16x16x32_bf16 v[40:43], v[172:175], v[144:147], v[40:43]
    ds_read_b128 v[168:171], v222 offset:9216
    s_mov_b32 s43, 0x88888888
    v_mfma_f32_16x16x32_bf16 v[44:47], v[172:175], v[148:151], v[44:47]
    ds_read_b64_tr_b16 v[156:157], v241 offset:40960
    s_waitcnt lgkmcnt(6)
    v_mfma_f32_16x16x32_bf16 v[48:51], v[176:179], v[144:147], v[48:51]
    ds_read_b128 v[172:175], v222 offset:10240
    v_cndmask_b32 v198, v192, v195, s[42:43]
    v_mfma_f32_16x16x32_bf16 v[52:55], v[176:179], v[148:151], v[52:55]
    ds_read_b64_tr_b16 v[158:159], v241 offset:41984
    v_mov_b32 v199, s46
    v_mfma_f32_16x16x32_bf16 v[56:59], v[180:183], v[144:147], v[56:59]
    ds_read_b128 v[176:179], v222 offset:11264
    s_mov_b32 s41, 11534336
    v_mfma_f32_16x16x32_bf16 v[60:63], v[180:183], v[148:151], v[60:63]
    buffer_load_dwordx4 v239, s[32:35], s82 offen offset:1024 sc1 lds
    s_mov_b32 exec_lo, 0x00f0000f
    s_mov_b32 exec_hi, 0xf0000f00
    buffer_store_dwordx4 v[196:199], v225, s[32:35], s41 offen sc1
    s_mov_b64 exec, -1
    v_mfma_f32_16x16x32_bf16 v[64:67], v[184:187], v[144:147], v[64:67]
    ds_read_b128 v[180:183], v222 offset:12288
    s_add_u32 s82, s82, 2048
    v_mfma_f32_16x16x32_bf16 v[68:71], v[184:187], v[148:151], v[68:71]
    s_bitset0_b32 s82, 15
    s_waitcnt lgkmcnt(2)
    v_mfma_f32_16x16x32_bf16 v[16:19], v[160:163], v[152:155], v[16:19]
    ds_read_b128 v[184:187], v222 offset:13312
    s_add_u32 m0, s91, 40960
    v_mfma_f32_16x16x32_bf16 v[20:23], v[160:163], v[156:159], v[20:23]
    buffer_load_dwordx4 v239, s[32:35], s82 offen sc1 lds
    v_mfma_f32_16x16x32_bf16 v[24:27], v[164:167], v[152:155], v[24:27]
    ds_read_b128 v[160:163], v222 offset:14336
    v_mfma_f32_16x16x32_bf16 v[28:31], v[164:167], v[156:159], v[28:31]
    s_waitcnt vmcnt(18)
    ds_read_b64_tr_b16 v[144:145], v240 offset:0
    v_mfma_f32_16x16x32_bf16 v[32:35], v[168:171], v[152:155], v[32:35]
    ds_read_b128 v[164:167], v222 offset:15360
    v_mfma_f32_16x16x32_bf16 v[36:39], v[168:171], v[156:159], v[36:39]
    ds_read_b64_tr_b16 v[146:147], v240 offset:1024
    buffer_load_dwordx4 a[116:119], v232, s[32:35], s85 offen offset:1024 sc1
    buffer_load_dwordx4 a[120:123], v232, s[32:35], s85 offen offset:2048 sc1
    v_mfma_f32_16x16x32_bf16 v[40:43], v[172:175], v[152:155], v[40:43]
    ds_read_b128 v[168:171], v222 offset:16384
    v_mfma_f32_16x16x32_bf16 v[44:47], v[172:175], v[156:159], v[44:47]
    ds_read_b64_tr_b16 v[148:149], v241 offset:0
    s_waitcnt lgkmcnt(6)
    v_mfma_f32_16x16x32_bf16 v[48:51], v[176:179], v[152:155], v[48:51]
    ds_read_b128 v[172:175], v222 offset:17408
    v_mfma_f32_16x16x32_bf16 v[52:55], v[176:179], v[156:159], v[52:55]
    ds_read_b64_tr_b16 v[150:151], v241 offset:1024
    v_mfma_f32_16x16x32_bf16 v[56:59], v[180:183], v[152:155], v[56:59]
    ds_read_b128 v[176:179], v222 offset:18432
    v_mfma_f32_16x16x32_bf16 v[60:63], v[180:183], v[156:159], v[60:63]
    buffer_load_dwordx4 v239, s[32:35], s82 offen offset:1024 sc1 lds
    v_mfma_f32_16x16x32_bf16 v[64:67], v[184:187], v[152:155], v[64:67]
    ds_read_b128 v[180:183], v222 offset:19456
    s_add_u32 s82, s82, 2048
    v_mfma_f32_16x16x32_bf16 v[68:71], v[184:187], v[156:159], v[68:71]
    s_bitset0_b32 s82, 15
    s_waitcnt lgkmcnt(2)
    v_mfma_f32_16x16x32_bf16 v[16:19], v[160:163], v[144:147], v[16:19]
    ds_read_b128 v[184:187], v222 offset:20480
    s_add_u32 m0, s91, 0
    v_mfma_f32_16x16x32_bf16 v[20:23], v[160:163], v[148:151], v[20:23]
    buffer_load_dwordx4 v239, s[32:35], s82 offen sc1 lds
    v_mfma_f32_16x16x32_bf16 v[24:27], v[164:167], v[144:147], v[24:27]
    ds_read_b128 v[160:163], v222 offset:21504
    v_mfma_f32_16x16x32_bf16 v[28:31], v[164:167], v[148:151], v[28:31]
    s_waitcnt vmcnt(18)
    ds_read_b64_tr_b16 v[152:153], v240 offset:8192
    v_mfma_f32_16x16x32_bf16 v[32:35], v[168:171], v[144:147], v[32:35]
    ds_read_b128 v[164:167], v222 offset:22528
    v_mfma_f32_16x16x32_bf16 v[36:39], v[168:171], v[148:151], v[36:39]
    ds_read_b64_tr_b16 v[154:155], v240 offset:9216
    buffer_load_dwordx4 a[124:127], v232, s[32:35], s85 offen offset:3072 sc1
    s_add_u32 s85, s85, 4096
    buffer_load_dwordx4 a[128:131], v232, s[32:35], s85 offen offset:0 sc1
    v_mfma_f32_16x16x32_bf16 v[40:43], v[172:175], v[144:147], v[40:43]
    ds_read_b128 v[168:171], v222 offset:23552
    v_mfma_f32_16x16x32_bf16 v[44:47], v[172:175], v[148:151], v[44:47]
    ds_read_b64_tr_b16 v[156:157], v241 offset:8192
    s_waitcnt lgkmcnt(6)
    v_mfma_f32_16x16x32_bf16 v[48:51], v[176:179], v[144:147], v[48:51]
    ds_read_b128 v[172:175], v222 offset:24576
    v_mfma_f32_16x16x32_bf16 v[52:55], v[176:179], v[148:151], v[52:55]
    ds_read_b64_tr_b16 v[158:159], v241 offset:9216
    v_mfma_f32_16x16x32_bf16 v[56:59], v[180:183], v[144:147], v[56:59]
    ds_read_b128 v[176:179], v222 offset:25600
    v_mfma_f32_16x16x32_bf16 v[60:63], v[180:183], v[148:151], v[60:63]
    buffer_load_dwordx4 v239, s[32:35], s82 offen offset:1024 sc1 lds
    v_mfma_f32_16x16x32_bf16 v[64:67], v[184:187], v[144:147], v[64:67]
    ds_read_b128 v[180:183], v222 offset:26624
    s_add_u32 s82, s82, 2048
    v_mfma_f32_16x16x32_bf16 v[68:71], v[184:187], v[148:151], v[68:71]
    s_bitset0_b32 s82, 15
    s_waitcnt lgkmcnt(2)
    v_mfma_f32_16x16x32_bf16 v[16:19], v[160:163], v[152:155], v[16:19]
    ds_read_b128 v[184:187], v222 offset:27648
    s_add_u32 m0, s91, 8192
    v_mfma_f32_16x16x32_bf16 v[20:23], v[160:163], v[156:159], v[20:23]
    buffer_load_dwordx4 v239, s[32:35], s82 offen sc1 lds
    v_mfma_f32_16x16x32_bf16 v[24:27], v[164:167], v[152:155], v[24:27]
    ds_read_b128 v[160:163], v223 offset:0
    v_mfma_f32_16x16x32_bf16 v[28:31], v[164:167], v[156:159], v[28:31]
    s_waitcnt vmcnt(18)
    ds_read_b64_tr_b16 v[144:145], v240 offset:16384
    v_mfma_f32_16x16x32_bf16 v[32:35], v[168:171], v[152:155], v[32:35]
    ds_read_b128 v[164:167], v223 offset:1024
    v_mfma_f32_16x16x32_bf16 v[36:39], v[168:171], v[156:159], v[36:39]
    ds_read_b64_tr_b16 v[146:147], v240 offset:17408
    buffer_load_dwordx4 a[132:135], v232, s[32:35], s85 offen offset:1024 sc1
    buffer_load_dwordx4 a[136:139], v232, s[32:35], s85 offen offset:2048 sc1
    v_mfma_f32_16x16x32_bf16 v[40:43], v[172:175], v[152:155], v[40:43]
    ds_read_b128 v[168:171], v223 offset:2048
    v_mfma_f32_16x16x32_bf16 v[44:47], v[172:175], v[156:159], v[44:47]
    ds_read_b64_tr_b16 v[148:149], v241 offset:16384
    s_waitcnt lgkmcnt(6)
    v_mfma_f32_16x16x32_bf16 v[48:51], v[176:179], v[152:155], v[48:51]
    ds_read_b128 v[172:175], v223 offset:3072
    v_mfma_f32_16x16x32_bf16 v[52:55], v[176:179], v[156:159], v[52:55]
    ds_read_b64_tr_b16 v[150:151], v241 offset:17408
    v_mfma_f32_16x16x32_bf16 v[56:59], v[180:183], v[152:155], v[56:59]
    ds_read_b128 v[176:179], v223 offset:4096
    v_mfma_f32_16x16x32_bf16 v[60:63], v[180:183], v[156:159], v[60:63]
    buffer_load_dwordx4 v239, s[32:35], s82 offen offset:1024 sc1 lds
    v_mfma_f32_16x16x32_bf16 v[64:67], v[184:187], v[152:155], v[64:67]
    ds_read_b128 v[180:183], v223 offset:5120
    s_add_u32 s82, s82, 2048
    v_mfma_f32_16x16x32_bf16 v[68:71], v[184:187], v[156:159], v[68:71]
    s_bitset0_b32 s82, 15
    s_waitcnt lgkmcnt(2)
    v_mfma_f32_16x16x32_bf16 v[16:19], v[160:163], v[144:147], v[16:19]
    ds_read_b128 v[184:187], v223 offset:6144
    s_add_u32 m0, s91, 16384
    v_mfma_f32_16x16x32_bf16 v[20:23], v[160:163], v[148:151], v[20:23]
    buffer_load_dwordx4 v239, s[32:35], s82 offen sc1 lds
    v_mov_b32 v128, v96
    v_mfma_f32_16x16x32_bf16 v[24:27], v[164:167], v[144:147], v[24:27]
    ds_read_b128 v[160:163], v223 offset:7168
    v_mov_b32 v129, v100
    v_mfma_f32_16x16x32_bf16 v[28:31], v[164:167], v[148:151], v[28:31]
    s_waitcnt vmcnt(18)
    ds_read_b64_tr_b16 v[152:153], v240 offset:32768
    v_mfma_f32_16x16x32_bf16 v[32:35], v[168:171], v[144:147], v[32:35]
    ds_read_b128 v[164:167], v223 offset:8192
    v_mov_b32 v130, v104
    v_mfma_f32_16x16x32_bf16 v[36:39], v[168:171], v[148:151], v[36:39]
    ds_read_b64_tr_b16 v[154:155], v240 offset:33792
    buffer_load_dwordx4 a[140:143], v232, s[32:35], s85 offen offset:3072 sc1
    s_add_u32 s85, s85, 4096
    buffer_load_dwordx4 a[144:147], v232, s[32:35], s85 offen offset:0 sc1
    v_mfma_f32_16x16x32_bf16 v[40:43], v[172:175], v[144:147], v[40:43]
    ds_read_b128 v[168:171], v223 offset:9216
    v_mov_b32 v131, v108
    v_mfma_f32_16x16x32_bf16 v[44:47], v[172:175], v[148:151], v[44:47]
    ds_read_b64_tr_b16 v[156:157], v241 offset:32768
    s_waitcnt lgkmcnt(6)
    v_mfma_f32_16x16x32_bf16 v[48:51], v[176:179], v[144:147], v[48:51]
    ds_read_b128 v[172:175], v223 offset:10240
    v_mov_b32 v132, v112
    v_mfma_f32_16x16x32_bf16 v[52:55], v[176:179], v[148:151], v[52:55]
    ds_read_b64_tr_b16 v[158:159], v241 offset:33792
    v_mov_b32 v133, v116
    v_mfma_f32_16x16x32_bf16 v[56:59], v[180:183], v[144:147], v[56:59]
    ds_read_b128 v[176:179], v223 offset:11264
    v_mov_b32 v134, v120
    v_mfma_f32_16x16x32_bf16 v[60:63], v[180:183], v[148:151], v[60:63]
    buffer_load_dwordx4 v239, s[32:35], s82 offen offset:1024 sc1 lds
    v_lshlrev_b32 v136, 5, v1
    v_mfma_f32_16x16x32_bf16 v[64:67], v[184:187], v[144:147], v[64:67]
    ds_read_b128 v[180:183], v223 offset:12288
    s_add_u32 s82, s82, 2048
    buffer_load_dwordx2 v[14:15], v231, s[32:35], s73 offen sc1
    v_mfma_f32_16x16x32_bf16 v[68:71], v[184:187], v[148:151], v[68:71]
    s_bitset0_b32 s82, 15
    s_waitcnt lgkmcnt(2)
    v_mfma_f32_16x16x32_bf16 v[16:19], v[160:163], v[152:155], v[16:19]
    ds_read_b128 v[184:187], v223 offset:13312
    s_add_u32 m0, s91, 32768
    v_mfma_f32_16x16x32_bf16 v[20:23], v[160:163], v[156:159], v[20:23]
    buffer_load_dwordx4 v239, s[32:35], s82 offen sc1 lds
    v_add_u32 v137, s91, v136
    v_mfma_f32_16x16x32_bf16 v[24:27], v[164:167], v[152:155], v[24:27]
    ds_read_b128 v[160:163], v223 offset:14336
    v_add_u32 v136, 139264, v136
    v_mfma_f32_16x16x32_bf16 v[28:31], v[164:167], v[156:159], v[28:31]
    s_waitcnt vmcnt(19)
    ds_read_b64_tr_b16 v[144:145], v240 offset:24576
    v_mfma_f32_16x16x32_bf16 v[32:35], v[168:171], v[152:155], v[32:35]
    ds_read_b128 v[164:167], v223 offset:15360
    v_mfma_f32_16x16x32_bf16 v[36:39], v[168:171], v[156:159], v[36:39]
    ds_read_b64_tr_b16 v[146:147], v240 offset:25600
    buffer_load_dwordx4 a[148:151], v232, s[32:35], s85 offen offset:1024 sc1
    buffer_load_dwordx4 a[152:155], v232, s[32:35], s85 offen offset:2048 sc1
    v_mfma_f32_16x16x32_bf16 v[40:43], v[172:175], v[152:155], v[40:43]
    ds_read_b128 v[168:171], v223 offset:16384
    v_mfma_f32_16x16x32_bf16 v[44:47], v[172:175], v[156:159], v[44:47]
    ds_read_b64_tr_b16 v[148:149], v241 offset:24576
    s_waitcnt lgkmcnt(6)
    v_mfma_f32_16x16x32_bf16 v[48:51], v[176:179], v[152:155], v[48:51]
    ds_read_b128 v[172:175], v223 offset:17408
    v_mfma_f32_16x16x32_bf16 v[52:55], v[176:179], v[156:159], v[52:55]
    ds_read_b64_tr_b16 v[150:151], v241 offset:25600
    v_mfma_f32_16x16x32_bf16 v[56:59], v[180:183], v[152:155], v[56:59]
    ds_read_b128 v[176:179], v223 offset:18432
    v_mfma_f32_16x16x32_bf16 v[60:63], v[180:183], v[156:159], v[60:63]
    buffer_load_dwordx4 v239, s[32:35], s82 offen offset:1024 sc1 lds
    s_add_u32 s82, s82, 1048576
    v_mfma_f32_16x16x32_bf16 v[64:67], v[184:187], v[152:155], v[64:67]
    ds_read_b128 v[180:183], v223 offset:19456
    s_add_u32 s82, s82, 2048
    v_mfma_f32_16x16x32_bf16 v[68:71], v[184:187], v[156:159], v[68:71]
    s_bitset0_b32 s82, 15
    s_waitcnt lgkmcnt(2)
    v_mfma_f32_16x16x32_bf16 v[16:19], v[160:163], v[144:147], v[16:19]
    ds_read_b128 v[184:187], v223 offset:20480
    v_mfma_f32_16x16x32_bf16 v[20:23], v[160:163], v[148:151], v[20:23]
    ds_write_b128 v137, v[128:131] offset:24576
    v_mfma_f32_16x16x32_bf16 v[24:27], v[164:167], v[144:147], v[24:27]
    ds_read_b128 v[160:163], v223 offset:21504
    v_mfma_f32_16x16x32_bf16 v[28:31], v[164:167], v[148:151], v[28:31]
    s_waitcnt vmcnt(17)
    ds_read_b64_tr_b16 v[152:153], v240 offset:40960
    v_mfma_f32_16x16x32_bf16 v[32:35], v[168:171], v[144:147], v[32:35]
    ds_read_b128 v[164:167], v223 offset:22528
    v_mfma_f32_16x16x32_bf16 v[36:39], v[168:171], v[148:151], v[36:39]
    ds_read_b64_tr_b16 v[154:155], v240 offset:41984
    buffer_load_dwordx4 a[156:159], v232, s[32:35], s85 offen offset:3072 sc1
    s_add_u32 s85, s85, 4096
    buffer_load_dwordx4 a[160:163], v232, s[32:35], s85 offen offset:0 sc1
    v_mfma_f32_16x16x32_bf16 v[40:43], v[172:175], v[144:147], v[40:43]
    ds_read_b128 v[168:171], v223 offset:23552
    v_mfma_f32_16x16x32_bf16 v[44:47], v[172:175], v[148:151], v[44:47]
    ds_read_b64_tr_b16 v[156:157], v241 offset:40960
    s_waitcnt lgkmcnt(7)
    v_mfma_f32_16x16x32_bf16 v[48:51], v[176:179], v[144:147], v[48:51]
    ds_read_b128 v[172:175], v223 offset:24576
    v_mfma_f32_16x16x32_bf16 v[52:55], v[176:179], v[148:151], v[52:55]
    ds_read_b64_tr_b16 v[158:159], v241 offset:41984
    buffer_load_dwordx4 v[80:83], v224, s[32:35], s41 offen offset:0 sc1
    v_mfma_f32_16x16x32_bf16 v[56:59], v[180:183], v[144:147], v[56:59]
    ds_read_b128 v[176:179], v223 offset:25600
    v_mfma_f32_16x16x32_bf16 v[60:63], v[180:183], v[148:151], v[60:63]
    ds_write_b128 v137, v[132:135] offset:24592
    v_mfma_f32_16x16x32_bf16 v[64:67], v[184:187], v[144:147], v[64:67]
    ds_read_b128 v[180:183], v223 offset:26624
    v_mfma_f32_16x16x32_bf16 v[68:71], v[184:187], v[148:151], v[68:71]
    s_waitcnt lgkmcnt(1)
    s_barrier
    v_mfma_f32_16x16x32_bf16 v[16:19], v[160:163], v[152:155], v[16:19]
    ds_read_b128 v[96:99], v136 offset:0
    ds_read_b128 v[184:187], v223 offset:27648
    v_mfma_f32_16x16x32_bf16 v[20:23], v[160:163], v[156:159], v[20:23]
    ds_read_b128 v[100:103], v136 offset:16
    v_mfma_f32_16x16x32_bf16 v[24:27], v[164:167], v[152:155], v[24:27]
    ds_read_b128 v[104:107], v136 offset:2048
    ds_read_b128 v[160:163], v227 offset:0
    v_mfma_f32_16x16x32_bf16 v[28:31], v[164:167], v[156:159], v[28:31]
    ds_read_b128 v[108:111], v136 offset:2064
    buffer_load_dwordx4 v[84:87], v224, s[32:35], s41 offen offset:512 sc1
    s_waitcnt vmcnt(17)
    ds_read_b64_tr_b16 v[144:145], v240 offset:0
    v_mfma_f32_16x16x32_bf16 v[32:35], v[168:171], v[152:155], v[32:35]
    ds_read_b128 v[112:115], v136 offset:4096
    ds_read_b128 v[164:167], v227 offset:1024
    v_mfma_f32_16x16x32_bf16 v[36:39], v[168:171], v[156:159], v[36:39]
    ds_read_b128 v[116:119], v136 offset:4112
    ds_read_b64_tr_b16 v[146:147], v240 offset:1024
    buffer_load_dwordx4 a[164:167], v232, s[32:35], s85 offen offset:1024 sc1
    buffer_load_dwordx4 a[168:171], v232, s[32:35], s85 offen offset:2048 sc1
    v_mfma_f32_16x16x32_bf16 v[40:43], v[172:175], v[152:155], v[40:43]
    ds_read_b128 v[120:123], v136 offset:6144
    ds_read_b128 v[168:171], v227 offset:2048
    v_mfma_f32_16x16x32_bf16 v[44:47], v[172:175], v[156:159], v[44:47]
    ds_read_b128 v[124:127], v136 offset:6160
    ds_read_b64_tr_b16 v[148:149], v241 offset:0
    s_waitcnt lgkmcnt(13)
    v_mfma_f32_16x16x32_bf16 v[48:51], v[176:179], v[152:155], v[48:51]
    ds_read_b128 v[172:175], v227 offset:3072
    v_mfma_f32_16x16x32_bf16 v[52:55], v[176:179], v[156:159], v[52:55]
    ds_read_b64_tr_b16 v[150:151], v241 offset:1024
    v_mfma_f32_16x16x32_bf16 v[56:59], v[180:183], v[152:155], v[56:59]
    ds_read_b128 v[176:179], v227 offset:4096
    v_mfma_f32_16x16x32_bf16 v[60:63], v[180:183], v[156:159], v[60:63]
    v_mfma_f32_16x16x32_bf16 v[64:67], v[184:187], v[152:155], v[64:67]
    ds_read_b128 v[180:183], v227 offset:5120
    v_mfma_f32_16x16x32_bf16 v[68:71], v[184:187], v[156:159], v[68:71]
    s_waitcnt vmcnt(10)
    v_cmp_ne_u64 s[86:87], s[46:47], v[14:15]
    s_nop 0
    s_cmp_eq_u64 s[86:87], 0
    s_cbranch_scc0 slow_15
ok_16:
    s_waitcnt lgkmcnt(5)
    s_barrier
    s_waitcnt lgkmcnt(2)
    v_mfma_f32_16x16x32_bf16 v[16:19], v[160:163], v[144:147], v[16:19]
    ds_read_b128 v[184:187], v227 offset:6144
    s_add_u32 m0, s91, 24576
    v_add_f32 v96, v96, v104
    v_mfma_f32_16x16x32_bf16 v[20:23], v[160:163], v[148:151], v[20:23]
    buffer_load_dwordx4 v239, s[32:35], s82 offen sc1 lds
    v_add_f32 v112, v112, v120
    v_mfma_f32_16x16x32_bf16 v[24:27], v[164:167], v[144:147], v[24:27]
    ds_read_b128 v[160:163], v227 offset:7168
    buffer_load_dwordx4 v239, s[32:35], s82 offen offset:1024 sc1 lds
    v_add_f32 v97, v97, v105
    v_mfma_f32_16x16x32_bf16 v[28:31], v[164:167], v[148:151], v[28:31]
    ds_read_b64_tr_b16 v[152:153], v240 offset:8192
    v_mfma_f32_16x16x32_bf16 v[32:35], v[168:171], v[144:147], v[32:35]
    ds_read_b128 v[164:167], v227 offset:8192
    s_add_u32 s82, s82, 2048
    v_add_f32 v113, v113, v121
    v_mfma_f32_16x16x32_bf16 v[36:39], v[168:171], v[148:151], v[36:39]
    ds_read_b64_tr_b16 v[154:155], v240 offset:9216
    s_bitset0_b32 s82, 15
    v_add_f32 v98, v98, v106
    v_mfma_f32_16x16x32_bf16 v[40:43], v[172:175], v[144:147], v[40:43]
    ds_read_b128 v[168:171], v227 offset:9216
    s_add_u32 m0, s91, 40960
    v_add_f32 v114, v114, v122
    v_mfma_f32_16x16x32_bf16 v[44:47], v[172:175], v[148:151], v[44:47]
    ds_read_b64_tr_b16 v[156:157], v241 offset:8192
    s_waitcnt lgkmcnt(6)
    v_mfma_f32_16x16x32_bf16 v[48:51], v[176:179], v[144:147], v[48:51]
    ds_read_b128 v[172:175], v227 offset:10240
    buffer_load_dwordx4 v239, s[32:35], s82 offen sc1 lds
    v_add_f32 v99, v99, v107
    v_mfma_f32_16x16x32_bf16 v[52:55], v[176:179], v[148:151], v[52:55]
    ds_read_b64_tr_b16 v[158:159], v241 offset:9216
    v_add_f32 v115, v115, v123
    v_add_f32 v100, v100, v108
    v_mfma_f32_16x16x32_bf16 v[56:59], v[180:183], v[144:147], v[56:59]
    ds_read_b128 v[176:179], v227 offset:11264
    v_add_f32 v116, v116, v124
    v_add_f32 v101, v101, v109
    v_mfma_f32_16x16x32_bf16 v[60:63], v[180:183], v[148:151], v[60:63]
    buffer_load_dwordx4 v239, s[32:35], s82 offen offset:1024 sc1 lds
    v_add_f32 v117, v117, v125
    v_add_f32 v102, v102, v110
    v_mfma_f32_16x16x32_bf16 v[64:67], v[184:187], v[144:147], v[64:67]
    ds_read_b128 v[180:183], v227 offset:12288
    s_add_u32 s82, s82, 2048
    v_add_f32 v118, v118, v126
    v_mfma_f32_16x16x32_bf16 v[68:71], v[184:187], v[148:151], v[68:71]
    s_bitset0_b32 s82, 15
    s_waitcnt lgkmcnt(2)
    v_mfma_f32_16x16x32_bf16 v[16:19], v[160:163], v[152:155], v[16:19]
    ds_read_b128 v[184:187], v227 offset:13312
    s_add_u32 m0, s91, 0
    v_add_f32 v96, v96, v112
    v_mfma_f32_16x16x32_bf16 v[20:23], v[160:163], v[156:159], v[20:23]
    buffer_load_dwordx4 v239, s[32:35], s82 offen sc1 lds
    v_add_f32 v97, v97, v113
    v_mfma_f32_16x16x32_bf16 v[24:27], v[164:167], v[152:155], v[24:27]
    ds_read_b128 v[160:163], v227 offset:14336
    buffer_load_dwordx4 v239, s[32:35], s82 offen offset:1024 sc1 lds
    v_add_f32 v98, v98, v114
    v_mfma_f32_16x16x32_bf16 v[28:31], v[164:167], v[156:159], v[28:31]
    ds_read_b64_tr_b16 v[144:145], v240 offset:16384
    v_mfma_f32_16x16x32_bf16 v[32:35], v[168:171], v[152:155], v[32:35]
    ds_read_b128 v[164:167], v227 offset:15360
    s_add_u32 s82, s82, 2048
    v_add_f32 v99, v99, v115
    v_mfma_f32_16x16x32_bf16 v[36:39], v[168:171], v[156:159], v[36:39]
    ds_read_b64_tr_b16 v[146:147], v240 offset:17408
    s_bitset0_b32 s82, 15
    v_add_f32 v100, v100, v116
    v_mfma_f32_16x16x32_bf16 v[40:43], v[172:175], v[152:155], v[40:43]
    ds_read_b128 v[168:171], v227 offset:16384
    s_add_u32 m0, s91, 8192
    v_add_f32 v101, v101, v117
    v_mfma_f32_16x16x32_bf16 v[44:47], v[172:175], v[156:159], v[44:47]
    ds_read_b64_tr_b16 v[148:149], v241 offset:16384
    s_waitcnt lgkmcnt(6)
    v_mfma_f32_16x16x32_bf16 v[48:51], v[176:179], v[152:155], v[48:51]
    ds_read_b128 v[172:175], v227 offset:17408
    buffer_load_dwordx4 v239, s[32:35], s82 offen sc1 lds
    v_add_f32 v102, v102, v118
    v_mfma_f32_16x16x32_bf16 v[52:55], v[176:179], v[156:159], v[52:55]
    ds_read_b64_tr_b16 v[150:151], v241 offset:17408
    v_mov_b32 v103, 0
    s_mov_b32 s42, 0
    v_mfma_f32_16x16x32_bf16 v[56:59], v[180:183], v[152:155], v[56:59]
    ds_read_b128 v[176:179], v227 offset:18432
    s_mov_b32 s43, -1
    v_cndmask_b32 v104, v96, v97, s[42:43]
    v_mfma_f32_16x16x32_bf16 v[60:63], v[180:183], v[156:159], v[60:63]
    buffer_load_dwordx4 v239, s[32:35], s82 offen offset:1024 sc1 lds
    v_cvt_pk_bf16_f32 v248, v104, v104
    v_lshlrev_b32 v105, 16, v248
    v_mfma_f32_16x16x32_bf16 v[64:67], v[184:187], v[152:155], v[64:67]
    ds_read_b128 v[180:183], v227 offset:19456
    s_add_u32 s82, s82, 2048
    v_sub_f32 v104, v104, v105
    v_mfma_f32_16x16x32_bf16 v[68:71], v[184:187], v[156:159], v[68:71]
    s_bitset0_b32 s82, 15
    s_waitcnt lgkmcnt(2)
    v_mfma_f32_16x16x32_bf16 v[16:19], v[160:163], v[144:147], v[16:19]
    ds_read_b128 v[184:187], v227 offset:20480
    s_add_u32 m0, s91, 16384
    v_cvt_pk_bf16_f32 v249, v104, 0
    v_mfma_f32_16x16x32_bf16 v[20:23], v[160:163], v[148:151], v[20:23]
    buffer_load_dwordx4 v239, s[32:35], s82 offen sc1 lds
    v_cndmask_b32 v104, v98, v99, s[42:43]
    v_mfma_f32_16x16x32_bf16 v[24:27], v[164:167], v[144:147], v[24:27]
    ds_read_b128 v[160:163], v227 offset:21504
    v_cvt_pk_bf16_f32 v250, v104, v104
    v_lshlrev_b32 v105, 16, v250
    v_mfma_f32_16x16x32_bf16 v[28:31], v[164:167], v[148:151], v[28:31]
    s_waitcnt vmcnt(15)
    ds_read_b64_tr_b16 v[152:153], v240 offset:32768
    v_mfma_f32_16x16x32_bf16 v[32:35], v[168:171], v[144:147], v[32:35]
    ds_read_b128 v[164:167], v227 offset:22528
    v_sub_f32 v104, v104, v105
    v_cvt_pk_bf16_f32 v251, v104, 0
    v_mfma_f32_16x16x32_bf16 v[36:39], v[168:171], v[148:151], v[36:39]
    ds_read_b64_tr_b16 v[154:155], v240 offset:33792
    buffer_load_dwordx4 a[172:175], v232, s[32:35], s85 offen offset:3072 sc1
    s_add_u32 s85, s85, 4096
    buffer_load_dwordx4 a[176:179], v232, s[32:35], s85 offen offset:0 sc1
    v_cndmask_b32 v104, v100, v101, s[42:43]
    v_mfma_f32_16x16x32_bf16 v[40:43], v[172:175], v[144:147], v[40:43]
    ds_read_b128 v[168:171], v227 offset:23552
    v_cvt_pk_bf16_f32 v252, v104, v104
    v_lshlrev_b32 v105, 16, v252
    v_mfma_f32_16x16x32_bf16 v[44:47], v[172:175], v[148:151], v[44:47]
    ds_read_b64_tr_b16 v[156:157], v241 offset:32768
    s_waitcnt lgkmcnt(6)
    v_mfma_f32_16x16x32_bf16 v[48:51], v[176:179], v[144:147], v[48:51]
    ds_read_b128 v[172:175], v227 offset:24576
    v_sub_f32 v104, v104, v105
    v_cvt_pk_bf16_f32 v253, v104, 0
    v_mfma_f32_16x16x32_bf16 v[52:55], v[176:179], v[148:151], v[52:55]
    ds_read_b64_tr_b16 v[158:159], v241 offset:33792
    v_cndmask_b32 v104, v102, v103, s[42:43]
    v_cvt_pk_bf16_f32 v254, v104, v104
    v_mfma_f32_16x16x32_bf16 v[56:59], v[180:183], v[144:147], v[56:59]
    ds_read_b128 v[176:179], v227 offset:25600
    v_lshlrev_b32 v105, 16, v254
    v_sub_f32 v104, v104, v105
    v_mfma_f32_16x16x32_bf16 v[60:63], v[180:183], v[148:151], v[60:63]
    buffer_load_dwordx4 v239, s[32:35], s82 offen offset:1024 sc1 lds
    v_cvt_pk_bf16_f32 v255, v104, 0
    s_waitcnt vmcnt(14)
    v_mfma_f32_16x16x32_bf16 v[64:67], v[184:187], v[144:147], v[64:67]
    ds_read_b128 v[180:183], v227 offset:26624
    s_add_u32 s82, s82, 2048
    v_sad_u32 v8, v83, s46, 0
    v_mfma_f32_16x16x32_bf16 v[68:71], v[184:187], v[148:151], v[68:71]
    s_bitset0_b32 s82, 15
    s_waitcnt lgkmcnt(2)
    v_mfma_f32_16x16x32_bf16 v[16:19], v[160:163], v[152:155], v[16:19]
    ds_read_b128 v[184:187], v227 offset:27648
    s_add_u32 m0, s91, 32768
    v_add_f32 v80, v80, v84
    v_mfma_f32_16x16x32_bf16 v[20:23], v[160:163], v[156:159], v[20:23]
    buffer_load_dwordx4 v239, s[32:35], s82 offen sc1 lds
    v_sad_u32 v8, v87, s46, v8
    v_mfma_f32_16x16x32_bf16 v[24:27], v[164:167], v[152:155], v[24:27]
    ds_read_b128 v[160:163], v221 offset:0
    v_add_f32 v82, v82, v86
    v_cmp_ne_u32 s[86:87], 0, v8
    s_nop 0
    s_cmp_eq_u64 s[86:87], 0
    s_cbranch_scc0 gslow_17
gok_18:
    v_mfma_f32_16x16x32_bf16 v[28:31], v[164:167], v[156:159], v[28:31]
    s_waitcnt vmcnt(11)
    ds_read_b64_tr_b16 v[144:145], v240 offset:24576
    v_mfma_f32_16x16x32_bf16 v[32:35], v[168:171], v[152:155], v[32:35]
    ds_read_b128 v[164:167], v221 offset:1024
    ds_read_b64_tr_b16 v[188:189], v226 offset:24576
    v_mov_b32 v81, v80
    v_mfma_f32_16x16x32_bf16 v[36:39], v[168:171], v[156:159], v[36:39]
    ds_read_b64_tr_b16 v[146:147], v240 offset:25600
    buffer_load_dwordx4 a[180:183], v232, s[32:35], s85 offen offset:1024 sc1
    buffer_load_dwordx4 a[184:187], v232, s[32:35], s85 offen offset:2048 sc1
    v_mov_b32 v83, v82
    v_mfma_f32_16x16x32_bf16 v[40:43], v[172:175], v[152:155], v[40:43]
    ds_read_b128 v[168:171], v221 offset:2048
    ds_read_b64_tr_b16 v[190:191], v226 offset:25600
    v_mov_b32 v12, 0x3727c5ac
    v_mfma_f32_16x16x32_bf16 v[44:47], v[172:175], v[156:159], v[44:47]
    ds_read_b64_tr_b16 v[148:149], v241 offset:24576
    s_waitcnt lgkmcnt(8)
    v_mfma_f32_16x16x32_bf16 v[48:51], v[176:179], v[152:155], v[48:51]
    ds_read_b128 v[172:175], v221 offset:3072
    v_permlane32_swap_b32 v80, v81
    v_permlane32_swap_b32 v82, v83
    v_mfma_f32_16x16x32_bf16 v[52:55], v[176:179], v[156:159], v[52:55]
    ds_read_b64_tr_b16 v[150:151], v241 offset:25600
    v_add_f32 v80, v80, v81
    v_add_f32 v82, v82, v83
    v_mfma_f32_16x16x32_bf16 v[56:59], v[180:183], v[152:155], v[56:59]
    ds_read_b128 v[176:179], v221 offset:4096
    v_mul_f32 v80, 0xbb000000, v80
    v_fmac_f32 v12, 0x3b000000, v82
    v_mfma_f32_16x16x32_bf16 v[60:63], v[180:183], v[156:159], v[60:63]
    buffer_load_dwordx4 v239, s[32:35], s82 offen offset:1024 sc1 lds
    v_cvt_pk_bf16_f32 v11, v80, 0
    v_fma_f32 v12, -v80, v80, v12
    v_mfma_f32_16x16x32_bf16 v[64:67], v[184:187], v[152:155], v[64:67]
    ds_read_b128 v[180:183], v221 offset:5120
    s_add_u32 s82, s82, 2048
    v_lshlrev_b32 v81, 16, v11
    v_mfma_f32_16x16x32_bf16 v[68:71], v[184:187], v[156:159], v[68:71]
    s_bitset0_b32 s82, 15
    v_max_f32 v12, 0x3727c5ac, v12
    v_sub_f32 v81, v80, v81
    v_rcp_f32 v12, v12
    v_cvt_pk_bf16_f32 v10, v80, v81
    s_nop 1
    v_mfma_f32_16x16x4_4b_bf16 v[16:31], v[248:249], v[10:11], v[16:31]
    s_mul_i32 s71, s81, 3712
    s_add_u32 s71, s71, 20971520
    v_mfma_f32_16x16x4_4b_bf16 v[32:47], v[250:251], v[10:11], v[32:47]
    v_lshrrev_b32 v9, 1, v232
    v_lshrrev_b32 v13, 2, v232
    v_mfma_f32_16x16x4_4b_bf16 v[48:63], v[252:253], v[10:11], v[48:63]
    v_mfma_f32_16x16x4_4b_bf16 v[64:79], v[254:255], v[10:11], v[64:79]
    s_mov_b32 exec_hi, 0
    buffer_store_dword v12, v13, s[32:35], s71 offen offset:3584 sc1
    s_mov_b32 exec_hi, -1
    s_nop 1
    v_max_f32 v16, 0, v16
    v_max_f32 v17, 0, v17
    v_max_f32 v18, 0, v18
    v_max_f32 v19, 0, v19
    v_pk_mul_f32 v[16:17], v[16:17], v[24:25]
    v_pk_mul_f32 v[18:19], v[18:19], v[26:27]
    v_max_f32 v32, 0, v32
    v_max_f32 v33, 0, v33
    v_max_f32 v34, 0, v34
    v_max_f32 v35, 0, v35
    v_pk_mul_f32 v[32:33], v[32:33], v[40:41]
    v_pk_mul_f32 v[34:35], v[34:35], v[42:43]
    v_cvt_pk_bf16_f32 v24, v16, v17
    v_cvt_pk_bf16_f32 v25, v18, v19
    v_cvt_pk_bf16_f32 v26, v32, v33
    v_cvt_pk_bf16_f32 v27, v34, v35
    buffer_store_dwordx4 v[24:27], v232, s[32:35], s71 offen offset:0 sc1
    v_max_f32 v20, 0, v20
    v_max_f32 v21, 0, v21
    v_max_f32 v22, 0, v22
    v_max_f32 v23, 0, v23
    v_pk_mul_f32 v[20:21], v[20:21], v[28:29]
    v_pk_mul_f32 v[22:23], v[22:23], v[30:31]
    v_max_f32 v36, 0, v36
    v_max_f32 v37, 0, v37
    v_max_f32 v38, 0, v38
    v_max_f32 v39, 0, v39
    v_pk_mul_f32 v[36:37], v[36:37], v[44:45]
    v_pk_mul_f32 v[38:39], v[38:39], v[46:47]
    v_cvt_pk_bf16_f32 v28, v20, v21
    v_cvt_pk_bf16_f32 v29, v22, v23
    v_cvt_pk_bf16_f32 v30, v36, v37
    v_cvt_pk_bf16_f32 v31, v38, v39
    buffer_store_dwordx4 v[28:31], v232, s[32:35], s71 offen offset:1024 sc1
    v_max_f32 v48, 0, v48
    v_max_f32 v49, 0, v49
    v_max_f32 v50, 0, v50
    v_max_f32 v51, 0, v51
    v_pk_mul_f32 v[48:49], v[48:49], v[56:57]
    v_pk_mul_f32 v[50:51], v[50:51], v[58:59]
    v_max_f32 v52, 0, v52
    v_max_f32 v53, 0, v53
    v_max_f32 v54, 0, v54
    v_max_f32 v55, 0, v55
    v_pk_mul_f32 v[52:53], v[52:53], v[60:61]
    v_pk_mul_f32 v[54:55], v[54:55], v[62:63]
    v_cvt_pk_bf16_f32 v56, v48, v49
    v_cvt_pk_bf16_f32 v57, v50, v51
    v_cvt_pk_bf16_f32 v58, v52, v53
    v_cvt_pk_bf16_f32 v59, v54, v55
    v_permlane32_swap_b32 v64, v66
    v_permlane32_swap_b32 v65, v67
    v_permlane32_swap_b32 v68, v70
    v_permlane32_swap_b32 v69, v71
    v_max_f32 v64, 0, v64
    v_max_f32 v65, 0, v65
    v_pk_mul_f32 v[64:65], v[64:65], v[66:67]
    v_max_f32 v68, 0, v68
    v_max_f32 v69, 0, v69
    v_pk_mul_f32 v[68:69], v[68:69], v[70:71]
    v_cvt_pk_bf16_f32 v66, v64, v65
    v_cvt_pk_bf16_f32 v67, v68, v69
    s_waitcnt lgkmcnt(2)
    v_mfma_f32_16x16x32_bf16 v[80:83], v[160:163], v[144:147], 0
    v_mfma_f32_16x16x32_bf16 v[192:195], v[188:191], v[188:191], 0
    v_mfma_f32_16x16x32_bf16 v[196:199], v[200:203], v[188:191], 0
    ds_read_b128 v[184:187], v221 offset:6144
    s_add_u32 m0, s91, 24576
    v_mfma_f32_16x16x32_bf16 v[84:87], v[160:163], v[148:151], 0
    buffer_load_dwordx4 v239, s[32:35], s82 offen sc1 lds
    buffer_store_dwordx4 v[56:59], v232, s[32:35], s71 offen offset:2048 sc1
    v_mfma_f32_16x16x32_bf16 v[88:91], v[164:167], v[144:147], 0
    ds_read_b128 v[160:163], v221 offset:7168
    v_mfma_f32_16x16x32_bf16 v[92:95], v[164:167], v[148:151], 0
    s_waitcnt vmcnt(17)
    ds_read_b64_tr_b16 v[152:153], v240 offset:40960
    v_mfma_f32_16x16x32_bf16 v[96:99], v[168:171], v[144:147], 0
    ds_read_b128 v[164:167], v221 offset:8192
    ds_read_b64_tr_b16 v[188:189], v226 offset:40960
    v_mfma_f32_16x16x32_bf16 v[100:103], v[168:171], v[148:151], 0
    ds_read_b64_tr_b16 v[154:155], v240 offset:41984
    v_mfma_f32_16x16x32_bf16 v[104:107], v[172:175], v[144:147], 0
    ds_read_b128 v[168:171], v221 offset:9216
    ds_read_b64_tr_b16 v[190:191], v226 offset:41984
    v_mfma_f32_16x16x32_bf16 v[108:111], v[172:175], v[148:151], 0
    ds_read_b64_tr_b16 v[156:157], v241 offset:40960
    s_waitcnt lgkmcnt(8)
    v_mfma_f32_16x16x32_bf16 v[112:115], v[176:179], v[144:147], 0
    ds_read_b128 v[172:175], v221 offset:10240
    v_mfma_f32_16x16x32_bf16 v[116:119], v[176:179], v[148:151], 0
    ds_read_b64_tr_b16 v[158:159], v241 offset:41984
    buffer_store_dwordx2 v[66:67], v9, s[32:35], s71 offen offset:3072 sc1
    v_mfma_f32_16x16x32_bf16 v[120:123], v[180:183], v[144:147], 0
    ds_read_b128 v[176:179], v221 offset:11264
    v_mfma_f32_16x16x32_bf16 v[124:127], v[180:183], v[148:151], 0
    buffer_load_dwordx4 v239, s[32:35], s82 offen offset:1024 sc1 lds
    v_mfma_f32_16x16x32_bf16 v[128:131], v[184:187], v[144:147], 0
    ds_read_b128 v[180:183], v221 offset:12288
    s_add_u32 s82, s82, 2048
    v_mfma_f32_16x16x32_bf16 v[132:135], v[184:187], v[148:151], 0
    s_bitset0_b32 s82, 15
    s_waitcnt lgkmcnt(2)
    v_mfma_f32_16x16x32_bf16 v[80:83], v[160:163], v[152:155], v[80:83]
    v_mfma_f32_16x16x32_bf16 v[192:195], v[188:191], v[188:191], v[192:195]
    v_mfma_f32_16x16x32_bf16 v[196:199], v[200:203], v[188:191], v[196:199]
    ds_read_b128 v[184:187], v221 offset:13312
    s_add_u32 m0, s91, 40960
    v_mfma_f32_16x16x32_bf16 v[84:87], v[160:163], v[156:159], v[84:87]
    buffer_load_dwordx4 v239, s[32:35], s82 offen sc1 lds
    v_mfma_f32_16x16x32_bf16 v[88:91], v[164:167], v[152:155], v[88:91]
    ds_read_b128 v[160:163], v221 offset:14336
    v_mfma_f32_16x16x32_bf16 v[92:95], v[164:167], v[156:159], v[92:95]
    s_waitcnt vmcnt(18)
    ds_read_b64_tr_b16 v[144:145], v240 offset:0
    v_mfma_f32_16x16x32_bf16 v[96:99], v[168:171], v[152:155], v[96:99]
    ds_read_b128 v[164:167], v221 offset:15360
    ds_read_b64_tr_b16 v[188:189], v226 offset:0
    v_mfma_f32_16x16x32_bf16 v[100:103], v[168:171], v[156:159], v[100:103]
    ds_read_b64_tr_b16 v[146:147], v240 offset:1024
    buffer_load_dwordx4 a[188:191], v232, s[32:35], s85 offen offset:3072 sc1
    s_add_u32 s85, s85, 4096
    buffer_load_dwordx4 a[192:195], v232, s[32:35], s85 offen offset:0 sc1
    v_mfma_f32_16x16x32_bf16 v[104:107], v[172:175], v[152:155], v[104:107]
    ds_read_b128 v[168:171], v221 offset:16384
    ds_read_b64_tr_b16 v[190:191], v226 offset:1024
    v_mfma_f32_16x16x32_bf16 v[108:111], v[172:175], v[156:159], v[108:111]
    ds_read_b64_tr_b16 v[148:149], v241 offset:0
    s_waitcnt lgkmcnt(8)
    v_mfma_f32_16x16x32_bf16 v[112:115], v[176:179], v[152:155], v[112:115]
    ds_read_b128 v[172:175], v221 offset:17408
    v_mfma_f32_16x16x32_bf16 v[116:119], v[176:179], v[156:159], v[116:119]
    ds_read_b64_tr_b16 v[150:151], v241 offset:1024
    v_mfma_f32_16x16x32_bf16 v[120:123], v[180:183], v[152:155], v[120:123]
    ds_read_b128 v[176:179], v221 offset:18432
    v_mfma_f32_16x16x32_bf16 v[124:127], v[180:183], v[156:159], v[124:127]
    buffer_load_dwordx4 v239, s[32:35], s82 offen offset:1024 sc1 lds
    v_mfma_f32_16x16x32_bf16 v[128:131], v[184:187], v[152:155], v[128:131]
    ds_read_b128 v[180:183], v221 offset:19456
    s_add_u32 s82, s82, 2048
    v_mfma_f32_16x16x32_bf16 v[132:135], v[184:187], v[156:159], v[132:135]
    s_bitset0_b32 s82, 15
    s_waitcnt lgkmcnt(2)
    v_mfma_f32_16x16x32_bf16 v[80:83], v[160:163], v[144:147], v[80:83]
    v_mfma_f32_16x16x32_bf16 v[192:195], v[188:191], v[188:191], v[192:195]
    v_mfma_f32_16x16x32_bf16 v[196:199], v[200:203], v[188:191], v[196:199]
    ds_read_b128 v[184:187], v221 offset:20480
    s_add_u32 m0, s91, 0
    v_mfma_f32_16x16x32_bf16 v[84:87], v[160:163], v[148:151], v[84:87]
    buffer_load_dwordx4 v239, s[32:35], s82 offen sc1 lds
    v_mfma_f32_16x16x32_bf16 v[88:91], v[164:167], v[144:147], v[88:91]
    ds_read_b128 v[160:163], v221 offset:21504
    v_mfma_f32_16x16x32_bf16 v[92:95], v[164:167], v[148:151], v[92:95]
    s_waitcnt vmcnt(20)
    ds_read_b64_tr_b16 v[152:153], v240 offset:8192
    v_mfma_f32_16x16x32_bf16 v[96:99], v[168:171], v[144:147], v[96:99]
    ds_read_b128 v[164:167], v221 offset:22528
    ds_read_b64_tr_b16 v[188:189], v226 offset:8192
    v_mfma_f32_16x16x32_bf16 v[100:103], v[168:171], v[148:151], v[100:103]
    ds_read_b64_tr_b16 v[154:155], v240 offset:9216
    buffer_load_dwordx4 a[196:199], v232, s[32:35], s85 offen offset:1024 sc1
    buffer_load_dwordx4 a[200:203], v232, s[32:35], s85 offen offset:2048 sc1
    v_mfma_f32_16x16x32_bf16 v[104:107], v[172:175], v[144:147], v[104:107]
    ds_read_b128 v[168:171], v221 offset:23552
    ds_read_b64_tr_b16 v[190:191], v226 offset:9216
    v_mfma_f32_16x16x32_bf16 v[108:111], v[172:175], v[148:151], v[108:111]
    ds_read_b64_tr_b16 v[156:157], v241 offset:8192
    s_waitcnt lgkmcnt(8)
    v_mfma_f32_16x16x32_bf16 v[112:115], v[176:179], v[144:147], v[112:115]
    ds_read_b128 v[172:175], v221 offset:24576
    v_mfma_f32_16x16x32_bf16 v[116:119], v[176:179], v[148:151], v[116:119]
    ds_read_b64_tr_b16 v[158:159], v241 offset:9216
    v_mfma_f32_16x16x32_bf16 v[120:123], v[180:183], v[144:147], v[120:123]
    ds_read_b128 v[176:179], v221 offset:25600
    v_mfma_f32_16x16x32_bf16 v[124:127], v[180:183], v[148:151], v[124:127]
    buffer_load_dwordx4 v239, s[32:35], s82 offen offset:1024 sc1 lds
    v_mfma_f32_16x16x32_bf16 v[128:131], v[184:187], v[144:147], v[128:131]
    ds_read_b128 v[180:183], v221 offset:26624
    s_add_u32 s82, s82, 2048
    v_mfma_f32_16x16x32_bf16 v[132:135], v[184:187], v[148:151], v[132:135]
    s_bitset0_b32 s82, 15
    s_waitcnt lgkmcnt(2)
    v_mfma_f32_16x16x32_bf16 v[80:83], v[160:163], v[152:155], v[80:83]
    v_mfma_f32_16x16x32_bf16 v[192:195], v[188:191], v[188:191], v[192:195]
    v_mfma_f32_16x16x32_bf16 v[196:199], v[200:203], v[188:191], v[196:199]
    ds_read_b128 v[184:187], v221 offset:27648
    s_add_u32 m0, s91, 8192
    v_mfma_f32_16x16x32_bf16 v[84:87], v[160:163], v[156:159], v[84:87]
    buffer_load_dwordx4 v239, s[32:35], s82 offen sc1 lds
    v_mfma_f32_16x16x32_bf16 v[88:91], v[164:167], v[152:155], v[88:91]
    ds_read_b128 v[160:163], v222 offset:0
    v_mfma_f32_16x16x32_bf16 v[92:95], v[164:167], v[156:159], v[92:95]
    s_waitcnt vmcnt(20)
    ds_read_b64_tr_b16 v[144:145], v240 offset:16384
    v_mfma_f32_16x16x32_bf16 v[96:99], v[168:171], v[152:155], v[96:99]
    ds_read_b128 v[164:167], v222 offset:1024
    v_mfma_f32_16x16x32_bf16 v[100:103], v[168:171], v[156:159], v[100:103]
    ds_read_b64_tr_b16 v[146:147], v240 offset:17408
    buffer_load_dwordx4 a[204:207], v232, s[32:35], s85 offen offset:3072 sc1
    s_add_u32 s85, s85, 4096
    buffer_load_dwordx4 a[208:211], v232, s[32:35], s85 offen offset:0 sc1
    v_mfma_f32_16x16x32_bf16 v[104:107], v[172:175], v[152:155], v[104:107]
    ds_read_b128 v[168:171], v222 offset:2048
    v_mfma_f32_16x16x32_bf16 v[108:111], v[172:175], v[156:159], v[108:111]
    ds_read_b64_tr_b16 v[148:149], v241 offset:16384
    s_waitcnt lgkmcnt(6)
    v_mfma_f32_16x16x32_bf16 v[112:115], v[176:179], v[152:155], v[112:115]
    ds_read_b128 v[172:175], v222 offset:3072
    s_mov_b32 s42, 0x22222222
    v_mfma_f32_16x16x32_bf16 v[116:119], v[176:179], v[156:159], v[116:119]
    ds_read_b64_tr_b16 v[150:151], v241 offset:17408
    s_mov_b32 s43, 0x22222222
    v_mfma_f32_16x16x32_bf16 v[120:123], v[180:183], v[152:155], v[120:123]
    ds_read_b128 v[176:179], v222 offset:4096
    v_cndmask_b32 v192, v192, v193, s[42:43]
    v_mfma_f32_16x16x32_bf16 v[124:127], v[180:183], v[156:159], v[124:127]
    buffer_load_dwordx4 v239, s[32:35], s82 offen offset:1024 sc1 lds
    s_mov_b32 s42, 0x44444444
    v_mfma_f32_16x16x32_bf16 v[128:131], v[184:187], v[152:155], v[128:131]
    ds_read_b128 v[180:183], v222 offset:5120
    s_add_u32 s82, s82, 2048
    s_waitcnt vmcnt(13)
    s_lshl_b32 s70, s81, 6
    s_add_u32 s70, s70, 0
    v_mov_b32 v214, s46
    v_mov_b32 v215, s47
    v_mov_b32 v216, s70
    s_mov_b64 exec, 1
    buffer_store_dwordx2 v[214:215], v216, s[32:35], s62 offen sc1
    s_mov_b64 exec, -1
    v_mfma_f32_16x16x32_bf16 v[132:135], v[184:187], v[156:159], v[132:135]
    s_bitset0_b32 s82, 15
    s_waitcnt lgkmcnt(2)
    v_mfma_f32_16x16x32_bf16 v[80:83], v[160:163], v[144:147], v[80:83]
    ds_read_b128 v[184:187], v222 offset:6144
    s_add_u32 m0, s91, 16384
    v_mfma_f32_16x16x32_bf16 v[84:87], v[160:163], v[148:151], v[84:87]
    buffer_load_dwordx4 v239, s[32:35], s82 offen sc1 lds
    s_mov_b32 s43, 0x44444444
    v_mfma_f32_16x16x32_bf16 v[88:91], v[164:167], v[144:147], v[88:91]
    ds_read_b128 v[160:163], v222 offset:7168
    v_cndmask_b32 v192, v192, v194, s[42:43]
    v_mfma_f32_16x16x32_bf16 v[92:95], v[164:167], v[148:151], v[92:95]
    ds_read_b64_tr_b16 v[152:153], v240 offset:32768
    v_mfma_f32_16x16x32_bf16 v[96:99], v[168:171], v[144:147], v[96:99]
    ds_read_b128 v[164:167], v222 offset:8192
    s_mov_b32 s42, 0x88888888
    v_mfma_f32_16x16x32_bf16 v[100:103], v[168:171], v[148:151], v[100:103]
    ds_read_b64_tr_b16 v[154:155], v240 offset:33792
    buffer_load_dwordx4 a[212:215], v232, s[32:35], s85 offen offset:1024 sc1
    v_mfma_f32_16x16x32_bf16 v[104:107], v[172:175], v[144:147], v[104:107]
    ds_read_b128 v[168:171], v222 offset:9216
    s_mov_b32 s43, 0x88888888
    v_mfma_f32_16x16x32_bf16 v[108:111], v[172:175], v[148:151], v[108:111]
    ds_read_b64_tr_b16 v[156:157], v241 offset:32768
    s_waitcnt lgkmcnt(6)
    v_mfma_f32_16x16x32_bf16 v[112:115], v[176:179], v[144:147], v[112:115]
    ds_read_b128 v[172:175], v222 offset:10240
    v_cndmask_b32 v198, v192, v195, s[42:43]
    v_mfma_f32_16x16x32_bf16 v[116:119], v[176:179], v[148:151], v[116:119]
    ds_read_b64_tr_b16 v[158:159], v241 offset:33792
    v_mov_b32 v199, s46
    v_mfma_f32_16x16x32_bf16 v[120:123], v[180:183], v[144:147], v[120:123]
    ds_read_b128 v[176:179], v222 offset:11264
    s_mov_b32 s41, 11665408
    v_mfma_f32_16x16x32_bf16 v[124:127], v[180:183], v[148:151], v[124:127]
    buffer_load_dwordx4 v239, s[32:35], s82 offen offset:1024 sc1 lds
    s_mov_b32 exec_lo, 0x00f0000f
    s_mov_b32 exec_hi, 0xf0000f00
    buffer_store_dwordx4 v[196:199], v225, s[32:35], s41 offen sc1
    s_mov_b64 exec, -1
    v_mfma_f32_16x16x32_bf16 v[128:131], v[184:187], v[144:147], v[128:131]
    ds_read_b128 v[180:183], v222 offset:12288
    s_add_u32 s82, s82, 2048
    v_mfma_f32_16x16x32_bf16 v[132:135], v[184:187], v[148:151], v[132:135]
    s_bitset0_b32 s82, 15
    s_waitcnt lgkmcnt(2)
    v_mfma_f32_16x16x32_bf16 v[80:83], v[160:163], v[152:155], v[80:83]
    ds_read_b128 v[184:187], v222 offset:13312
    s_add_u32 m0, s91, 32768
    v_mfma_f32_16x16x32_bf16 v[84:87], v[160:163], v[156:159], v[84:87]
    buffer_load_dwordx4 v239, s[32:35], s82 offen sc1 lds
    s_lshl_b32 s72, s54, 5
    v_mfma_f32_16x16x32_bf16 v[88:91], v[164:167], v[152:155], v[88:91]
    ds_read_b128 v[160:163], v222 offset:14336
    s_lshl_b32 s70, s44, 3
    v_mfma_f32_16x16x32_bf16 v[92:95], v[164:167], v[156:159], v[92:95]
    s_waitcnt vmcnt(18)
    ds_read_b64_tr_b16 v[144:145], v240 offset:24576
    v_mfma_f32_16x16x32_bf16 v[96:99], v[168:171], v[152:155], v[96:99]
    ds_read_b128 v[164:167], v222 offset:15360
    s_add_u32 s72, s72, s70
    v_mfma_f32_16x16x32_bf16 v[100:103], v[168:171], v[156:159], v[100:103]
    ds_read_b64_tr_b16 v[146:147], v240 offset:25600
    buffer_load_dwordx4 a[216:219], v232, s[32:35], s85 offen offset:2048 sc1
    v_mfma_f32_16x16x32_bf16 v[104:107], v[172:175], v[152:155], v[104:107]
    ds_read_b128 v[168:171], v222 offset:16384
    v_and_b32 v220, 7, v1
    v_mfma_f32_16x16x32_bf16 v[108:111], v[172:175], v[156:159], v[108:111]
    ds_read_b64_tr_b16 v[148:149], v241 offset:24576
    s_waitcnt lgkmcnt(6)
    v_mfma_f32_16x16x32_bf16 v[112:115], v[176:179], v[152:155], v[112:115]
    ds_read_b128 v[172:175], v222 offset:17408
    v_add_lshl_u32 v220, v220, s72, 6
    v_mfma_f32_16x16x32_bf16 v[116:119], v[176:179], v[156:159], v[116:119]
    ds_read_b64_tr_b16 v[150:151], v241 offset:25600
    s_lshl_b32 s49, s54, 5
    v_mfma_f32_16x16x32_bf16 v[120:123], v[180:183], v[152:155], v[120:123]
    ds_read_b128 v[176:179], v222 offset:18432
    s_lshl_b32 s45, s44, 3
    v_mfma_f32_16x16x32_bf16 v[124:127], v[180:183], v[156:159], v[124:127]
    buffer_load_dwordx4 v239, s[32:35], s82 offen offset:1024 sc1 lds
    s_add_u32 s49, s49, s45
    v_mfma_f32_16x16x32_bf16 v[128:131], v[184:187], v[152:155], v[128:131]
    ds_read_b128 v[180:183], v222 offset:19456
    s_add_u32 s82, s82, 2048
    v_mfma_f32_16x16x32_bf16 v[132:135], v[184:187], v[156:159], v[132:135]
    s_bitset0_b32 s82, 15
    s_waitcnt lgkmcnt(2)
    v_mfma_f32_16x16x32_bf16 v[80:83], v[160:163], v[144:147], v[80:83]
    ds_read_b128 v[184:187], v222 offset:20480
    s_add_u32 m0, s91, 24576
    v_mfma_f32_16x16x32_bf16 v[84:87], v[160:163], v[148:151], v[84:87]
    buffer_load_dwordx4 v239, s[32:35], s82 offen sc1 lds
    s_mul_i32 s49, s49, 3712
    v_mfma_f32_16x16x32_bf16 v[88:91], v[164:167], v[144:147], v[88:91]
    ds_read_b128 v[160:163], v222 offset:21504
    s_add_u32 s49, s49, 20971520
    v_mfma_f32_16x16x32_bf16 v[92:95], v[164:167], v[148:151], v[92:95]
    s_waitcnt vmcnt(17)
    ds_read_b64_tr_b16 v[152:153], v240 offset:40960
    v_mfma_f32_16x16x32_bf16 v[96:99], v[168:171], v[144:147], v[96:99]
    ds_read_b128 v[164:167], v222 offset:22528
    s_mul_i32 s45, s65, 14848
    v_mfma_f32_16x16x32_bf16 v[100:103], v[168:171], v[148:151], v[100:103]
    ds_read_b64_tr_b16 v[154:155], v240 offset:41984
    buffer_load_dwordx4 a[220:223], v232, s[32:35], s85 offen offset:3072 sc1
    v_mfma_f32_16x16x32_bf16 v[104:107], v[172:175], v[144:147], v[104:107]
    ds_read_b128 v[168:171], v222 offset:23552
    s_sub_u32 s95, s49, s45
    v_mfma_f32_16x16x32_bf16 v[108:111], v[172:175], v[148:151], v[108:111]
    ds_read_b64_tr_b16 v[156:157], v241 offset:40960
    s_waitcnt lgkmcnt(6)
    v_mfma_f32_16x16x32_bf16 v[112:115], v[176:179], v[144:147], v[112:115]
    ds_read_b128 v[172:175], v222 offset:24576
    s_add_u32 s49, s49, s45
    v_mfma_f32_16x16x32_bf16 v[116:119], v[176:179], v[148:151], v[116:119]
    ds_read_b64_tr_b16 v[158:159], v241 offset:41984
    v_lshrrev_b32 v15, 1, v232
    v_mfma_f32_16x16x32_bf16 v[120:123], v[180:183], v[144:147], v[120:123]
    ds_read_b128 v[176:179], v222 offset:25600
    s_lshr_b32 s45, s44, 1
    v_mfma_f32_16x16x32_bf16 v[124:127], v[180:183], v[148:151], v[124:127]
    buffer_load_dwordx4 v239, s[32:35], s82 offen offset:1024 sc1 lds
    s_lshl_b32 s45, s45, 6
    v_mfma_f32_16x16x32_bf16 v[128:131], v[184:187], v[144:147], v[128:131]
    ds_read_b128 v[180:183], v222 offset:26624
    s_add_u32 s82, s82, 2048
    buffer_load_dwordx2 v[218:219], v220, s[32:35], s62 offen sc1
    v_mfma_f32_16x16x32_bf16 v[132:135], v[184:187], v[148:151], v[132:135]
    s_bitset0_b32 s82, 15
    s_waitcnt lgkmcnt(2)
    v_mfma_f32_16x16x32_bf16 v[80:83], v[160:163], v[152:155], v[80:83]
    ds_read_b128 v[184:187], v222 offset:27648
    s_add_u32 m0, s91, 40960
    v_mfma_f32_16x16x32_bf16 v[84:87], v[160:163], v[156:159], v[84:87]
    buffer_load_dwordx4 v239, s[32:35], s82 offen sc1 lds
    v_lshl_add_u32 v14, v2, 2, s45
    v_mfma_f32_16x16x32_bf16 v[88:91], v[164:167], v[152:155], v[88:91]
    ds_read_b128 v[160:163], v223 offset:0
    v_mfma_f32_16x16x32_bf16 v[92:95], v[164:167], v[156:159], v[92:95]
    s_waitcnt vmcnt(17)
    ds_read_b64_tr_b16 v[144:145], v240 offset:0
    v_mfma_f32_16x16x32_bf16 v[96:99], v[168:171], v[152:155], v[96:99]
    ds_read_b128 v[164:167], v223 offset:1024
    v_mfma_f32_16x16x32_bf16 v[100:103], v[168:171], v[156:159], v[100:103]
    ds_read_b64_tr_b16 v[146:147], v240 offset:1024
    v_mfma_f32_16x16x32_bf16 v[104:107], v[172:175], v[152:155], v[104:107]
    ds_read_b128 v[168:171], v223 offset:2048
    v_mfma_f32_16x16x32_bf16 v[108:111], v[172:175], v[156:159], v[108:111]
    ds_read_b64_tr_b16 v[148:149], v241 offset:0
    s_waitcnt lgkmcnt(6)
    v_mfma_f32_16x16x32_bf16 v[112:115], v[176:179], v[152:155], v[112:115]
    ds_read_b128 v[172:175], v223 offset:3072
    v_mfma_f32_16x16x32_bf16 v[116:119], v[176:179], v[156:159], v[116:119]
    ds_read_b64_tr_b16 v[150:151], v241 offset:1024
    v_mfma_f32_16x16x32_bf16 v[120:123], v[180:183], v[152:155], v[120:123]
    ds_read_b128 v[176:179], v223 offset:4096
    v_mfma_f32_16x16x32_bf16 v[124:127], v[180:183], v[156:159], v[124:127]
    buffer_load_dwordx4 v239, s[32:35], s82 offen offset:1024 sc1 lds
    v_mfma_f32_16x16x32_bf16 v[128:131], v[184:187], v[152:155], v[128:131]
    ds_read_b128 v[180:183], v223 offset:5120
    s_add_u32 s82, s82, 2048
    v_mfma_f32_16x16x32_bf16 v[132:135], v[184:187], v[156:159], v[132:135]
    s_bitset0_b32 s82, 15
    s_waitcnt lgkmcnt(2)
    v_mfma_f32_16x16x32_bf16 v[80:83], v[160:163], v[144:147], v[80:83]
    ds_read_b128 v[184:187], v223 offset:6144
    s_add_u32 m0, s91, 0
    v_mfma_f32_16x16x32_bf16 v[84:87], v[160:163], v[148:151], v[84:87]
    buffer_load_dwordx4 v239, s[32:35], s82 offen sc1 lds
    v_mfma_f32_16x16x32_bf16 v[88:91], v[164:167], v[144:147], v[88:91]
    ds_read_b128 v[160:163], v223 offset:7168
    v_mfma_f32_16x16x32_bf16 v[92:95], v[164:167], v[148:151], v[92:95]
    s_waitcnt vmcnt(15)
    ds_read_b64_tr_b16 v[152:153], v240 offset:8192
    v_mfma_f32_16x16x32_bf16 v[96:99], v[168:171], v[144:147], v[96:99]
    ds_read_b128 v[164:167], v223 offset:8192
    v_mfma_f32_16x16x32_bf16 v[100:103], v[168:171], v[148:151], v[100:103]
    ds_read_b64_tr_b16 v[154:155], v240 offset:9216
    v_mfma_f32_16x16x32_bf16 v[104:107], v[172:175], v[144:147], v[104:107]
    ds_read_b128 v[168:171], v223 offset:9216
    v_mfma_f32_16x16x32_bf16 v[108:111], v[172:175], v[148:151], v[108:111]
    ds_read_b64_tr_b16 v[156:157], v241 offset:8192
    s_waitcnt lgkmcnt(6)
    v_mfma_f32_16x16x32_bf16 v[112:115], v[176:179], v[144:147], v[112:115]
    ds_read_b128 v[172:175], v223 offset:10240
    v_mfma_f32_16x16x32_bf16 v[116:119], v[176:179], v[148:151], v[116:119]
    ds_read_b64_tr_b16 v[158:159], v241 offset:9216
    v_mfma_f32_16x16x32_bf16 v[120:123], v[180:183], v[144:147], v[120:123]
    ds_read_b128 v[176:179], v223 offset:11264
    v_mfma_f32_16x16x32_bf16 v[124:127], v[180:183], v[148:151], v[124:127]
    buffer_load_dwordx4 v239, s[32:35], s82 offen offset:1024 sc1 lds
    v_mfma_f32_16x16x32_bf16 v[128:131], v[184:187], v[144:147], v[128:131]
    ds_read_b128 v[180:183], v223 offset:12288
    s_add_u32 s82, s82, 2048
    v_mfma_f32_16x16x32_bf16 v[132:135], v[184:187], v[148:151], v[132:135]
    s_bitset0_b32 s82, 15
    s_waitcnt lgkmcnt(2)
    v_mfma_f32_16x16x32_bf16 v[80:83], v[160:163], v[152:155], v[80:83]
    ds_read_b128 v[184:187], v223 offset:13312
    s_add_u32 m0, s91, 8192
    v_mfma_f32_16x16x32_bf16 v[84:87], v[160:163], v[156:159], v[84:87]
    buffer_load_dwordx4 v239, s[32:35], s82 offen sc1 lds
    v_mfma_f32_16x16x32_bf16 v[88:91], v[164:167], v[152:155], v[88:91]
    ds_read_b128 v[160:163], v223 offset:14336
    v_mfma_f32_16x16x32_bf16 v[92:95], v[164:167], v[156:159], v[92:95]
    s_waitcnt vmcnt(13)
    ds_read_b64_tr_b16 v[144:145], v240 offset:16384
    v_mfma_f32_16x16x32_bf16 v[96:99], v[168:171], v[152:155], v[96:99]
    ds_read_b128 v[164:167], v223 offset:15360
    v_mfma_f32_16x16x32_bf16 v[100:103], v[168:171], v[156:159], v[100:103]
    ds_read_b64_tr_b16 v[146:147], v240 offset:17408
    v_mfma_f32_16x16x32_bf16 v[104:107], v[172:175], v[152:155], v[104:107]
    ds_read_b128 v[168:171], v223 offset:16384
    v_mfma_f32_16x16x32_bf16 v[108:111], v[172:175], v[156:159], v[108:111]
    ds_read_b64_tr_b16 v[148:149], v241 offset:16384
    s_waitcnt lgkmcnt(6)
    v_mfma_f32_16x16x32_bf16 v[112:115], v[176:179], v[152:155], v[112:115]
    ds_read_b128 v[172:175], v223 offset:17408
    v_mfma_f32_16x16x32_bf16 v[116:119], v[176:179], v[156:159], v[116:119]
    ds_read_b64_tr_b16 v[150:151], v241 offset:17408
    v_mfma_f32_16x16x32_bf16 v[120:123], v[180:183], v[152:155], v[120:123]
    ds_read_b128 v[176:179], v223 offset:18432
    v_mfma_f32_16x16x32_bf16 v[124:127], v[180:183], v[156:159], v[124:127]
    buffer_load_dwordx4 v239, s[32:35], s82 offen offset:1024 sc1 lds
    v_mfma_f32_16x16x32_bf16 v[128:131], v[184:187], v[152:155], v[128:131]
    ds_read_b128 v[180:183], v223 offset:19456
    s_add_u32 s82, s82, 2048
    v_mfma_f32_16x16x32_bf16 v[132:135], v[184:187], v[156:159], v[132:135]
    s_bitset0_b32 s82, 15
    s_waitcnt vmcnt(6)
    v_cmp_ne_u64 s[86:87], s[46:47], v[218:219]
    s_nop 0
    s_cmp_eq_u64 s[86:87], 0
    s_cbranch_scc0 slow_19
ok_20:
    s_waitcnt lgkmcnt(2)
    v_mfma_f32_16x16x32_bf16 v[80:83], v[160:163], v[144:147], v[80:83]
    ds_read_b128 v[184:187], v223 offset:20480
    v_mfma_f32_16x16x32_bf16 v[84:87], v[160:163], v[148:151], v[84:87]
    s_add_u32 s45, s49, 0
    buffer_load_dwordx4 v[32:35], v232, s[32:35], s45 offen offset:0 sc1
    v_mfma_f32_16x16x32_bf16 v[88:91], v[164:167], v[144:147], v[88:91]
    ds_read_b128 v[160:163], v223 offset:21504
    v_mfma_f32_16x16x32_bf16 v[92:95], v[164:167], v[148:151], v[92:95]
    ds_read_b64_tr_b16 v[152:153], v240 offset:32768
    v_mfma_f32_16x16x32_bf16 v[96:99], v[168:171], v[144:147], v[96:99]
    ds_read_b128 v[164:167], v223 offset:22528
    v_mfma_f32_16x16x32_bf16 v[100:103], v[168:171], v[148:151], v[100:103]
    ds_read_b64_tr_b16 v[154:155], v240 offset:33792
    v_mfma_f32_16x16x32_bf16 v[104:107], v[172:175], v[144:147], v[104:107]
    buffer_load_dwordx4 v[36:39], v232, s[32:35], s45 offen offset:1024 sc1
    ds_read_b128 v[168:171], v223 offset:23552
    v_mfma_f32_16x16x32_bf16 v[108:111], v[172:175], v[148:151], v[108:111]
    ds_read_b64_tr_b16 v[156:157], v241 offset:32768
    s_waitcnt lgkmcnt(6)
    v_mfma_f32_16x16x32_bf16 v[112:115], v[176:179], v[144:147], v[112:115]
    ds_read_b128 v[172:175], v223 offset:24576
    v_mfma_f32_16x16x32_bf16 v[116:119], v[176:179], v[148:151], v[116:119]
    ds_read_b64_tr_b16 v[158:159], v241 offset:33792
    buffer_load_dwordx4 v[16:19], v224, s[32:35], s41 offen offset:0 sc1
    v_mfma_f32_16x16x32_bf16 v[120:123], v[180:183], v[144:147], v[120:123]
    ds_read_b128 v[176:179], v223 offset:25600
    v_mfma_f32_16x16x32_bf16 v[124:127], v[180:183], v[148:151], v[124:127]
    s_add_u32 s45, s49, 3712
    buffer_load_dwordx4 v[40:43], v232, s[32:35], s45 offen offset:0 sc1
    v_mfma_f32_16x16x32_bf16 v[128:131], v[184:187], v[144:147], v[128:131]
    ds_read_b128 v[180:183], v223 offset:26624
    v_mfma_f32_16x16x32_bf16 v[132:135], v[184:187], v[148:151], v[132:135]
    s_waitcnt lgkmcnt(2)
    v_mfma_f32_16x16x32_bf16 v[80:83], v[160:163], v[152:155], v[80:83]
    ds_read_b128 v[184:187], v223 offset:27648
    s_add_u32 m0, s91, 16384
    v_mfma_f32_16x16x32_bf16 v[84:87], v[160:163], v[156:159], v[84:87]
    s_mov_b32 s68, 4193280
    s_mov_b32 s69, 3145728
    v_mfma_f32_16x16x32_bf16 v[88:91], v[164:167], v[152:155], v[88:91]
    buffer_load_dwordx4 v[44:47], v232, s[32:35], s45 offen offset:1024 sc1
    ds_read_b128 v[160:163], v227 offset:0
    v_mfma_f32_16x16x32_bf16 v[92:95], v[164:167], v[156:159], v[92:95]
    buffer_load_dwordx4 v[20:23], v224, s[32:35], s41 offen offset:512 sc1
    ds_read_b64_tr_b16 v[144:145], v240 offset:24576
    v_mfma_f32_16x16x32_bf16 v[96:99], v[168:171], v[152:155], v[96:99]
    ds_read_b128 v[164:167], v227 offset:1024
    buffer_load_dwordx4 v242, s[32:35], s69 offen sc1 lds
    v_mfma_f32_16x16x32_bf16 v[100:103], v[168:171], v[156:159], v[100:103]
    ds_read_b64_tr_b16 v[146:147], v240 offset:25600
    buffer_load_dwordx4 v242, s[32:35], s68 offen offset:1024 sc1 lds
    v_mfma_f32_16x16x32_bf16 v[104:107], v[172:175], v[152:155], v[104:107]
    ds_read_b128 v[168:171], v227 offset:2048
    v_mfma_f32_16x16x32_bf16 v[108:111], v[172:175], v[156:159], v[108:111]
    s_add_u32 s45, s49, 7424
    buffer_load_dwordx4 v[48:51], v232, s[32:35], s45 offen offset:0 sc1
    ds_read_b64_tr_b16 v[148:149], v241 offset:24576
    s_waitcnt lgkmcnt(6)
    v_mfma_f32_16x16x32_bf16 v[112:115], v[176:179], v[152:155], v[112:115]
    ds_read_b128 v[172:175], v227 offset:3072
    v_mfma_f32_16x16x32_bf16 v[116:119], v[176:179], v[156:159], v[116:119]
    ds_read_b64_tr_b16 v[150:151], v241 offset:25600
    v_mfma_f32_16x16x32_bf16 v[120:123], v[180:183], v[152:155], v[120:123]
    ds_read_b128 v[176:179], v227 offset:4096
    v_mfma_f32_16x16x32_bf16 v[124:127], v[180:183], v[156:159], v[124:127]
    v_mfma_f32_16x16x32_bf16 v[128:131], v[184:187], v[152:155], v[128:131]
    buffer_load_dwordx4 v[52:55], v232, s[32:35], s45 offen offset:1024 sc1
    ds_read_b128 v[180:183], v227 offset:5120
    v_mfma_f32_16x16x32_bf16 v[132:135], v[184:187], v[156:159], v[132:135]
    s_waitcnt lgkmcnt(2)
    v_mfma_f32_16x16x32_bf16 v[80:83], v[160:163], v[144:147], v[80:83]
    ds_read_b128 v[184:187], v227 offset:6144
    v_mfma_f32_16x16x32_bf16 v[84:87], v[160:163], v[148:151], v[84:87]
    v_mfma_f32_16x16x32_bf16 v[88:91], v[164:167], v[144:147], v[88:91]
    ds_read_b128 v[160:163], v227 offset:7168
    v_mfma_f32_16x16x32_bf16 v[92:95], v[164:167], v[148:151], v[92:95]
    s_add_u32 s45, s49, 11136
    buffer_load_dwordx4 v[56:59], v232, s[32:35], s45 offen offset:0 sc1
    s_waitcnt vmcnt(15)
    ds_read_b64_tr_b16 v[152:153], v240 offset:40960
    v_mfma_f32_16x16x32_bf16 v[96:99], v[168:171], v[144:147], v[96:99]
    ds_read_b128 v[164:167], v227 offset:8192
    v_mfma_f32_16x16x32_bf16 v[100:103], v[168:171], v[148:151], v[100:103]
    ds_read_b64_tr_b16 v[154:155], v240 offset:41984
    v_mfma_f32_16x16x32_bf16 v[104:107], v[172:175], v[144:147], v[104:107]
    ds_read_b128 v[168:171], v227 offset:9216
    v_mfma_f32_16x16x32_bf16 v[108:111], v[172:175], v[148:151], v[108:111]
    ds_read_b64_tr_b16 v[156:157], v241 offset:40960
    s_waitcnt lgkmcnt(6)
    v_mfma_f32_16x16x32_bf16 v[112:115], v[176:179], v[144:147], v[112:115]
    buffer_load_dwordx4 v[60:63], v232, s[32:35], s45 offen offset:1024 sc1
    ds_read_b128 v[172:175], v227 offset:10240
    v_mfma_f32_16x16x32_bf16 v[116:119], v[176:179], v[148:151], v[116:119]
    ds_read_b64_tr_b16 v[158:159], v241 offset:41984
    v_mfma_f32_16x16x32_bf16 v[120:123], v[180:183], v[144:147], v[120:123]
    ds_read_b128 v[176:179], v227 offset:11264
    v_mfma_f32_16x16x32_bf16 v[124:127], v[180:183], v[148:151], v[124:127]
    v_mfma_f32_16x16x32_bf16 v[128:131], v[184:187], v[144:147], v[128:131]
    ds_read_b128 v[180:183], v227 offset:12288
    v_mfma_f32_16x16x32_bf16 v[132:135], v[184:187], v[148:151], v[132:135]
    s_add_u32 s45, s49, 0
    buffer_load_dwordx4 v[64:67], v232, s[32:35], s45 offen offset:2048 sc1
    s_waitcnt lgkmcnt(2)
    v_mfma_f32_16x16x32_bf16 v[80:83], v[160:163], v[152:155], v[80:83]
    ds_read_b128 v[184:187], v227 offset:13312
    s_waitcnt vmcnt(7)
    v_mfma_f32_16x16x32_bf16 v[84:87], v[160:163], v[156:159], v[84:87]
    v_sad_u32 v8, v19, s46, 0
    v_add_f32 v16, v16, v20
    v_mfma_f32_16x16x32_bf16 v[88:91], v[164:167], v[152:155], v[88:91]
    ds_read_b128 v[160:163], v227 offset:14336
    v_sad_u32 v8, v23, s46, v8
    v_mfma_f32_16x16x32_bf16 v[92:95], v[164:167], v[156:159], v[92:95]
    ds_read_b64_tr_b16 v[144:145], v240 offset:0
    v_mfma_f32_16x16x32_bf16 v[96:99], v[168:171], v[152:155], v[96:99]
    s_add_u32 s45, s49, 3712
    buffer_load_dwordx4 v[68:71], v232, s[32:35], s45 offen offset:2048 sc1
    ds_read_b128 v[164:167], v227 offset:15360
    v_mfma_f32_16x16x32_bf16 v[100:103], v[168:171], v[156:159], v[100:103]
    ds_read_b64_tr_b16 v[146:147], v240 offset:1024
    v_add_f32 v18, v18, v22
    v_mfma_f32_16x16x32_bf16 v[104:107], v[172:175], v[152:155], v[104:107]
    ds_read_b128 v[168:171], v227 offset:16384
    v_cmp_ne_u32 s[86:87], 0, v8
    s_nop 0
    s_cmp_eq_u64 s[86:87], 0
    s_cbranch_scc0 gslow_21
gok_22:
    v_mfma_f32_16x16x32_bf16 v[108:111], v[172:175], v[156:159], v[108:111]
    ds_read_b64_tr_b16 v[148:149], v241 offset:0
    s_waitcnt lgkmcnt(6)
    v_mfma_f32_16x16x32_bf16 v[112:115], v[176:179], v[152:155], v[112:115]
    ds_read_b128 v[172:175], v227 offset:17408
    v_mov_b32 v17, v16
    v_mfma_f32_16x16x32_bf16 v[116:119], v[176:179], v[156:159], v[116:119]
    s_add_u32 s45, s49, 7424
    buffer_load_dwordx4 v[72:75], v232, s[32:35], s45 offen offset:2048 sc1
    ds_read_b64_tr_b16 v[150:151], v241 offset:1024
    v_mfma_f32_16x16x32_bf16 v[120:123], v[180:183], v[152:155], v[120:123]
    ds_read_b128 v[176:179], v227 offset:18432
    v_mov_b32 v19, v18
    v_mfma_f32_16x16x32_bf16 v[124:127], v[180:183], v[156:159], v[124:127]
    v_mov_b32 v12, 0x3727c5ac
    v_permlane32_swap_b32 v16, v17
    v_mfma_f32_16x16x32_bf16 v[128:131], v[184:187], v[152:155], v[128:131]
    ds_read_b128 v[180:183], v227 offset:19456
    v_permlane32_swap_b32 v18, v19
    v_mfma_f32_16x16x32_bf16 v[132:135], v[184:187], v[156:159], v[132:135]
    v_add_f32 v16, v16, v17
    s_waitcnt lgkmcnt(2)
    v_mfma_f32_16x16x32_bf16 v[80:83], v[160:163], v[144:147], v[80:83]
    s_add_u32 s45, s49, 11136
    buffer_load_dwordx4 v[76:79], v232, s[32:35], s45 offen offset:2048 sc1
    ds_read_b128 v[184:187], v227 offset:20480
    v_mfma_f32_16x16x32_bf16 v[84:87], v[160:163], v[148:151], v[84:87]
    v_add_f32 v18, v18, v19
    v_mul_f32 v16, 0xbb000000, v16
    v_mfma_f32_16x16x32_bf16 v[88:91], v[164:167], v[144:147], v[88:91]
    ds_read_b128 v[160:163], v227 offset:21504
    v_fmac_f32 v12, 0x3b000000, v18
    v_mfma_f32_16x16x32_bf16 v[92:95], v[164:167], v[148:151], v[92:95]
    ds_read_b64_tr_b16 v[152:153], v240 offset:8192
    v_mfma_f32_16x16x32_bf16 v[96:99], v[168:171], v[144:147], v[96:99]
    ds_read_b128 v[164:167], v227 offset:22528
    v_cvt_pk_bf16_f32 v11, v16, 0
    v_mfma_f32_16x16x32_bf16 v[100:103], v[168:171], v[148:151], v[100:103]
    s_add_u32 s45, s49, 0
    buffer_load_dwordx2 v[204:205], v15, s[32:35], s45 offen offset:3072 sc1
    ds_read_b64_tr_b16 v[154:155], v240 offset:9216
    v_mfma_f32_16x16x32_bf16 v[104:107], v[172:175], v[144:147], v[104:107]
    ds_read_b128 v[168:171], v227 offset:23552
    v_fma_f32 v12, -v16, v16, v12
    v_mfma_f32_16x16x32_bf16 v[108:111], v[172:175], v[148:151], v[108:111]
    ds_read_b64_tr_b16 v[156:157], v241 offset:8192
    s_waitcnt lgkmcnt(6)
    v_mfma_f32_16x16x32_bf16 v[112:115], v[176:179], v[144:147], v[112:115]
    ds_read_b128 v[172:175], v227 offset:24576
    v_lshlrev_b32 v17, 16, v11
    v_mfma_f32_16x16x32_bf16 v[116:119], v[176:179], v[148:151], v[116:119]
    ds_read_b64_tr_b16 v[158:159], v241 offset:9216
    v_max_f32 v12, 0x3727c5ac, v12
    v_mfma_f32_16x16x32_bf16 v[120:123], v[180:183], v[144:147], v[120:123]
    s_add_u32 s45, s49, 3712
    buffer_load_dwordx2 v[206:207], v15, s[32:35], s45 offen offset:3072 sc1
    ds_read_b128 v[176:179], v227 offset:25600
    v_mfma_f32_16x16x32_bf16 v[124:127], v[180:183], v[148:151], v[124:127]
    v_sub_f32 v17, v16, v17
    v_rcp_f32 v12, v12
    v_mfma_f32_16x16x32_bf16 v[128:131], v[184:187], v[144:147], v[128:131]
    ds_read_b128 v[180:183], v227 offset:26624
    v_cvt_pk_bf16_f32 v10, v16, v17
    v_mfma_f32_16x16x32_bf16 v[132:135], v[184:187], v[148:151], v[132:135]
    s_waitcnt lgkmcnt(2)
    v_mfma_f32_16x16x32_bf16 v[80:83], v[160:163], v[152:155], v[80:83]
    ds_read_b128 v[184:187], v227 offset:27648
    v_mfma_f32_16x16x32_bf16 v[84:87], v[160:163], v[156:159], v[84:87]
    s_add_u32 s45, s49, 7424
    buffer_load_dwordx2 v[208:209], v15, s[32:35], s45 offen offset:3072 sc1
    v_mfma_f32_16x16x32_bf16 v[88:91], v[164:167], v[152:155], v[88:91]
    v_mfma_f32_16x16x32_bf16 v[92:95], v[164:167], v[156:159], v[92:95]
    v_mfma_f32_16x16x32_bf16 v[96:99], v[168:171], v[152:155], v[96:99]
    v_mfma_f32_16x16x32_bf16 v[100:103], v[168:171], v[156:159], v[100:103]
    v_mfma_f32_16x16x32_bf16 v[104:107], v[172:175], v[152:155], v[104:107]
    s_add_u32 s45, s49, 11136
    buffer_load_dwordx2 v[210:211], v15, s[32:35], s45 offen offset:3072 sc1
    v_mfma_f32_16x16x32_bf16 v[108:111], v[172:175], v[156:159], v[108:111]
    s_waitcnt lgkmcnt(0)
    v_mfma_f32_16x16x32_bf16 v[112:115], v[176:179], v[152:155], v[112:115]
    v_mfma_f32_16x16x32_bf16 v[116:119], v[176:179], v[156:159], v[116:119]
    v_mfma_f32_16x16x32_bf16 v[120:123], v[180:183], v[152:155], v[120:123]
    v_mfma_f32_16x16x32_bf16 v[124:127], v[180:183], v[156:159], v[124:127]
    s_add_u32 s45, s95, 14848
    buffer_load_dwordx4 v[212:215], v232, s[32:35], s45 offen offset:0 sc1
    v_mfma_f32_16x16x32_bf16 v[128:131], v[184:187], v[152:155], v[128:131]
    v_mfma_f32_16x16x32_bf16 v[132:135], v[184:187], v[156:159], v[132:135]
    v_mfma_f32_16x16x4_4b_bf16 v[80:95], v[248:249], v[10:11], v[80:95]
    v_mfma_f32_16x16x4_4b_bf16 v[96:111], v[250:251], v[10:11], v[96:111]
    v_mfma_f32_16x16x4_4b_bf16 v[112:127], v[252:253], v[10:11], v[112:127]
    s_nop 2
    v_mfma_f32_16x16x4_4b_bf16 v[128:143], v[254:255], v[10:11], v[128:143]
    buffer_load_dwordx4 v[188:191], v232, s[32:35], s45 offen offset:1024 sc1
    s_mul_i32 s71, s81, 3712
    s_add_u32 s71, s71, 24772608
    v_lshrrev_b32 v9, 1, v232
    v_lshrrev_b32 v13, 2, v232
    s_mov_b32 exec_hi, 0
    buffer_store_dword v12, v13, s[32:35], s71 offen offset:3584 sc1
    s_mov_b32 exec_hi, -1
    v_max_f32 v80, 0, v80
    v_max_f32 v81, 0, v81
    v_max_f32 v82, 0, v82
    v_max_f32 v83, 0, v83
    v_pk_mul_f32 v[80:81], v[80:81], v[88:89]
    v_pk_mul_f32 v[82:83], v[82:83], v[90:91]
    v_max_f32 v96, 0, v96
    s_add_u32 s45, s95, 18560
    buffer_load_dwordx4 v[192:195], v232, s[32:35], s45 offen offset:0 sc1
    v_max_f32 v97, 0, v97
    v_max_f32 v98, 0, v98
    v_max_f32 v99, 0, v99
    v_pk_mul_f32 v[96:97], v[96:97], v[104:105]
    v_pk_mul_f32 v[98:99], v[98:99], v[106:107]
    v_cvt_pk_bf16_f32 v88, v80, v81
    v_cvt_pk_bf16_f32 v89, v82, v83
    v_cvt_pk_bf16_f32 v90, v96, v97
    v_cvt_pk_bf16_f32 v91, v98, v99
    buffer_store_dwordx4 v[88:91], v232, s[32:35], s71 offen offset:0 sc1
    v_max_f32 v84, 0, v84
    v_max_f32 v85, 0, v85
    v_max_f32 v86, 0, v86
    v_max_f32 v87, 0, v87
    v_pk_mul_f32 v[84:85], v[84:85], v[92:93]
    v_pk_mul_f32 v[86:87], v[86:87], v[94:95]
    v_max_f32 v100, 0, v100
    v_max_f32 v101, 0, v101
    v_max_f32 v102, 0, v102
    v_max_f32 v103, 0, v103
    v_pk_mul_f32 v[100:101], v[100:101], v[108:109]
    v_pk_mul_f32 v[102:103], v[102:103], v[110:111]
    v_cvt_pk_bf16_f32 v92, v84, v85
    v_cvt_pk_bf16_f32 v93, v86, v87
    v_cvt_pk_bf16_f32 v94, v100, v101
    v_cvt_pk_bf16_f32 v95, v102, v103
    buffer_store_dwordx4 v[92:95], v232, s[32:35], s71 offen offset:1024 sc1
    s_waitcnt vmcnt(18)
    ds_read_b64_tr_b16 v[80:81], v243 offset:0
    ds_read_b64_tr_b16 v[82:83], v243 offset:512
    ds_read_b64_tr_b16 v[84:85], v243 offset:1024
    ds_read_b64_tr_b16 v[86:87], v243 offset:1536
    v_max_f32 v112, 0, v112
    v_max_f32 v113, 0, v113
    v_max_f32 v114, 0, v114
    v_max_f32 v115, 0, v115
    v_pk_mul_f32 v[112:113], v[112:113], v[120:121]
    v_pk_mul_f32 v[114:115], v[114:115], v[122:123]
    v_max_f32 v116, 0, v116
    v_max_f32 v117, 0, v117
    v_max_f32 v118, 0, v118
    v_max_f32 v119, 0, v119
    v_pk_mul_f32 v[116:117], v[116:117], v[124:125]
    v_pk_mul_f32 v[118:119], v[118:119], v[126:127]
    v_cvt_pk_bf16_f32 v120, v112, v113
    v_cvt_pk_bf16_f32 v121, v114, v115
    v_cvt_pk_bf16_f32 v122, v116, v117
    v_cvt_pk_bf16_f32 v123, v118, v119
    buffer_store_dwordx4 v[120:123], v232, s[32:35], s71 offen offset:2048 sc1
    v_permlane32_swap_b32 v128, v130
    v_permlane32_swap_b32 v129, v131
    v_permlane32_swap_b32 v132, v134
    v_permlane32_swap_b32 v133, v135
    v_max_f32 v128, 0, v128
    v_max_f32 v129, 0, v129
    v_pk_mul_f32 v[128:129], v[128:129], v[130:131]
    v_max_f32 v132, 0, v132
    v_max_f32 v133, 0, v133
    v_pk_mul_f32 v[132:133], v[132:133], v[134:135]
    v_cvt_pk_bf16_f32 v130, v128, v129
    v_cvt_pk_bf16_f32 v131, v132, v133
    s_waitcnt lgkmcnt(0)
    s_barrier
    v_mfma_f32_16x16x32_bf16 v[144:147], a[0:3], v[32:35], 0
    buffer_store_dwordx2 v[130:131], v9, s[32:35], s71 offen offset:3072 sc1
    v_mfma_f32_16x16x32_bf16 v[148:151], a[4:7], v[32:35], 0
    buffer_load_dwordx4 v[196:199], v232, s[32:35], s45 offen offset:1024 sc1
    v_mfma_f32_16x16x32_bf16 v[152:155], a[8:11], v[32:35], 0
    v_mfma_f32_16x16x32_bf16 v[156:159], a[12:15], v[32:35], 0
    v_mfma_f32_16x16x32_bf16 v[160:163], a[0:3], v[36:39], 0
    v_mfma_f32_16x16x32_bf16 v[164:167], a[4:7], v[36:39], 0
    v_mfma_f32_16x16x32_bf16 v[168:171], a[8:11], v[36:39], 0
    s_add_u32 s45, s95, 22272
    buffer_load_dwordx4 v[200:203], v232, s[32:35], s45 offen offset:0 sc1
    v_mfma_f32_16x16x32_bf16 v[172:175], a[12:15], v[36:39], 0
    v_mfma_f32_16x16x32_bf16 v[144:147], a[16:19], v[40:43], v[144:147]
    v_mfma_f32_16x16x32_bf16 v[148:151], a[20:23], v[40:43], v[148:151]
    v_mfma_f32_16x16x32_bf16 v[152:155], a[24:27], v[40:43], v[152:155]
    v_mfma_f32_16x16x32_bf16 v[156:159], a[28:31], v[40:43], v[156:159]
    buffer_load_dwordx4 v[16:19], v232, s[32:35], s45 offen offset:1024 sc1
    v_mfma_f32_16x16x32_bf16 v[160:163], a[16:19], v[44:47], v[160:163]
    v_mfma_f32_16x16x32_bf16 v[164:167], a[20:23], v[44:47], v[164:167]
    v_mfma_f32_16x16x32_bf16 v[168:171], a[24:27], v[44:47], v[168:171]
    v_mfma_f32_16x16x32_bf16 v[172:175], a[28:31], v[44:47], v[172:175]
    s_waitcnt vmcnt(22)
    v_mfma_f32_16x16x32_bf16 v[144:147], a[32:35], v[48:51], v[144:147]
    s_add_u32 s45, s95, 25984
    buffer_load_dwordx4 v[20:23], v232, s[32:35], s45 offen offset:0 sc1
    v_mfma_f32_16x16x32_bf16 v[148:151], a[36:39], v[48:51], v[148:151]
    v_mfma_f32_16x16x32_bf16 v[152:155], a[40:43], v[48:51], v[152:155]
    v_mfma_f32_16x16x32_bf16 v[156:159], a[44:47], v[48:51], v[156:159]
    s_waitcnt vmcnt(22)
    v_mfma_f32_16x16x32_bf16 v[160:163], a[32:35], v[52:55], v[160:163]
    v_mfma_f32_16x16x32_bf16 v[164:167], a[36:39], v[52:55], v[164:167]
    buffer_load_dwordx4 v[24:27], v232, s[32:35], s45 offen offset:1024 sc1
    v_mfma_f32_16x16x32_bf16 v[168:171], a[40:43], v[52:55], v[168:171]
    v_mfma_f32_16x16x32_bf16 v[172:175], a[44:47], v[52:55], v[172:175]
    s_waitcnt vmcnt(22)
    v_mfma_f32_16x16x32_bf16 v[144:147], a[48:51], v[56:59], v[144:147]
    v_mfma_f32_16x16x32_bf16 v[148:151], a[52:55], v[56:59], v[148:151]
    v_mfma_f32_16x16x32_bf16 v[152:155], a[56:59], v[56:59], v[152:155]
    s_add_u32 s45, s95, 14848
    buffer_load_dwordx4 v[28:31], v232, s[32:35], s45 offen offset:2048 sc1
    v_mfma_f32_16x16x32_bf16 v[156:159], a[60:63], v[56:59], v[156:159]
    s_waitcnt vmcnt(22)
    v_mfma_f32_16x16x32_bf16 v[160:163], a[48:51], v[60:63], v[160:163]
    v_mfma_f32_16x16x32_bf16 v[164:167], a[52:55], v[60:63], v[164:167]
    v_mfma_f32_16x16x32_bf16 v[168:171], a[56:59], v[60:63], v[168:171]
    v_mfma_f32_16x16x32_bf16 v[172:175], a[60:63], v[60:63], v[172:175]
    s_add_u32 s45, s95, 18560
    buffer_load_dwordx4 v[176:179], v232, s[32:35], s45 offen offset:2048 sc1
    s_waitcnt vmcnt(21)
    v_swap_b32 v66, v68
    v_swap_b32 v67, v69
    s_nop 1
    v_mfma_f32_16x16x32_bf16 v[144:147], a[64:67], v[64:67], v[144:147]
    v_mfma_f32_16x16x32_bf16 v[148:151], a[68:71], v[64:67], v[148:151]
    v_mfma_f32_16x16x32_bf16 v[152:155], a[72:75], v[64:67], v[152:155]
    v_mfma_f32_16x16x32_bf16 v[156:159], a[76:79], v[64:67], v[156:159]
    v_mfma_f32_16x16x32_bf16 v[160:163], a[64:67], v[68:71], v[160:163]
    s_add_u32 s45, s95, 22272
    buffer_load_dwordx4 v[180:183], v232, s[32:35], s45 offen offset:2048 sc1
    v_mfma_f32_16x16x32_bf16 v[164:167], a[68:71], v[68:71], v[164:167]
    v_mfma_f32_16x16x32_bf16 v[168:171], a[72:75], v[68:71], v[168:171]
    v_mfma_f32_16x16x32_bf16 v[172:175], a[76:79], v[68:71], v[172:175]
    s_waitcnt vmcnt(20)
    v_swap_b32 v74, v76
    v_swap_b32 v75, v77
    s_nop 1
    v_mfma_f32_16x16x32_bf16 v[144:147], a[80:83], v[72:75], v[144:147]
    v_mfma_f32_16x16x32_bf16 v[148:151], a[84:87], v[72:75], v[148:151]
    s_add_u32 s45, s95, 25984
    buffer_load_dwordx4 v[184:187], v232, s[32:35], s45 offen offset:2048 sc1
    v_mfma_f32_16x16x32_bf16 v[152:155], a[88:91], v[72:75], v[152:155]
    v_mfma_f32_16x16x32_bf16 v[156:159], a[92:95], v[72:75], v[156:159]
    v_mfma_f32_16x16x32_bf16 v[160:163], a[80:83], v[76:79], v[160:163]
    v_mfma_f32_16x16x32_bf16 v[164:167], a[84:87], v[76:79], v[164:167]
    v_mfma_f32_16x16x32_bf16 v[168:171], a[88:91], v[76:79], v[168:171]
    s_add_u32 s45, s95, 14848
    buffer_load_dwordx2 v[216:217], v15, s[32:35], s45 offen offset:3072 sc1
    v_mfma_f32_16x16x32_bf16 v[172:175], a[92:95], v[76:79], v[172:175]
    s_waitcnt vmcnt(18)
    v_swap_b32 v205, v206
    v_swap_b32 v209, v210
    v_swap_b32 v206, v208
    v_swap_b32 v207, v209
    s_nop 1
    v_mfma_f32_16x16x32_bf16 v[144:147], a[96:99], v[204:207], v[144:147]
    v_mfma_f32_16x16x32_bf16 v[148:151], a[100:103], v[204:207], v[148:151]
    v_mfma_f32_16x16x32_bf16 v[152:155], a[104:107], v[204:207], v[152:155]
    v_mfma_f32_16x16x32_bf16 v[156:159], a[108:111], v[204:207], v[156:159]
    s_add_u32 s45, s95, 18560
    buffer_load_dwordx2 v[218:219], v15, s[32:35], s45 offen offset:3072 sc1
    v_mfma_f32_16x16x32_bf16 v[160:163], a[96:99], v[208:211], v[160:163]
    v_mfma_f32_16x16x32_bf16 v[164:167], a[100:103], v[208:211], v[164:167]
    v_mfma_f32_16x16x32_bf16 v[168:171], a[104:107], v[208:211], v[168:171]
    v_mfma_f32_16x16x32_bf16 v[172:175], a[108:111], v[208:211], v[172:175]
    s_waitcnt vmcnt(18)
    v_mfma_f32_16x16x32_bf16 v[144:147], a[112:115], v[212:215], v[144:147]
    s_add_u32 s45, s95, 22272
    buffer_load_dwordx2 v[220:221], v15, s[32:35], s45 offen offset:3072 sc1
    v_mfma_f32_16x16x32_bf16 v[148:151], a[116:119], v[212:215], v[148:151]
    v_mfma_f32_16x16x32_bf16 v[152:155], a[120:123], v[212:215], v[152:155]
    s_waitcnt vmcnt(12)
    s_lshl_b32 s70, s81, 6
    s_add_u32 s70, s70, 65536
    v_mov_b32 v4, s46
    v_mov_b32 v5, s47
    v_mov_b32 v6, s70
    s_mov_b64 exec, 1
    buffer_store_dwordx2 v[4:5], v6, s[32:35], s62 offen sc1
    s_mov_b64 exec, -1
    v_mfma_f32_16x16x32_bf16 v[156:159], a[124:127], v[212:215], v[156:159]
    s_add_u32 s73, s62, 65536
    s_lshl_b32 s68, s54, 5
    v_mfma_f32_16x16x32_bf16 v[160:163], a[112:115], v[188:191], v[160:163]
    s_lshl_b32 s69, s44, 3
    s_add_u32 s68, s68, s69
    v_mfma_f32_16x16x32_bf16 v[164:167], a[116:119], v[188:191], v[164:167]
    s_add_u32 s45, s95, 25984
    buffer_load_dwordx2 v[222:223], v15, s[32:35], s45 offen offset:3072 sc1
    v_mfma_f32_16x16x32_bf16 v[168:171], a[120:123], v[188:191], v[168:171]
    v_and_b32 v8, 7, v1
    v_add_lshl_u32 v8, v8, s68, 6
    v_mfma_f32_16x16x32_bf16 v[172:175], a[124:127], v[188:191], v[172:175]
    v_mfma_f32_16x16x32_bf16 v[144:147], a[128:131], v[192:195], v[144:147]
    v_mfma_f32_16x16x32_bf16 v[148:151], a[132:135], v[192:195], v[148:151]
    v_mfma_f32_16x16x32_bf16 v[152:155], a[136:139], v[192:195], v[152:155]
    buffer_load_dword v224, v14, s[32:35], s49 offen offset:3584 sc1
    v_mfma_f32_16x16x32_bf16 v[156:159], a[140:143], v[192:195], v[156:159]
    s_waitcnt vmcnt(14)
    v_mfma_f32_16x16x32_bf16 v[160:163], a[128:131], v[196:199], v[160:163]
    v_mfma_f32_16x16x32_bf16 v[164:167], a[132:135], v[196:199], v[164:167]
    v_mfma_f32_16x16x32_bf16 v[168:171], a[136:139], v[196:199], v[168:171]
    v_mfma_f32_16x16x32_bf16 v[172:175], a[140:143], v[196:199], v[172:175]
    s_waitcnt vmcnt(13)
    v_mfma_f32_16x16x32_bf16 v[144:147], a[144:147], v[200:203], v[144:147]
    v_mfma_f32_16x16x32_bf16 v[148:151], a[148:151], v[200:203], v[148:151]
    v_mfma_f32_16x16x32_bf16 v[152:155], a[152:155], v[200:203], v[152:155]
    v_mfma_f32_16x16x32_bf16 v[156:159], a[156:159], v[200:203], v[156:159]
    s_waitcnt vmcnt(12)
    v_mfma_f32_16x16x32_bf16 v[160:163], a[144:147], v[16:19], v[160:163]
    v_mfma_f32_16x16x32_bf16 v[164:167], a[148:151], v[16:19], v[164:167]
    v_mfma_f32_16x16x32_bf16 v[168:171], a[152:155], v[16:19], v[168:171]
    v_mfma_f32_16x16x32_bf16 v[172:175], a[156:159], v[16:19], v[172:175]
    s_waitcnt vmcnt(11)
    v_mfma_f32_16x16x32_bf16 v[144:147], a[160:163], v[20:23], v[144:147]
    v_mfma_f32_16x16x32_bf16 v[148:151], a[164:167], v[20:23], v[148:151]
    v_mfma_f32_16x16x32_bf16 v[152:155], a[168:171], v[20:23], v[152:155]
    v_mfma_f32_16x16x32_bf16 v[156:159], a[172:175], v[20:23], v[156:159]
    s_waitcnt vmcnt(10)
    v_mfma_f32_16x16x32_bf16 v[160:163], a[160:163], v[24:27], v[160:163]
    v_mfma_f32_16x16x32_bf16 v[164:167], a[164:167], v[24:27], v[164:167]
    v_mfma_f32_16x16x32_bf16 v[168:171], a[168:171], v[24:27], v[168:171]
    v_mfma_f32_16x16x32_bf16 v[172:175], a[172:175], v[24:27], v[172:175]
    s_waitcnt vmcnt(8)
    v_swap_b32 v30, v176
    v_swap_b32 v31, v177
    s_nop 1
    v_mfma_f32_16x16x32_bf16 v[144:147], a[176:179], v[28:31], v[144:147]
    v_mfma_f32_16x16x32_bf16 v[148:151], a[180:183], v[28:31], v[148:151]
    v_mfma_f32_16x16x32_bf16 v[152:155], a[184:187], v[28:31], v[152:155]
    v_mfma_f32_16x16x32_bf16 v[156:159], a[188:191], v[28:31], v[156:159]
    v_mfma_f32_16x16x32_bf16 v[160:163], a[176:179], v[176:179], v[160:163]
    v_mfma_f32_16x16x32_bf16 v[164:167], a[180:183], v[176:179], v[164:167]
    v_mfma_f32_16x16x32_bf16 v[168:171], a[184:187], v[176:179], v[168:171]
    v_mfma_f32_16x16x32_bf16 v[172:175], a[188:191], v[176:179], v[172:175]
    s_waitcnt vmcnt(6)
    v_swap_b32 v182, v184
    v_swap_b32 v183, v185
    s_nop 1
    v_mfma_f32_16x16x32_bf16 v[144:147], a[192:195], v[180:183], v[144:147]
    v_mfma_f32_16x16x32_bf16 v[148:151], a[196:199], v[180:183], v[148:151]
    v_mfma_f32_16x16x32_bf16 v[152:155], a[200:203], v[180:183], v[152:155]
    v_mfma_f32_16x16x32_bf16 v[156:159], a[204:207], v[180:183], v[156:159]
    v_mfma_f32_16x16x32_bf16 v[160:163], a[192:195], v[184:187], v[160:163]
    v_mfma_f32_16x16x32_bf16 v[164:167], a[196:199], v[184:187], v[164:167]
    v_mfma_f32_16x16x32_bf16 v[168:171], a[200:203], v[184:187], v[168:171]
    v_mfma_f32_16x16x32_bf16 v[172:175], a[204:207], v[184:187], v[172:175]
    s_waitcnt vmcnt(1)
    v_swap_b32 v217, v218
    v_swap_b32 v221, v222
    v_swap_b32 v218, v220
    v_swap_b32 v219, v221
    s_nop 1
    v_mfma_f32_16x16x32_bf16 v[144:147], a[208:211], v[216:219], v[144:147]
    v_mfma_f32_16x16x32_bf16 v[148:151], a[212:215], v[216:219], v[148:151]
    v_mfma_f32_16x16x32_bf16 v[152:155], a[216:219], v[216:219], v[152:155]
    v_mfma_f32_16x16x32_bf16 v[156:159], a[220:223], v[216:219], v[156:159]
    v_mfma_f32_16x16x32_bf16 v[160:163], a[208:211], v[220:223], v[160:163]
    buffer_load_dwordx2 v[10:11], v8, s[32:35], s73 offen sc1
    v_mfma_f32_16x16x32_bf16 v[164:167], a[212:215], v[220:223], v[164:167]
    v_mfma_f32_16x16x32_bf16 v[168:171], a[216:219], v[220:223], v[168:171]
    v_mfma_f32_16x16x32_bf16 v[172:175], a[220:223], v[220:223], v[172:175]
    v_add_u32 v13, 134912, v232
    s_mul_i32 s68, s44, 6144
    v_lshlrev_b32 v128, 16, v80
    v_and_b32 v129, 0xffff0000, v80
    v_lshlrev_b32 v130, 16, v81
    v_and_b32 v131, 0xffff0000, v81
    v_lshlrev_b32 v132, 16, v82
    v_and_b32 v133, 0xffff0000, v82
    v_lshlrev_b32 v134, 16, v83
    v_and_b32 v135, 0xffff0000, v83
    s_cmp_lg_u32 s44, 0
    s_cbranch_scc1 red_25
    ds_write_b128 v13, v[152:155] offset:10240
    v_mov_b32 v120, v144
    ds_write_b128 v13, v[156:159] offset:11264
    v_mov_b32 v121, v145
    ds_write_b128 v13, v[160:163] offset:14336
    v_mov_b32 v122, v146
    ds_write_b128 v13, v[164:167] offset:15360
    v_mov_b32 v123, v147
    ds_write_b128 v13, v[168:171] offset:18432
    v_mov_b32 v124, v148
    ds_write_b128 v13, v[172:175] offset:19456
    v_mov_b32 v125, v149
    v_mov_b32 v126, v150
    v_mov_b32 v127, v151
    s_branch reddone_23
red_25:
    s_cmp_lg_u32 s44, 1
    s_cbranch_scc1 red_26
    ds_write_b128 v13, v[144:147] offset:0
    v_mov_b32 v120, v152
    ds_write_b128 v13, v[148:151] offset:1024
    v_mov_b32 v121, v153
    ds_write_b128 v13, v[160:163] offset:16384
    v_mov_b32 v122, v154
    ds_write_b128 v13, v[164:167] offset:17408
    v_mov_b32 v123, v155
    ds_write_b128 v13, v[168:171] offset:20480
    v_mov_b32 v124, v156
    ds_write_b128 v13, v[172:175] offset:21504
    v_mov_b32 v125, v157
    v_mov_b32 v126, v158
    v_mov_b32 v127, v159
    s_branch reddone_23
red_26:
    s_cmp_lg_u32 s44, 2
    s_cbranch_scc1 red_27
    ds_write_b128 v13, v[144:147] offset:2048
    v_mov_b32 v120, v160
    ds_write_b128 v13, v[148:151] offset:3072
    v_mov_b32 v121, v161
    ds_write_b128 v13, v[152:155] offset:6144
    v_mov_b32 v122, v162
    ds_write_b128 v13, v[156:159] offset:7168
    v_mov_b32 v123, v163
    ds_write_b128 v13, v[168:171] offset:22528
    v_mov_b32 v124, v164
    ds_write_b128 v13, v[172:175] offset:23552
    v_mov_b32 v125, v165
    v_mov_b32 v126, v166
    v_mov_b32 v127, v167
    s_branch reddone_23
red_27:
    ds_write_b128 v13, v[144:147] offset:4096
    v_mov_b32 v120, v168
    ds_write_b128 v13, v[148:151] offset:5120
    v_mov_b32 v121, v169
    ds_write_b128 v13, v[152:155] offset:8192
    v_mov_b32 v122, v170
    ds_write_b128 v13, v[156:159] offset:9216
    v_mov_b32 v123, v171
    ds_write_b128 v13, v[160:163] offset:12288
    v_mov_b32 v124, v172
    ds_write_b128 v13, v[164:167] offset:13312
    v_mov_b32 v125, v173
    v_mov_b32 v126, v174
    v_mov_b32 v127, v175
reddone_23:
    v_add_u32 v13, s68, v13
    s_waitcnt vmcnt(1)
    v_mov_b32 v225, v224
    s_waitcnt lgkmcnt(0)
    s_barrier
    ds_read_b128 v[144:147], v13 offset:0
    ds_read_b128 v[148:151], v13 offset:2048
    ds_read_b128 v[152:155], v13 offset:4096
    ds_read_b128 v[156:159], v13 offset:1024
    ds_read_b128 v[160:163], v13 offset:3072
    ds_read_b128 v[164:167], v13 offset:5120
    s_waitcnt vmcnt(0)
    v_cmp_ne_u64 s[86:87], s[46:47], v[10:11]
    s_nop 0
    s_cmp_eq_u64 s[86:87], 0
    s_cbranch_scc0 slow_28
ok_29:
    s_add_u32 s49, s49, 3801088
    s_add_u32 s95, s95, 3801088
    s_add_u32 s45, s49, 0
    buffer_load_dwordx4 v[32:35], v232, s[32:35], s45 offen offset:0 sc1
    buffer_load_dwordx4 v[36:39], v232, s[32:35], s45 offen offset:1024 sc1
    s_add_u32 s45, s49, 3712
    buffer_load_dwordx4 v[40:43], v232, s[32:35], s45 offen offset:0 sc1
    buffer_load_dwordx4 v[44:47], v232, s[32:35], s45 offen offset:1024 sc1
    s_add_u32 s45, s49, 7424
    buffer_load_dwordx4 v[48:51], v232, s[32:35], s45 offen offset:0 sc1
    buffer_load_dwordx4 v[52:55], v232, s[32:35], s45 offen offset:1024 sc1
    s_add_u32 s45, s49, 11136
    buffer_load_dwordx4 v[56:59], v232, s[32:35], s45 offen offset:0 sc1
    s_waitcnt lgkmcnt(5)
    v_pk_add_f32 v[120:121], v[120:121], v[144:145]
    v_pk_add_f32 v[122:123], v[122:123], v[146:147]
    s_waitcnt lgkmcnt(4)
    v_pk_add_f32 v[120:121], v[120:121], v[148:149]
    v_pk_add_f32 v[122:123], v[122:123], v[150:151]
    buffer_load_dwordx4 v[60:63], v232, s[32:35], s45 offen offset:1024 sc1
    s_waitcnt lgkmcnt(3)
    v_pk_add_f32 v[120:121], v[120:121], v[152:153]
    v_pk_add_f32 v[122:123], v[122:123], v[154:155]
    v_pk_fma_f32 v[120:121], v[120:121], v[224:225], v[128:129]
    v_pk_fma_f32 v[122:123], v[122:123], v[224:225], v[130:131]
    v_cvt_pk_bf16_f32 v136, v120, v121
    v_cvt_pk_bf16_f32 v137, v122, v123
    s_add_u32 s45, s49, 0
    buffer_load_dwordx4 v[64:67], v232, s[32:35], s45 offen offset:2048 sc1
    s_waitcnt lgkmcnt(2)
    v_pk_add_f32 v[124:125], v[124:125], v[156:157]
    v_pk_add_f32 v[126:127], v[126:127], v[158:159]
    s_waitcnt lgkmcnt(1)
    v_pk_add_f32 v[124:125], v[124:125], v[160:161]
    v_pk_add_f32 v[126:127], v[126:127], v[162:163]
    s_add_u32 s45, s49, 3712
    buffer_load_dwordx4 v[68:71], v232, s[32:35], s45 offen offset:2048 sc1
    s_waitcnt lgkmcnt(0)
    v_pk_add_f32 v[124:125], v[124:125], v[164:165]
    v_pk_add_f32 v[126:127], v[126:127], v[166:167]
    v_pk_fma_f32 v[124:125], v[124:125], v[224:225], v[132:133]
    v_pk_fma_f32 v[126:127], v[126:127], v[224:225], v[134:135]
    v_cvt_pk_bf16_f32 v138, v124, v125
    v_cvt_pk_bf16_f32 v139, v126, v127
    ds_write_b64 v244, v[136:137] offset:0
    ds_write_b64 v244, v[138:139] offset:32
    s_add_u32 s45, s49, 7424
    buffer_load_dwordx4 v[72:75], v232, s[32:35], s45 offen offset:2048 sc1
    v_pk_mul_f32 v[142:143], v[120:121], v[120:121]
    v_pk_add_f32 v[140:141], v[120:121], v[122:123]
    v_pk_fma_f32 v[142:143], v[122:123], v[122:123], v[142:143]
    v_pk_add_f32 v[140:141], v[140:141], v[124:125]
    v_pk_fma_f32 v[142:143], v[124:125], v[124:125], v[142:143]
    v_pk_add_f32 v[140:141], v[140:141], v[126:127]
    v_pk_fma_f32 v[142:143], v[126:127], v[126:127], v[142:143]
    v_add_f32 v140, v140, v141
    v_add_f32 v142, v142, v143
    s_add_u32 s45, s49, 11136
    buffer_load_dwordx4 v[76:79], v232, s[32:35], s45 offen offset:2048 sc1
    s_add_u32 s45, s49, 0
    buffer_load_dwordx2 v[204:205], v15, s[32:35], s45 offen offset:3072 sc1
    s_waitcnt lgkmcnt(0)
    s_barrier
    ds_read_b64_tr_b16 v[168:169], v245 offset:0
    ds_read_b64_tr_b16 v[170:171], v245 offset:544
    s_mov_b32 s72, 5242880
    s_waitcnt lgkmcnt(0)
    buffer_store_dwordx4 v[168:171], v246, s[32:35], s72 offen sc1
    v_mov_b32 v141, v140
    v_mov_b32 v143, v142
    s_nop 0
    v_permlane16_swap_b32 v140, v141
    v_permlane16_swap_b32 v142, v143
    v_add_f32 v140, v140, v141
    v_add_f32 v142, v142, v143
    s_add_u32 s45, s49, 3712
    buffer_load_dwordx2 v[206:207], v15, s[32:35], s45 offen offset:3072 sc1
    v_mov_b32 v141, v140
    v_mov_b32 v143, v142
    s_nop 0
    v_permlane32_swap_b32 v140, v141
    v_permlane32_swap_b32 v142, v143
    v_add_f32 v140, v140, v141
    v_add_f32 v142, v142, v143
    s_add_u32 s45, s49, 7424
    buffer_load_dwordx2 v[208:209], v15, s[32:35], s45 offen offset:3072 sc1
    s_mov_b32 s42, 0xffff0000
    s_mov_b32 s43, 0
    v_cndmask_b32 v140, v140, v142, s[42:43]
    s_mov_b32 s69, 344064
    s_mov_b32 exec_hi, 0
    buffer_atomic_add_f32 v140, v247, s[32:35], s69 offen
    s_mov_b32 exec_hi, -1
    s_add_u32 s45, s49, 11136
    buffer_load_dwordx2 v[210:211], v15, s[32:35], s45 offen offset:3072 sc1
    s_add_u32 s45, s95, 14848
    buffer_load_dwordx4 v[212:215], v232, s[32:35], s45 offen offset:0 sc1
    buffer_load_dwordx4 v[188:191], v232, s[32:35], s45 offen offset:1024 sc1
    s_add_u32 s45, s95, 18560
    buffer_load_dwordx4 v[192:195], v232, s[32:35], s45 offen offset:0 sc1
    s_waitcnt vmcnt(20)
    v_mfma_f32_16x16x32_bf16 v[88:91], a[0:3], v[32:35], 0
    v_mfma_f32_16x16x32_bf16 v[92:95], a[4:7], v[32:35], 0
    buffer_load_dwordx4 v[196:199], v232, s[32:35], s45 offen offset:1024 sc1
    v_mfma_f32_16x16x32_bf16 v[96:99], a[8:11], v[32:35], 0
    v_mfma_f32_16x16x32_bf16 v[100:103], a[12:15], v[32:35], 0
    s_waitcnt vmcnt(20)
    v_mfma_f32_16x16x32_bf16 v[104:107], a[0:3], v[36:39], 0
    v_mfma_f32_16x16x32_bf16 v[108:111], a[4:7], v[36:39], 0
    v_mfma_f32_16x16x32_bf16 v[112:115], a[8:11], v[36:39], 0
    s_add_u32 s45, s95, 22272
    buffer_load_dwordx4 v[200:203], v232, s[32:35], s45 offen offset:0 sc1
    v_mfma_f32_16x16x32_bf16 v[116:119], a[12:15], v[36:39], 0
    s_waitcnt vmcnt(20)
    v_mfma_f32_16x16x32_bf16 v[88:91], a[16:19], v[40:43], v[88:91]
    v_mfma_f32_16x16x32_bf16 v[92:95], a[20:23], v[40:43], v[92:95]
    v_mfma_f32_16x16x32_bf16 v[96:99], a[24:27], v[40:43], v[96:99]
    v_mfma_f32_16x16x32_bf16 v[100:103], a[28:31], v[40:43], v[100:103]
    buffer_load_dwordx4 v[16:19], v232, s[32:35], s45 offen offset:1024 sc1
    s_waitcnt vmcnt(20)
    v_mfma_f32_16x16x32_bf16 v[104:107], a[16:19], v[44:47], v[104:107]
    v_mfma_f32_16x16x32_bf16 v[108:111], a[20:23], v[44:47], v[108:111]
    v_mfma_f32_16x16x32_bf16 v[112:115], a[24:27], v[44:47], v[112:115]
    v_mfma_f32_16x16x32_bf16 v[116:119], a[28:31], v[44:47], v[116:119]
    s_waitcnt vmcnt(19)
    v_mfma_f32_16x16x32_bf16 v[88:91], a[32:35], v[48:51], v[88:91]
    s_add_u32 s45, s95, 25984
    buffer_load_dwordx4 v[20:23], v232, s[32:35], s45 offen offset:0 sc1
    v_mfma_f32_16x16x32_bf16 v[92:95], a[36:39], v[48:51], v[92:95]
    v_mfma_f32_16x16x32_bf16 v[96:99], a[40:43], v[48:51], v[96:99]
    v_mfma_f32_16x16x32_bf16 v[100:103], a[44:47], v[48:51], v[100:103]
    s_waitcnt vmcnt(19)
    v_mfma_f32_16x16x32_bf16 v[104:107], a[32:35], v[52:55], v[104:107]
    v_mfma_f32_16x16x32_bf16 v[108:111], a[36:39], v[52:55], v[108:111]
    buffer_load_dwordx4 v[24:27], v232, s[32:35], s45 offen offset:1024 sc1
    v_mfma_f32_16x16x32_bf16 v[112:115], a[40:43], v[52:55], v[112:115]
    v_mfma_f32_16x16x32_bf16 v[116:119], a[44:47], v[52:55], v[116:119]
    s_waitcnt vmcnt(19)
    v_mfma_f32_16x16x32_bf16 v[88:91], a[48:51], v[56:59], v[88:91]
    v_mfma_f32_16x16x32_bf16 v[92:95], a[52:55], v[56:59], v[92:95]
    v_mfma_f32_16x16x32_bf16 v[96:99], a[56:59], v[56:59], v[96:99]
    s_add_u32 s45, s95, 14848
    buffer_load_dwordx4 v[28:31], v232, s[32:35], s45 offen offset:2048 sc1
    v_mfma_f32_16x16x32_bf16 v[100:103], a[60:63], v[56:59], v[100:103]
    s_waitcnt vmcnt(19)
    v_mfma_f32_16x16x32_bf16 v[104:107], a[48:51], v[60:63], v[104:107]
    v_mfma_f32_16x16x32_bf16 v[108:111], a[52:55], v[60:63], v[108:111]
    v_mfma_f32_16x16x32_bf16 v[112:115], a[56:59], v[60:63], v[112:115]
    v_mfma_f32_16x16x32_bf16 v[116:119], a[60:63], v[60:63], v[116:119]
    s_add_u32 s45, s95, 18560
    buffer_load_dwordx4 v[176:179], v232, s[32:35], s45 offen offset:2048 sc1
    s_waitcnt vmcnt(18)
    v_swap_b32 v66, v68
    v_swap_b32 v67, v69
    s_nop 1
    v_mfma_f32_16x16x32_bf16 v[88:91], a[64:67], v[64:67], v[88:91]
    v_mfma_f32_16x16x32_bf16 v[92:95], a[68:71], v[64:67], v[92:95]
    v_mfma_f32_16x16x32_bf16 v[96:99], a[72:75], v[64:67], v[96:99]
    v_mfma_f32_16x16x32_bf16 v[100:103], a[76:79], v[64:67], v[100:103]
    v_mfma_f32_16x16x32_bf16 v[104:107], a[64:67], v[68:71], v[104:107]
    s_add_u32 s45, s95, 22272
    buffer_load_dwordx4 v[180:183], v232, s[32:35], s45 offen offset:2048 sc1
    v_mfma_f32_16x16x32_bf16 v[108:111], a[68:71], v[68:71], v[108:111]
    v_mfma_f32_16x16x32_bf16 v[112:115], a[72:75], v[68:71], v[112:115]
    v_mfma_f32_16x16x32_bf16 v[116:119], a[76:79], v[68:71], v[116:119]
    s_waitcnt vmcnt(17)
    v_swap_b32 v74, v76
    v_swap_b32 v75, v77
    s_nop 1
    v_mfma_f32_16x16x32_bf16 v[88:91], a[80:83], v[72:75], v[88:91]
    v_mfma_f32_16x16x32_bf16 v[92:95], a[84:87], v[72:75], v[92:95]
    s_add_u32 s45, s95, 25984
    buffer_load_dwordx4 v[184:187], v232, s[32:35], s45 offen offset:2048 sc1
    v_mfma_f32_16x16x32_bf16 v[96:99], a[88:91], v[72:75], v[96:99]
    v_mfma_f32_16x16x32_bf16 v[100:103], a[92:95], v[72:75], v[100:103]
    v_mfma_f32_16x16x32_bf16 v[104:107], a[80:83], v[76:79], v[104:107]
    s_waitcnt vmcnt(13)
    s_barrier
    s_cmp_lg_u32 s44, 1
    s_cbranch_scc1 nosig_30
    s_lshl_b32 s67, s2, 4
    s_add_u32 s67, s67, 229376
    v_lshl_add_u32 v6, v1, 12, s67
    v_mov_b32 v4, s46
    v_mov_b32 v5, s47
    s_mov_b64 exec, 0xff
    buffer_store_dwordx2 v[4:5], v6, s[32:35], 0 offen sc1
    s_mov_b64 exec, -1
nosig_30:
    v_mfma_f32_16x16x32_bf16 v[108:111], a[84:87], v[76:79], v[108:111]
    v_mfma_f32_16x16x32_bf16 v[112:115], a[88:91], v[76:79], v[112:115]
    s_add_u32 s45, s95, 14848
    buffer_load_dwordx2 v[216:217], v15, s[32:35], s45 offen offset:3072 sc1
    v_mfma_f32_16x16x32_bf16 v[116:119], a[92:95], v[76:79], v[116:119]
    s_waitcnt vmcnt(13)
    v_swap_b32 v205, v206
    v_swap_b32 v209, v210
    v_swap_b32 v206, v208
    v_swap_b32 v207, v209
    s_nop 1
    v_mfma_f32_16x16x32_bf16 v[88:91], a[96:99], v[204:207], v[88:91]
    v_mfma_f32_16x16x32_bf16 v[92:95], a[100:103], v[204:207], v[92:95]
    v_mfma_f32_16x16x32_bf16 v[96:99], a[104:107], v[204:207], v[96:99]
    v_mfma_f32_16x16x32_bf16 v[100:103], a[108:111], v[204:207], v[100:103]
    s_add_u32 s45, s95, 18560
    buffer_load_dwordx2 v[218:219], v15, s[32:35], s45 offen offset:3072 sc1
    v_mfma_f32_16x16x32_bf16 v[104:107], a[96:99], v[208:211], v[104:107]
    v_mfma_f32_16x16x32_bf16 v[108:111], a[100:103], v[208:211], v[108:111]
    v_mfma_f32_16x16x32_bf16 v[112:115], a[104:107], v[208:211], v[112:115]
    v_mfma_f32_16x16x32_bf16 v[116:119], a[108:111], v[208:211], v[116:119]
    s_waitcnt vmcnt(13)
    v_mfma_f32_16x16x32_bf16 v[88:91], a[112:115], v[212:215], v[88:91]
    s_add_u32 s45, s95, 22272
    buffer_load_dwordx2 v[220:221], v15, s[32:35], s45 offen offset:3072 sc1
    v_mfma_f32_16x16x32_bf16 v[92:95], a[116:119], v[212:215], v[92:95]
    v_mfma_f32_16x16x32_bf16 v[96:99], a[120:123], v[212:215], v[96:99]
    v_mfma_f32_16x16x32_bf16 v[100:103], a[124:127], v[212:215], v[100:103]
    s_waitcnt vmcnt(13)
    v_mfma_f32_16x16x32_bf16 v[104:107], a[112:115], v[188:191], v[104:107]
    v_mfma_f32_16x16x32_bf16 v[108:111], a[116:119], v[188:191], v[108:111]
    s_add_u32 s45, s95, 25984
    buffer_load_dwordx2 v[222:223], v15, s[32:35], s45 offen offset:3072 sc1
    v_mfma_f32_16x16x32_bf16 v[112:115], a[120:123], v[188:191], v[112:115]
    v_mfma_f32_16x16x32_bf16 v[116:119], a[124:127], v[188:191], v[116:119]
    s_waitcnt vmcnt(13)
    v_mfma_f32_16x16x32_bf16 v[88:91], a[128:131], v[192:195], v[88:91]
    v_mfma_f32_16x16x32_bf16 v[92:95], a[132:135], v[192:195], v[92:95]
    v_mfma_f32_16x16x32_bf16 v[96:99], a[136:139], v[192:195], v[96:99]
    buffer_load_dword v226, v14, s[32:35], s49 offen offset:3584 sc1
    v_mfma_f32_16x16x32_bf16 v[100:103], a[140:143], v[192:195], v[100:103]
    s_waitcnt vmcnt(13)
    v_mfma_f32_16x16x32_bf16 v[104:107], a[128:131], v[196:199], v[104:107]
    v_mfma_f32_16x16x32_bf16 v[108:111], a[132:135], v[196:199], v[108:111]
    v_mfma_f32_16x16x32_bf16 v[112:115], a[136:139], v[196:199], v[112:115]
    v_add_u32 v8, 114688, v231
    ds_write_b128 v8, a[224:227] offset:0
    v_mfma_f32_16x16x32_bf16 v[116:119], a[140:143], v[196:199], v[116:119]
    ds_write_b128 v8, a[228:231] offset:4160
    ds_write_b128 v8, a[232:235] offset:8320
    s_waitcnt vmcnt(12)
    v_mfma_f32_16x16x32_bf16 v[88:91], a[144:147], v[200:203], v[88:91]
    ds_write_b128 v8, a[236:239] offset:12480
    v_mfma_f32_16x16x32_bf16 v[92:95], a[148:151], v[200:203], v[92:95]
    v_mfma_f32_16x16x32_bf16 v[96:99], a[152:155], v[200:203], v[96:99]
    v_mfma_f32_16x16x32_bf16 v[100:103], a[156:159], v[200:203], v[100:103]
    s_waitcnt vmcnt(11)
    v_mfma_f32_16x16x32_bf16 v[104:107], a[144:147], v[16:19], v[104:107]
    v_mfma_f32_16x16x32_bf16 v[108:111], a[148:151], v[16:19], v[108:111]
    v_mfma_f32_16x16x32_bf16 v[112:115], a[152:155], v[16:19], v[112:115]
    v_mfma_f32_16x16x32_bf16 v[116:119], a[156:159], v[16:19], v[116:119]
    s_waitcnt vmcnt(10)
    v_mfma_f32_16x16x32_bf16 v[88:91], a[160:163], v[20:23], v[88:91]
    v_mfma_f32_16x16x32_bf16 v[92:95], a[164:167], v[20:23], v[92:95]
    v_mfma_f32_16x16x32_bf16 v[96:99], a[168:171], v[20:23], v[96:99]
    v_mfma_f32_16x16x32_bf16 v[100:103], a[172:175], v[20:23], v[100:103]
    s_waitcnt vmcnt(9)
    v_mfma_f32_16x16x32_bf16 v[104:107], a[160:163], v[24:27], v[104:107]
    v_mfma_f32_16x16x32_bf16 v[108:111], a[164:167], v[24:27], v[108:111]
    v_mfma_f32_16x16x32_bf16 v[112:115], a[168:171], v[24:27], v[112:115]
    v_mfma_f32_16x16x32_bf16 v[116:119], a[172:175], v[24:27], v[116:119]
    s_waitcnt vmcnt(7)
    v_swap_b32 v30, v176
    v_swap_b32 v31, v177
    s_nop 1
    v_mfma_f32_16x16x32_bf16 v[88:91], a[176:179], v[28:31], v[88:91]
    v_mfma_f32_16x16x32_bf16 v[92:95], a[180:183], v[28:31], v[92:95]
    v_mfma_f32_16x16x32_bf16 v[96:99], a[184:187], v[28:31], v[96:99]
    v_mfma_f32_16x16x32_bf16 v[100:103], a[188:191], v[28:31], v[100:103]
    v_mfma_f32_16x16x32_bf16 v[104:107], a[176:179], v[176:179], v[104:107]
    v_mfma_f32_16x16x32_bf16 v[108:111], a[180:183], v[176:179], v[108:111]
    v_mfma_f32_16x16x32_bf16 v[112:115], a[184:187], v[176:179], v[112:115]
    v_mfma_f32_16x16x32_bf16 v[116:119], a[188:191], v[176:179], v[116:119]
    s_waitcnt vmcnt(5)
    v_swap_b32 v182, v184
    v_swap_b32 v183, v185
    s_nop 1
    v_mfma_f32_16x16x32_bf16 v[88:91], a[192:195], v[180:183], v[88:91]
    v_mfma_f32_16x16x32_bf16 v[92:95], a[196:199], v[180:183], v[92:95]
    v_mfma_f32_16x16x32_bf16 v[96:99], a[200:203], v[180:183], v[96:99]
    v_mfma_f32_16x16x32_bf16 v[100:103], a[204:207], v[180:183], v[100:103]
    v_mfma_f32_16x16x32_bf16 v[104:107], a[192:195], v[184:187], v[104:107]
    v_mfma_f32_16x16x32_bf16 v[108:111], a[196:199], v[184:187], v[108:111]
    v_mfma_f32_16x16x32_bf16 v[112:115], a[200:203], v[184:187], v[112:115]
    v_mfma_f32_16x16x32_bf16 v[116:119], a[204:207], v[184:187], v[116:119]
    s_add_u32 s73, s80, 229376
    s_waitcnt vmcnt(1)
    v_swap_b32 v217, v218
    v_swap_b32 v221, v222
    v_swap_b32 v218, v220
    v_swap_b32 v219, v221
    s_nop 1
    v_mfma_f32_16x16x32_bf16 v[88:91], a[208:211], v[216:219], v[88:91]
    buffer_load_dwordx2 v[4:5], v231, s[32:35], s73 offen sc1
    v_mfma_f32_16x16x32_bf16 v[92:95], a[212:215], v[216:219], v[92:95]
    v_mfma_f32_16x16x32_bf16 v[96:99], a[216:219], v[216:219], v[96:99]
    v_mfma_f32_16x16x32_bf16 v[100:103], a[220:223], v[216:219], v[100:103]
    v_mfma_f32_16x16x32_bf16 v[104:107], a[208:211], v[220:223], v[104:107]
    v_mfma_f32_16x16x32_bf16 v[108:111], a[212:215], v[220:223], v[108:111]
    v_mfma_f32_16x16x32_bf16 v[112:115], a[216:219], v[220:223], v[112:115]
    v_mfma_f32_16x16x32_bf16 v[116:119], a[220:223], v[220:223], v[116:119]
    v_add_u32 v13, 134912, v232
    s_mul_i32 s68, s44, 6144
    v_lshlrev_b32 v128, 16, v84
    v_and_b32 v129, 0xffff0000, v84
    v_lshlrev_b32 v130, 16, v85
    v_and_b32 v131, 0xffff0000, v85
    v_lshlrev_b32 v132, 16, v86
    v_and_b32 v133, 0xffff0000, v86
    v_lshlrev_b32 v134, 16, v87
    v_and_b32 v135, 0xffff0000, v87
    s_cmp_lg_u32 s44, 0
    s_cbranch_scc1 red_33
    ds_write_b128 v13, v[96:99] offset:10240
    v_mov_b32 v120, v88
    ds_write_b128 v13, v[100:103] offset:11264
    v_mov_b32 v121, v89
    ds_write_b128 v13, v[104:107] offset:14336
    v_mov_b32 v122, v90
    ds_write_b128 v13, v[108:111] offset:15360
    v_mov_b32 v123, v91
    ds_write_b128 v13, v[112:115] offset:18432
    v_mov_b32 v124, v92
    ds_write_b128 v13, v[116:119] offset:19456
    v_mov_b32 v125, v93
    v_mov_b32 v126, v94
    v_mov_b32 v127, v95
    s_branch reddone_31
red_33:
    s_cmp_lg_u32 s44, 1
    s_cbranch_scc1 red_34
    ds_write_b128 v13, v[88:91] offset:0
    v_mov_b32 v120, v96
    ds_write_b128 v13, v[92:95] offset:1024
    v_mov_b32 v121, v97
    ds_write_b128 v13, v[104:107] offset:16384
    v_mov_b32 v122, v98
    ds_write_b128 v13, v[108:111] offset:17408
    v_mov_b32 v123, v99
    ds_write_b128 v13, v[112:115] offset:20480
    v_mov_b32 v124, v100
    ds_write_b128 v13, v[116:119] offset:21504
    v_mov_b32 v125, v101
    v_mov_b32 v126, v102
    v_mov_b32 v127, v103
    s_branch reddone_31
red_34:
    s_cmp_lg_u32 s44, 2
    s_cbranch_scc1 red_35
    ds_write_b128 v13, v[88:91] offset:2048
    v_mov_b32 v120, v104
    ds_write_b128 v13, v[92:95] offset:3072
    v_mov_b32 v121, v105
    ds_write_b128 v13, v[96:99] offset:6144
    v_mov_b32 v122, v106
    ds_write_b128 v13, v[100:103] offset:7168
    v_mov_b32 v123, v107
    ds_write_b128 v13, v[112:115] offset:22528
    v_mov_b32 v124, v108
    ds_write_b128 v13, v[116:119] offset:23552
    v_mov_b32 v125, v109
    v_mov_b32 v126, v110
    v_mov_b32 v127, v111
    s_branch reddone_31
red_35:
    ds_write_b128 v13, v[88:91] offset:4096
    v_mov_b32 v120, v112
    ds_write_b128 v13, v[92:95] offset:5120
    v_mov_b32 v121, v113
    ds_write_b128 v13, v[96:99] offset:8192
    v_mov_b32 v122, v114
    ds_write_b128 v13, v[100:103] offset:9216
    v_mov_b32 v123, v115
    ds_write_b128 v13, v[104:107] offset:12288
    v_mov_b32 v124, v116
    ds_write_b128 v13, v[108:111] offset:13312
    v_mov_b32 v125, v117
    v_mov_b32 v126, v118
    v_mov_b32 v127, v119
reddone_31:
    v_add_u32 v13, s68, v13
    s_waitcnt vmcnt(1)
    v_mov_b32 v227, v226
    s_waitcnt lgkmcnt(0)
    s_barrier
    ds_read_b128 v[144:147], v13 offset:0
    ds_read_b128 v[148:151], v13 offset:2048
    ds_read_b128 v[152:155], v13 offset:4096
    ds_read_b128 v[156:159], v13 offset:1024
    ds_read_b128 v[160:163], v13 offset:3072
    ds_read_b128 v[164:167], v13 offset:5120
    s_waitcnt lgkmcnt(5)
    v_pk_add_f32 v[120:121], v[120:121], v[144:145]
    v_pk_add_f32 v[122:123], v[122:123], v[146:147]
    s_waitcnt lgkmcnt(4)
    v_pk_add_f32 v[120:121], v[120:121], v[148:149]
    v_pk_add_f32 v[122:123], v[122:123], v[150:151]
    s_waitcnt lgkmcnt(3)
    v_pk_add_f32 v[120:121], v[120:121], v[152:153]
    v_pk_add_f32 v[122:123], v[122:123], v[154:155]
    v_pk_fma_f32 v[120:121], v[120:121], v[226:227], v[128:129]
    v_pk_fma_f32 v[122:123], v[122:123], v[226:227], v[130:131]
    v_cvt_pk_bf16_f32 v136, v120, v121
    v_cvt_pk_bf16_f32 v137, v122, v123
    s_waitcnt lgkmcnt(2)
    v_pk_add_f32 v[124:125], v[124:125], v[156:157]
    v_pk_add_f32 v[126:127], v[126:127], v[158:159]
    s_waitcnt lgkmcnt(1)
    v_pk_add_f32 v[124:125], v[124:125], v[160:161]
    v_pk_add_f32 v[126:127], v[126:127], v[162:163]
    s_waitcnt lgkmcnt(0)
    v_pk_add_f32 v[124:125], v[124:125], v[164:165]
    v_pk_add_f32 v[126:127], v[126:127], v[166:167]
    v_pk_fma_f32 v[124:125], v[124:125], v[226:227], v[132:133]
    v_pk_fma_f32 v[126:127], v[126:127], v[226:227], v[134:135]
    v_cvt_pk_bf16_f32 v138, v124, v125
    v_cvt_pk_bf16_f32 v139, v126, v127
    ds_write_b64 v244, v[136:137] offset:0
    ds_write_b64 v244, v[138:139] offset:32
    v_pk_mul_f32 v[142:143], v[120:121], v[120:121]
    v_pk_add_f32 v[140:141], v[120:121], v[122:123]
    v_pk_fma_f32 v[142:143], v[122:123], v[122:123], v[142:143]
    v_pk_add_f32 v[140:141], v[140:141], v[124:125]
    v_pk_fma_f32 v[142:143], v[124:125], v[124:125], v[142:143]
    v_pk_add_f32 v[140:141], v[140:141], v[126:127]
    v_pk_fma_f32 v[142:143], v[126:127], v[126:127], v[142:143]
    v_add_f32 v140, v140, v141
    v_add_f32 v142, v142, v143
    s_waitcnt vmcnt(0)
    v_cmp_ne_u64 s[86:87], s[46:47], v[4:5]
    s_nop 0
    s_cmp_eq_u64 s[86:87], 0
    s_cbranch_scc0 slow_36
ok_37:
    s_waitcnt lgkmcnt(0)
    s_barrier
    s_mov_b32 s68, 344064
    s_mov_b32 s69, 348160
    s_mov_b32 s70, 5242880
    s_mov_b32 s71, 5505024
    buffer_load_dwordx4 v[192:195], v231, s[32:35], s68 offen sc1
    buffer_load_dwordx4 v[196:199], v231, s[32:35], s69 offen sc1
    buffer_load_dwordx2 v[200:201], v235, s[32:35], s70 offen sc1
    buffer_load_dwordx2 v[202:203], v235, s[32:35], s70 offen offset:64 sc1
    buffer_load_dwordx2 v[204:205], v236, s[32:35], s70 offen sc1
    buffer_load_dwordx2 v[206:207], v236, s[32:35], s71 offen sc1
    ds_read_b64_tr_b16 v[168:169], v245 offset:0
    ds_read_b64_tr_b16 v[170:171], v245 offset:544
    s_mov_b32 s72, 6291456
    s_waitcnt lgkmcnt(0)
    buffer_store_dwordx4 v[168:171], v246, s[32:35], s72 offen sc1
    v_mov_b32 v141, v140
    v_mov_b32 v143, v142
    s_nop 0
    v_permlane16_swap_b32 v140, v141
    v_permlane16_swap_b32 v142, v143
    v_add_f32 v140, v140, v141
    v_add_f32 v142, v142, v143
    v_mov_b32 v141, v140
    v_mov_b32 v143, v142
    s_nop 0
    v_permlane32_swap_b32 v140, v141
    v_permlane32_swap_b32 v142, v143
    v_add_f32 v140, v140, v141
    v_add_f32 v142, v142, v143
    s_mov_b32 s42, 0xffff0000
    s_mov_b32 s43, 0
    v_cndmask_b32 v140, v140, v142, s[42:43]
    s_mov_b32 s69, 352256
    s_mov_b32 exec_hi, 0
    buffer_atomic_add_f32 v140, v247, s[32:35], s69 offen
    s_mov_b32 exec_hi, -1
    v_add_u32 v8, 114688, v231
    ds_write_b128 v8, a[240:243] offset:16640
    ds_write_b128 v8, a[244:247] offset:20800
    ds_write_b128 v8, a[248:251] offset:24960
    ds_write_b128 v8, a[252:255] offset:29120
    v_and_b32 v4, 3, v1
    v_bfe_u32 v5, v1, 2, 1
    v_mul_u32_u24 v4, 4160, v4
    v_mul_u32_u24 v5, 16640, v5
    v_add3_u32 v8, v4, v5, 0
    v_add_u32 v8, 118784, v8
    v_mov_b32 v6, 0
    v_mov_b32 v7, 0
    s_mov_b64 exec, 0xff
    ds_write_b64 v8, v[228:229]
    ds_write_b64 v8, v[6:7] offset:8
    ds_write_b64 v8, v[6:7] offset:16
    ds_write_b64 v8, v[6:7] offset:24
    s_mov_b64 exec, -1
    v_mov_b32 v4, 0
    v_mov_b32 v5, 0
    v_mov_b32 v6, 0
    v_mov_b32 v7, 0
    s_and_b32 s68, s44, 1
    s_mul_i32 s68, s68, 4608
    s_add_u32 s68, s68, 147968
    v_add_u32 v8, s68, v232
    s_mov_b64 exec, 0x3fffffff
    ds_write_b128 v8, v[4:7]
    s_mov_b64 exec, -1
    s_waitcnt lgkmcnt(0)
    s_barrier
    ds_read_b64 v[48:49], v233 offset:3776
    ds_read_b64 v[50:51], v233 offset:3784
    ds_read_b64 v[52:53], v233 offset:3264
    ds_read_b64 v[54:55], v233 offset:3272
    ds_read_b64 v[56:57], v233 offset:2752
    ds_read_b64 v[58:59], v233 offset:2760
    ds_read_b64 v[60:61], v233 offset:2240
    ds_read_b64 v[62:63], v233 offset:2248
    ds_read_b64 v[64:65], v233 offset:3712
    ds_read_b64 v[66:67], v233 offset:3720
    ds_read_b64 v[68:69], v233 offset:3200
    ds_read_b64 v[70:71], v233 offset:3208
    ds_read_b64 v[72:73], v233 offset:2688
    ds_read_b64 v[74:75], v233 offset:2696
    ds_read_b64 v[76:77], v233 offset:2176
    ds_read_b64 v[78:79], v233 offset:2184
    ds_read_b64 v[80:81], v233 offset:3648
    ds_read_b64 v[82:83], v233 offset:3656
    ds_read_b64 v[84:85], v233 offset:3136
    ds_read_b64 v[86:87], v233 offset:3144
    ds_read_b64 v[88:89], v233 offset:2624
    ds_read_b64 v[90:91], v233 offset:2632
    ds_read_b64 v[92:93], v233 offset:2112
    ds_read_b64 v[94:95], v233 offset:2120
    ds_read_b64 v[96:97], v233 offset:3584
    ds_read_b64 v[98:99], v233 offset:3592
    ds_read_b64 v[100:101], v233 offset:3072
    ds_read_b64 v[102:103], v233 offset:3080
    ds_read_b64 v[104:105], v233 offset:2560
    ds_read_b64 v[106:107], v233 offset:2568
    ds_read_b64 v[108:109], v233 offset:2048
    ds_read_b64 v[110:111], v233 offset:2056
    s_cmp_lt_u32 s44, 2
    s_cselect_b32 s40, s48, s50
    s_lshl_b32 s89, s44, 11
    s_add_u32 s89, s89, 157184
    s_xor_b32 s90, s44, 1
    s_lshl_b32 s90, s90, 11
    s_add_u32 s90, s90, 157184
    s_cmp_eq_u32 s44, 3
    s_cselect_b32 s89, 155104, s89
    s_cmp_eq_u32 s44, 2
    s_cselect_b32 s90, 155104, s90
    s_add_u32 s64, s80, 262144
    s_waitcnt vmcnt(2)
    v_mov_b32 v4, 0
    v_mov_b32 v5, 0x3727c5ac
    s_mov_b32 s72, 0x3b000000
    s_mov_b32 s73, 0x3b000000
    v_lshrrev_b32 v6, 1, v231
    v_add_u32 v6, 148448, v6
    v_pk_fma_f32 v[192:193], v[192:193], s[72:73], v[4:5]
    v_pk_fma_f32 v[194:195], v[194:195], s[72:73], v[4:5]
    v_pk_fma_f32 v[196:197], v[196:197], s[72:73], v[4:5]
    v_pk_fma_f32 v[198:199], v[198:199], s[72:73], v[4:5]
    v_fma_f32 v193, -v192, v192, v193
    v_fma_f32 v195, -v194, v194, v195
    v_fma_f32 v197, -v196, v196, v197
    v_fma_f32 v199, -v198, v198, v199
    v_max_f32 v193, v5, v193
    v_max_f32 v195, v5, v195
    v_max_f32 v197, v5, v197
    v_max_f32 v199, v5, v199
    v_rsq_f32 v112, v193
    v_lshlrev_b32 v120, 16, v200
    v_and_b32 v121, 0xffff0000, v200
    v_rsq_f32 v113, v195
    v_lshlrev_b32 v122, 16, v201
    v_and_b32 v123, 0xffff0000, v201
    v_rsq_f32 v114, v197
    v_lshlrev_b32 v124, 16, v202
    v_and_b32 v125, 0xffff0000, v202
    v_rsq_f32 v115, v199
    v_lshlrev_b32 v126, 16, v203
    v_and_b32 v127, 0xffff0000, v203
    v_mul_f32 v116, -v192, v112
    v_mul_f32 v117, -v194, v113
    v_mul_f32 v118, -v196, v114
    v_mul_f32 v119, -v198, v115
    v_pk_fma_f32 v[120:121], v[120:121], v[112:113], v[116:117]
    v_pk_fma_f32 v[122:123], v[122:123], v[114:115], v[118:119]
    v_cvt_pk_bf16_f32 v128, v120, v121
    v_cvt_pk_bf16_f32 v129, v122, v123
    ds_write_b64 v6, v[128:129] offset:0
    v_pk_fma_f32 v[124:125], v[124:125], v[112:113], v[116:117]
    v_pk_fma_f32 v[126:127], v[126:127], v[114:115], v[118:119]
    v_cvt_pk_bf16_f32 v130, v124, v125
    v_cvt_pk_bf16_f32 v131, v126, v127
    ds_write_b64 v6, v[130:131] offset:4608
    s_waitcnt lgkmcnt(0)
    s_barrier
    ds_read_b128 v[112:115], v234 offset:192
    ds_read_b128 v[116:119], v234 offset:704
    ds_read_b128 v[120:123], v234 offset:1216
    ds_read_b128 v[124:127], v234 offset:1728
    ds_read_b128 v[128:131], v234 offset:128
    s_waitcnt lgkmcnt(4)
    v_mfma_f32_16x16x32_bf16 v[16:19], v[48:51], v[112:115], 0
    ds_read_b128 v[132:135], v234 offset:640
    ds_read_b128 v[136:139], v234 offset:1152
    v_mfma_f32_16x16x32_bf16 v[20:23], v[52:55], v[112:115], 0
    ds_read_b128 v[140:143], v234 offset:1664
    ds_read_b128 v[144:147], v234 offset:64
    s_waitcnt lgkmcnt(7)
    v_mfma_f32_16x16x32_bf16 v[20:23], v[48:51], v[116:119], v[20:23]
    s_waitcnt vmcnt(0)
    s_barrier
    s_cmp_lg_u32 s44, 1
    s_cbranch_scc1 nosig_38
    s_lshl_b32 s67, s2, 4
    s_add_u32 s67, s67, 262144
    v_lshl_add_u32 v6, v1, 12, s67
    v_mov_b32 v4, s46
    v_mov_b32 v5, s47
    s_mov_b64 exec, 0xff
    buffer_store_dwordx2 v[4:5], v6, s[32:35], 0 offen sc1
    s_mov_b64 exec, -1
nosig_38:
    v_mfma_f32_16x16x32_bf16 v[24:27], v[52:55], v[116:119], 0
    ds_read_b128 v[148:151], v234 offset:576
    ds_read_b128 v[152:155], v234 offset:1088
    v_mfma_f32_16x16x32_bf16 v[24:27], v[56:59], v[112:115], v[24:27]
    ds_read_b128 v[156:159], v234 offset:1600
    ds_read_b128 v[160:163], v234 offset:0
    s_waitcnt lgkmcnt(10)
    v_mfma_f32_16x16x32_bf16 v[24:27], v[48:51], v[120:123], v[24:27]
    ds_read_b128 v[164:167], v234 offset:512
    ds_read_b128 v[168:171], v234 offset:1024
    v_mfma_f32_16x16x32_bf16 v[28:31], v[56:59], v[116:119], 0
    ds_read_b128 v[172:175], v234 offset:1536
    ds_read_b64 v[8:9], v238 offset:0
    v_mfma_f32_16x16x32_bf16 v[28:31], v[52:55], v[120:123], v[28:31]
    ds_read_b64 v[10:11], v238 offset:512
    ds_read_b64 v[176:177], v233 offset:1728
    v_mfma_f32_16x16x32_bf16 v[28:31], v[60:63], v[112:115], v[28:31]
    ds_read_b64 v[178:179], v233 offset:1736
    ds_read_b64 v[180:181], v233 offset:1216
    s_waitcnt lgkmcnt(15)
    v_mfma_f32_16x16x32_bf16 v[28:31], v[48:51], v[124:127], v[28:31]
    ds_read_b64 v[182:183], v233 offset:1224
    ds_read_b64 v[184:185], v233 offset:704
    v_mfma_f32_16x16x32_bf16 v[16:19], v[64:67], v[128:131], v[16:19]
    ds_read_b64 v[186:187], v233 offset:712
    ds_read_b64 v[188:189], v233 offset:192
    v_mfma_f32_16x16x32_bf16 v[20:23], v[68:71], v[128:131], v[20:23]
    ds_read_b64 v[190:191], v233 offset:200
    v_lshlrev_b32 v208, 16, v204
    v_mfma_f32_16x16x32_bf16 v[20:23], v[64:67], v[132:135], v[20:23]
    v_and_b32 v209, 0xffff0000, v204
    v_lshlrev_b32 v210, 16, v205
    v_mfma_f32_16x16x32_bf16 v[24:27], v[68:71], v[132:135], v[24:27]
    v_and_b32 v211, 0xffff0000, v205
    v_lshlrev_b32 v212, 16, v206
    v_mfma_f32_16x16x32_bf16 v[24:27], v[72:75], v[128:131], v[24:27]
    v_and_b32 v213, 0xffff0000, v206
    v_lshlrev_b32 v214, 16, v207
    s_waitcnt lgkmcnt(15)
    v_mfma_f32_16x16x32_bf16 v[24:27], v[64:67], v[136:139], v[24:27]
    v_and_b32 v215, 0xffff0000, v207
    s_waitcnt lgkmcnt(8)
    v_mfma_f32_16x16x32_bf16 v[28:31], v[72:75], v[132:135], v[28:31]
    v_lshlrev_b32 v12, 16, v8
    v_and_b32 v13, 0xffff0000, v8
    v_mfma_f32_16x16x32_bf16 v[28:31], v[68:71], v[136:139], v[28:31]
    v_fmac_f32 v208, s40, v12
    v_fmac_f32 v209, s40, v13
    v_mfma_f32_16x16x32_bf16 v[28:31], v[76:79], v[128:131], v[28:31]
    v_lshlrev_b32 v12, 16, v9
    v_and_b32 v13, 0xffff0000, v9
    v_mfma_f32_16x16x32_bf16 v[28:31], v[64:67], v[140:143], v[28:31]
    v_fmac_f32 v210, s40, v12
    v_fmac_f32 v211, s40, v13
    v_mfma_f32_16x16x32_bf16 v[16:19], v[80:83], v[144:147], v[16:19]
    v_lshlrev_b32 v12, 16, v10
    v_and_b32 v13, 0xffff0000, v10
    v_mfma_f32_16x16x32_bf16 v[20:23], v[84:87], v[144:147], v[20:23]
    v_fmac_f32 v212, s40, v12
    v_fmac_f32 v213, s40, v13
    v_mfma_f32_16x16x32_bf16 v[20:23], v[80:83], v[148:151], v[20:23]
    v_lshlrev_b32 v12, 16, v11
    v_and_b32 v13, 0xffff0000, v11
    v_mfma_f32_16x16x32_bf16 v[24:27], v[84:87], v[148:151], v[24:27]
    v_fmac_f32 v214, s40, v12
    v_fmac_f32 v215, s40, v13
    v_mfma_f32_16x16x32_bf16 v[24:27], v[88:91], v[144:147], v[24:27]
    v_mfma_f32_16x16x32_bf16 v[24:27], v[80:83], v[152:155], v[24:27]
    v_mfma_f32_16x16x32_bf16 v[28:31], v[88:91], v[148:151], v[28:31]
    v_mfma_f32_16x16x32_bf16 v[28:31], v[84:87], v[152:155], v[28:31]
    v_mfma_f32_16x16x32_bf16 v[28:31], v[92:95], v[144:147], v[28:31]
    v_mfma_f32_16x16x32_bf16 v[28:31], v[80:83], v[156:159], v[28:31]
    v_mfma_f32_16x16x32_bf16 v[16:19], v[96:99], v[160:163], v[16:19]
    v_mfma_f32_16x16x32_bf16 v[20:23], v[100:103], v[160:163], v[20:23]
    v_mfma_f32_16x16x32_bf16 v[20:23], v[96:99], v[164:167], v[20:23]
    v_mfma_f32_16x16x32_bf16 v[24:27], v[100:103], v[164:167], v[24:27]
    v_mfma_f32_16x16x32_bf16 v[24:27], v[104:107], v[160:163], v[24:27]
    v_mfma_f32_16x16x32_bf16 v[24:27], v[96:99], v[168:171], v[24:27]
    v_mfma_f32_16x16x32_bf16 v[28:31], v[104:107], v[164:167], v[28:31]
    v_mfma_f32_16x16x32_bf16 v[28:31], v[100:103], v[168:171], v[28:31]
    v_mfma_f32_16x16x32_bf16 v[28:31], v[108:111], v[160:163], v[28:31]
    v_mfma_f32_16x16x32_bf16 v[28:31], v[96:99], v[172:175], v[28:31]
    v_add_u32 v14, s89, v232
    s_bitcmp1_b32 s44, 0
    s_cbranch_scc1 xodd_39
    s_nop 3
    ds_write_b128 v14, v[24:27] offset:0
    ds_write_b128 v14, v[28:31] offset:1024
    v_add_f32 v208, v208, v16
    v_add_f32 v209, v209, v17
    v_add_f32 v210, v210, v18
    v_add_f32 v211, v211, v19
    v_add_f32 v212, v212, v20
    v_add_f32 v213, v213, v21
    v_add_f32 v214, v214, v22
    v_add_f32 v215, v215, v23
    s_branch xdone_40
xodd_39:
    s_nop 3
    ds_write_b128 v14, v[16:19] offset:0
    ds_write_b128 v14, v[20:23] offset:1024
    v_add_f32 v208, v208, v24
    v_add_f32 v209, v209, v25
    v_add_f32 v210, v210, v26
    v_add_f32 v211, v211, v27
    v_add_f32 v212, v212, v28
    v_add_f32 v213, v213, v29
    v_add_f32 v214, v214, v30
    v_add_f32 v215, v215, v31
xdone_40:
    s_waitcnt lgkmcnt(0)
    s_barrier
    v_mfma_f32_16x16x32_bf16 v[32:35], v[52:55], v[124:127], 0
    v_add_u32 v14, s90, v232
    ds_read_b128 v[4:7], v14
    v_mfma_f32_16x16x32_bf16 v[32:35], v[56:59], v[120:123], v[32:35]
    ds_read_b128 v[8:11], v14 offset:1024
    s_mov_b32 s72, 7340032
    v_mfma_f32_16x16x32_bf16 v[36:39], v[56:59], v[124:127], 0
    v_mfma_f32_16x16x32_bf16 v[32:35], v[60:63], v[116:119], v[32:35]
    v_mfma_f32_16x16x32_bf16 v[36:39], v[60:63], v[120:123], v[36:39]
    ds_read_b64 v[192:193], v233 offset:1664
    v_mfma_f32_16x16x32_bf16 v[40:43], v[60:63], v[124:127], 0
    ds_read_b64 v[194:195], v233 offset:1672
    s_waitcnt lgkmcnt(2)
    v_add_f32 v208, v208, v4
    v_mfma_f32_16x16x32_bf16 v[32:35], v[176:179], v[112:115], v[32:35]
    ds_read_b64 v[196:197], v233 offset:1152
    v_add_f32 v209, v209, v5
    v_add_f32 v210, v210, v6
    v_mfma_f32_16x16x32_bf16 v[36:39], v[176:179], v[116:119], v[36:39]
    ds_read_b64 v[198:199], v233 offset:1160
    v_add_f32 v211, v211, v7
    v_add_f32 v212, v212, v8
    v_mfma_f32_16x16x32_bf16 v[40:43], v[176:179], v[120:123], v[40:43]
    ds_read_b64 v[200:201], v233 offset:640
    buffer_load_dwordx2 v[12:13], v231, s[32:35], s64 offen sc1
    v_add_f32 v213, v213, v9
    v_mfma_f32_16x16x32_bf16 v[44:47], v[176:179], v[124:127], 0
    ds_read_b64 v[202:203], v233 offset:648
    v_add_f32 v214, v214, v10
    v_add_f32 v215, v215, v11
    v_mfma_f32_16x16x32_bf16 v[36:39], v[180:183], v[112:115], v[36:39]
    ds_read_b64 v[204:205], v233 offset:128
    v_cvt_pk_bf16_f32 v4, v208, v209
    v_cvt_pk_bf16_f32 v5, v210, v211
    v_mfma_f32_16x16x32_bf16 v[40:43], v[180:183], v[116:119], v[40:43]
    ds_read_b64 v[206:207], v233 offset:136
    v_cvt_pk_bf16_f32 v6, v212, v213
    v_cvt_pk_bf16_f32 v7, v214, v215
    v_mfma_f32_16x16x32_bf16 v[44:47], v[180:183], v[120:123], v[44:47]
    v_mfma_f32_16x16x32_bf16 v[40:43], v[184:187], v[112:115], v[40:43]
    v_permlane16_swap_b32 v4, v6
    v_permlane16_swap_b32 v5, v7
    v_mfma_f32_16x16x32_bf16 v[44:47], v[184:187], v[116:119], v[44:47]
    buffer_store_dwordx4 v[4:7], v237, s[32:35], s72 offen sc1
    v_mfma_f32_16x16x32_bf16 v[44:47], v[188:191], v[112:115], v[44:47]
    v_mfma_f32_16x16x32_bf16 v[32:35], v[68:71], v[140:143], v[32:35]
    s_lshl_b32 s83, s52, 2
    s_add_u32 s83, s83, s44
    v_mfma_f32_16x16x32_bf16 v[32:35], v[72:75], v[136:139], v[32:35]
    s_lshl_b32 s81, s83, 5
    s_add_u32 s81, s81, s53
    v_mfma_f32_16x16x32_bf16 v[36:39], v[72:75], v[140:143], v[36:39]
    ds_read_b64 v[176:177], v233 offset:1600
    s_lshr_b32 s83, s83, 1
    v_mfma_f32_16x16x32_bf16 v[32:35], v[76:79], v[132:135], v[32:35]
    ds_read_b64 v[178:179], v233 offset:1608
    s_lshl_b32 s83, s83, 16
    v_mfma_f32_16x16x32_bf16 v[36:39], v[76:79], v[136:139], v[36:39]
    ds_read_b64 v[180:181], v233 offset:1088
    s_add_u32 s83, s83, 7340032
    v_mfma_f32_16x16x32_bf16 v[40:43], v[76:79], v[140:143], v[40:43]
    ds_read_b64 v[182:183], v233 offset:1096
    s_waitcnt lgkmcnt(10)
    v_mfma_f32_16x16x32_bf16 v[32:35], v[192:195], v[128:131], v[32:35]
    ds_read_b64 v[184:185], v233 offset:576
    v_mfma_f32_16x16x32_bf16 v[36:39], v[192:195], v[132:135], v[36:39]
    ds_read_b64 v[186:187], v233 offset:584
    v_mfma_f32_16x16x32_bf16 v[40:43], v[192:195], v[136:139], v[40:43]
    ds_read_b64 v[188:189], v233 offset:64
    v_mfma_f32_16x16x32_bf16 v[44:47], v[192:195], v[140:143], v[44:47]
    ds_read_b64 v[190:191], v233 offset:72
    s_waitcnt lgkmcnt(12)
    v_mfma_f32_16x16x32_bf16 v[36:39], v[196:199], v[128:131], v[36:39]
    s_lshr_b32 s74, s53, 2
    s_and_b32 s74, s74, 6
    v_mfma_f32_16x16x32_bf16 v[40:43], v[196:199], v[132:135], v[40:43]
    s_lshl_b32 s82, s44, 1
    s_add_u32 s74, s74, s82
    v_mfma_f32_16x16x32_bf16 v[44:47], v[196:199], v[136:139], v[44:47]
    s_and_b32 s74, s74, 7
    s_lshl_b32 s82, s74, 12
    s_waitcnt lgkmcnt(10)
    v_mfma_f32_16x16x32_bf16 v[40:43], v[200:203], v[128:131], v[40:43]
    s_add_u32 s82, s82, s83
    s_add_u32 s74, s44, 0
    v_mfma_f32_16x16x32_bf16 v[44:47], v[200:203], v[132:135], v[44:47]
    s_and_b32 s74, s74, 3
    s_mul_i32 s74, s74, 28672
    s_waitcnt lgkmcnt(8)
    v_mfma_f32_16x16x32_bf16 v[44:47], v[204:207], v[128:131], v[44:47]
    v_add_u32 v221, s74, v232
    s_add_u32 s74, s44, 1
    v_mfma_f32_16x16x32_bf16 v[32:35], v[84:87], v[156:159], v[32:35]
    s_and_b32 s74, s74, 3
    s_mul_i32 s74, s74, 28672
    v_mfma_f32_16x16x32_bf16 v[32:35], v[88:91], v[152:155], v[32:35]
    v_add_u32 v222, s74, v232
    s_add_u32 s74, s44, 2
    v_mfma_f32_16x16x32_bf16 v[36:39], v[88:91], v[156:159], v[36:39]
    ds_read_b64 v[192:193], v233 offset:1536
    s_and_b32 s74, s74, 3
    v_mfma_f32_16x16x32_bf16 v[32:35], v[92:95], v[148:151], v[32:35]
    ds_read_b64 v[194:195], v233 offset:1544
    s_mul_i32 s74, s74, 28672
    v_mfma_f32_16x16x32_bf16 v[36:39], v[92:95], v[152:155], v[36:39]
    ds_read_b64 v[196:197], v233 offset:1024
    v_add_u32 v223, s74, v232
    v_mfma_f32_16x16x32_bf16 v[40:43], v[92:95], v[156:159], v[40:43]
    ds_read_b64 v[198:199], v233 offset:1032
    s_add_u32 s74, s44, 3
    s_waitcnt lgkmcnt(10)
    v_mfma_f32_16x16x32_bf16 v[32:35], v[176:179], v[144:147], v[32:35]
    ds_read_b64 v[200:201], v233 offset:512
    s_and_b32 s74, s74, 3
    v_mfma_f32_16x16x32_bf16 v[36:39], v[176:179], v[148:151], v[36:39]
    ds_read_b64 v[202:203], v233 offset:520
    s_mul_i32 s74, s74, 28672
    v_mfma_f32_16x16x32_bf16 v[40:43], v[176:179], v[152:155], v[40:43]
    ds_read_b64 v[204:205], v233 offset:0
    v_add_u32 v227, s74, v232
    v_mfma_f32_16x16x32_bf16 v[44:47], v[176:179], v[156:159], v[44:47]
    ds_read_b64 v[206:207], v233 offset:8
    s_bfe_u32 s74, s53, 65538
    s_waitcnt lgkmcnt(12)
    v_mfma_f32_16x16x32_bf16 v[36:39], v[180:183], v[144:147], v[36:39]
    s_lshl_b32 s75, s74, 5
    v_xor_b32 v226, s75, v240
    v_mfma_f32_16x16x32_bf16 v[40:43], v[180:183], v[148:151], v[40:43]
    s_lshr_b32 s75, s81, 5
    s_lshl_b32 s75, s75, 12
    v_mfma_f32_16x16x32_bf16 v[44:47], v[180:183], v[152:155], v[44:47]
    s_waitcnt vmcnt(1)
    v_cmp_ne_u64 s[86:87], s[46:47], v[12:13]
    s_nop 0
    s_cmp_eq_u64 s[86:87], 0
    s_cbranch_scc0 slow_41
ok_42:
    s_barrier
    s_mov_b32 s68, 352256
    s_mov_b32 s69, 356352
    s_mov_b32 s70, 6291456
    s_mov_b32 s71, 6553600
    buffer_load_dwordx4 v[112:115], v231, s[32:35], s68 offen sc1
    buffer_load_dwordx4 v[116:119], v231, s[32:35], s69 offen sc1
    buffer_load_dwordx2 v[120:121], v235, s[32:35], s70 offen sc1
    buffer_load_dwordx2 v[122:123], v235, s[32:35], s70 offen offset:64 sc1
    buffer_load_dwordx2 v[216:217], v236, s[32:35], s70 offen sc1
    buffer_load_dwordx2 v[218:219], v236, s[32:35], s71 offen sc1
    s_waitcnt lgkmcnt(10)
    v_mfma_f32_16x16x32_bf16 v[40:43], v[184:187], v[144:147], v[40:43]
    v_and_b32 v224, 31, v1
    v_lshrrev_b32 v225, 5, v1
    v_mfma_f32_16x16x32_bf16 v[44:47], v[184:187], v[148:151], v[44:47]
    v_lshlrev_b32 v225, 10, v225
    v_lshl_add_u32 v224, v224, 4, v225
    s_waitcnt lgkmcnt(8)
    v_mfma_f32_16x16x32_bf16 v[44:47], v[188:191], v[144:147], v[44:47]
    v_add_u32 v224, s75, v224
    s_lshl_b32 s74, s74, 8
    v_mfma_f32_16x16x32_bf16 v[32:35], v[100:103], v[172:175], v[32:35]
    s_add_u32 s75, s75, s74
    s_lshr_b32 s74, s53, 2
    v_mfma_f32_16x16x32_bf16 v[32:35], v[104:107], v[168:171], v[32:35]
    s_and_b32 s74, s74, 6
    s_lshl_b32 s76, s44, 1
    v_mfma_f32_16x16x32_bf16 v[36:39], v[104:107], v[172:175], v[36:39]
    s_add_u32 s74, s74, s76
    s_and_b32 s74, s74, 7
    v_mfma_f32_16x16x32_bf16 v[32:35], v[108:111], v[164:167], v[32:35]
    s_lshl_b32 s74, s74, 8
    s_add_u32 s75, s75, s74
    v_mfma_f32_16x16x32_bf16 v[36:39], v[108:111], v[168:171], v[36:39]
    v_lshl_add_u32 v225, v2, 4, s75
    s_mov_b32 s62, 655360
    v_mfma_f32_16x16x32_bf16 v[40:43], v[108:111], v[172:175], v[40:43]
    s_waitcnt lgkmcnt(6)
    v_mfma_f32_16x16x32_bf16 v[32:35], v[192:195], v[160:163], v[32:35]
    v_mfma_f32_16x16x32_bf16 v[36:39], v[192:195], v[164:167], v[36:39]
    v_mfma_f32_16x16x32_bf16 v[40:43], v[192:195], v[168:171], v[40:43]
    s_waitcnt vmcnt(6)
    s_barrier
    s_cmp_lg_u32 s44, 1
    s_cbranch_scc1 nosig_43
    s_lshl_b32 s67, s2, 4
    s_add_u32 s67, s67, 163840
    v_lshl_add_u32 v6, v1, 12, s67
    v_mov_b32 v4, s46
    v_mov_b32 v5, s47
    s_mov_b64 exec, 0xff
    buffer_store_dwordx2 v[4:5], v6, s[32:35], 0 offen sc1
    s_mov_b64 exec, -1
nosig_43:
    v_mfma_f32_16x16x32_bf16 v[44:47], v[192:195], v[172:175], v[44:47]
    s_waitcnt lgkmcnt(4)
    v_mfma_f32_16x16x32_bf16 v[36:39], v[196:199], v[160:163], v[36:39]
    v_mfma_f32_16x16x32_bf16 v[40:43], v[196:199], v[164:167], v[40:43]
    v_mfma_f32_16x16x32_bf16 v[44:47], v[196:199], v[168:171], v[44:47]
    s_waitcnt lgkmcnt(2)
    v_mfma_f32_16x16x32_bf16 v[40:43], v[200:203], v[160:163], v[40:43]
    v_mfma_f32_16x16x32_bf16 v[44:47], v[200:203], v[164:167], v[44:47]
    s_waitcnt lgkmcnt(0)
    v_mfma_f32_16x16x32_bf16 v[44:47], v[204:207], v[160:163], v[44:47]
    s_waitcnt vmcnt(2)
    v_mov_b32 v4, 0
    v_mov_b32 v5, 0x3727c5ac
    s_mov_b32 s72, 0x3b000000
    s_mov_b32 s73, 0x3b000000
    v_lshrrev_b32 v6, 1, v231
    v_add_u32 v6, 150496, v6
    v_pk_fma_f32 v[112:113], v[112:113], s[72:73], v[4:5]
    v_pk_fma_f32 v[114:115], v[114:115], s[72:73], v[4:5]
    v_pk_fma_f32 v[116:117], v[116:117], s[72:73], v[4:5]
    v_pk_fma_f32 v[118:119], v[118:119], s[72:73], v[4:5]
    v_fma_f32 v113, -v112, v112, v113
    v_fma_f32 v115, -v114, v114, v115
    v_fma_f32 v117, -v116, v116, v117
    v_fma_f32 v119, -v118, v118, v119
    v_max_f32 v113, v5, v113
    v_max_f32 v115, v5, v115
    v_max_f32 v117, v5, v117
    v_max_f32 v119, v5, v119
    v_rsq_f32 v128, v113
    v_lshlrev_b32 v136, 16, v120
    v_and_b32 v137, 0xffff0000, v120
    v_rsq_f32 v129, v115
    v_lshlrev_b32 v138, 16, v121
    v_and_b32 v139, 0xffff0000, v121
    v_rsq_f32 v130, v117
    v_lshlrev_b32 v140, 16, v122
    v_and_b32 v141, 0xffff0000, v122
    v_rsq_f32 v131, v119
    v_lshlrev_b32 v142, 16, v123
    v_and_b32 v143, 0xffff0000, v123
    v_mul_f32 v132, -v112, v128
    v_mul_f32 v133, -v114, v129
    v_mul_f32 v134, -v116, v130
    v_mul_f32 v135, -v118, v131
    v_pk_fma_f32 v[136:137], v[136:137], v[128:129], v[132:133]
    v_pk_fma_f32 v[138:139], v[138:139], v[130:131], v[134:135]
    v_cvt_pk_bf16_f32 v144, v136, v137
    v_cvt_pk_bf16_f32 v145, v138, v139
    ds_write_b64 v6, v[144:145] offset:0
    v_pk_fma_f32 v[140:141], v[140:141], v[128:129], v[132:133]
    v_pk_fma_f32 v[142:143], v[142:143], v[130:131], v[134:135]
    v_cvt_pk_bf16_f32 v146, v140, v141
    v_cvt_pk_bf16_f32 v147, v142, v143
    ds_write_b64 v6, v[146:147] offset:4608
    s_waitcnt lgkmcnt(0)
    s_barrier
    ds_read_b128 v[112:115], v234 offset:2240
    ds_read_b128 v[116:119], v234 offset:2752
    ds_read_b128 v[120:123], v234 offset:3264
    ds_read_b128 v[124:127], v234 offset:3776
    s_add_u32 s73, s80, 163840
    s_waitcnt lgkmcnt(3)
    v_mfma_f32_16x16x32_bf16 v[32:35], v[48:51], v[112:115], v[32:35]
    ds_read_b128 v[128:131], v234 offset:2176
    ds_read_b128 v[132:135], v234 offset:2688
    v_mfma_f32_16x16x32_bf16 v[36:39], v[52:55], v[112:115], v[36:39]
    ds_read_b128 v[136:139], v234 offset:3200
    ds_read_b128 v[140:143], v234 offset:3712
    v_mfma_f32_16x16x32_bf16 v[40:43], v[56:59], v[112:115], v[40:43]
    ds_read_b128 v[144:147], v234 offset:2112
    ds_read_b128 v[148:151], v234 offset:2624
    v_mfma_f32_16x16x32_bf16 v[44:47], v[60:63], v[112:115], v[44:47]
    ds_read_b128 v[152:155], v234 offset:3136
    ds_read_b128 v[156:159], v234 offset:3648
    s_waitcnt lgkmcnt(10)
    v_mfma_f32_16x16x32_bf16 v[36:39], v[48:51], v[116:119], v[36:39]
    ds_read_b128 v[160:163], v234 offset:2048
    ds_read_b128 v[164:167], v234 offset:2560
    v_mfma_f32_16x16x32_bf16 v[40:43], v[52:55], v[116:119], v[40:43]
    ds_read_b128 v[168:171], v234 offset:3072
    ds_read_b128 v[172:175], v234 offset:3584
    v_mfma_f32_16x16x32_bf16 v[44:47], v[56:59], v[116:119], v[44:47]
    ds_read_b64 v[8:9], v238 offset:2048
    ds_read_b64 v[10:11], v238 offset:2560
    s_waitcnt lgkmcnt(15)
    v_mfma_f32_16x16x32_bf16 v[40:43], v[48:51], v[120:123], v[40:43]
    s_waitcnt vmcnt(0)
    v_lshlrev_b32 v208, 16, v216
    v_mfma_f32_16x16x32_bf16 v[44:47], v[52:55], v[120:123], v[44:47]
    v_and_b32 v209, 0xffff0000, v216
    v_lshlrev_b32 v210, 16, v217
    s_waitcnt lgkmcnt(14)
    v_mfma_f32_16x16x32_bf16 v[44:47], v[48:51], v[124:127], v[44:47]
    v_and_b32 v211, 0xffff0000, v217
    v_lshlrev_b32 v212, 16, v218
    s_waitcnt lgkmcnt(13)
    v_mfma_f32_16x16x32_bf16 v[32:35], v[64:67], v[128:131], v[32:35]
    v_and_b32 v213, 0xffff0000, v218
    v_lshlrev_b32 v214, 16, v219
    v_mfma_f32_16x16x32_bf16 v[36:39], v[68:71], v[128:131], v[36:39]
    v_and_b32 v215, 0xffff0000, v219
    v_mov_b32 v200, 0x3f803f80
    v_mfma_f32_16x16x32_bf16 v[40:43], v[72:75], v[128:131], v[40:43]
    v_mov_b32 v201, 0x3f803f80
    v_mov_b32 v202, 0x3f803f80
    v_mfma_f32_16x16x32_bf16 v[44:47], v[76:79], v[128:131], v[44:47]
    v_mov_b32 v203, 0x3f803f80
    s_waitcnt lgkmcnt(12)
    v_mfma_f32_16x16x32_bf16 v[36:39], v[64:67], v[132:135], v[36:39]
    s_waitcnt lgkmcnt(0)
    v_lshlrev_b32 v12, 16, v8
    v_mfma_f32_16x16x32_bf16 v[40:43], v[68:71], v[132:135], v[40:43]
    v_and_b32 v13, 0xffff0000, v8
    v_fmac_f32 v208, s40, v12
    v_mfma_f32_16x16x32_bf16 v[44:47], v[72:75], v[132:135], v[44:47]
    v_fmac_f32 v209, s40, v13
    v_lshlrev_b32 v12, 16, v9
    v_mfma_f32_16x16x32_bf16 v[40:43], v[64:67], v[136:139], v[40:43]
    v_and_b32 v13, 0xffff0000, v9
    v_fmac_f32 v210, s40, v12
    v_mfma_f32_16x16x32_bf16 v[44:47], v[68:71], v[136:139], v[44:47]
    v_fmac_f32 v211, s40, v13
    v_lshlrev_b32 v12, 16, v10
    v_mfma_f32_16x16x32_bf16 v[44:47], v[64:67], v[140:143], v[44:47]
    v_and_b32 v13, 0xffff0000, v10
    v_fmac_f32 v212, s40, v12
    v_mfma_f32_16x16x32_bf16 v[32:35], v[80:83], v[144:147], v[32:35]
    buffer_load_dwordx2 v[14:15], v231, s[32:35], s73 offen sc1
    v_fmac_f32 v213, s40, v13
    v_mfma_f32_16x16x32_bf16 v[36:39], v[84:87], v[144:147], v[36:39]
    v_lshlrev_b32 v12, 16, v11
    v_and_b32 v13, 0xffff0000, v11
    v_mfma_f32_16x16x32_bf16 v[40:43], v[88:91], v[144:147], v[40:43]
    v_fmac_f32 v214, s40, v12
    v_fmac_f32 v215, s40, v13
    v_mfma_f32_16x16x32_bf16 v[44:47], v[92:95], v[144:147], v[44:47]
    v_mfma_f32_16x16x32_bf16 v[36:39], v[80:83], v[148:151], v[36:39]
    v_mfma_f32_16x16x32_bf16 v[40:43], v[84:87], v[148:151], v[40:43]
    v_mfma_f32_16x16x32_bf16 v[44:47], v[88:91], v[148:151], v[44:47]
    v_mfma_f32_16x16x32_bf16 v[40:43], v[80:83], v[152:155], v[40:43]
    v_mfma_f32_16x16x32_bf16 v[44:47], v[84:87], v[152:155], v[44:47]
    v_mfma_f32_16x16x32_bf16 v[44:47], v[80:83], v[156:159], v[44:47]
    v_mfma_f32_16x16x32_bf16 v[32:35], v[96:99], v[160:163], v[32:35]
    v_mfma_f32_16x16x32_bf16 v[36:39], v[100:103], v[160:163], v[36:39]
    v_mfma_f32_16x16x32_bf16 v[40:43], v[104:107], v[160:163], v[40:43]
    v_mfma_f32_16x16x32_bf16 v[44:47], v[108:111], v[160:163], v[44:47]
    v_mfma_f32_16x16x32_bf16 v[36:39], v[96:99], v[164:167], v[36:39]
    v_mfma_f32_16x16x32_bf16 v[40:43], v[100:103], v[164:167], v[40:43]
    v_mfma_f32_16x16x32_bf16 v[44:47], v[104:107], v[164:167], v[44:47]
    v_mfma_f32_16x16x32_bf16 v[40:43], v[96:99], v[168:171], v[40:43]
    v_mfma_f32_16x16x32_bf16 v[44:47], v[100:103], v[168:171], v[44:47]
    v_mfma_f32_16x16x32_bf16 v[44:47], v[96:99], v[172:175], v[44:47]
    s_waitcnt vmcnt(0)
    v_cmp_ne_u64 s[86:87], s[46:47], v[14:15]
    s_nop 0
    s_cmp_eq_u64 s[86:87], 0
    s_cbranch_scc0 slow_44
ok_45:
    s_add_u32 s89, s91, 24576
    s_xor_b32 s90, s89, 2048
    v_add_u32 v14, s89, v232
    s_bitcmp1_b32 s44, 0
    s_cbranch_scc1 xodd_46
    s_nop 3
    ds_write_b128 v14, v[40:43] offset:0
    ds_write_b128 v14, v[44:47] offset:1024
    v_add_f32 v208, v208, v32
    v_add_f32 v209, v209, v33
    v_add_f32 v210, v210, v34
    v_add_f32 v211, v211, v35
    v_add_f32 v212, v212, v36
    v_add_f32 v213, v213, v37
    v_add_f32 v214, v214, v38
    v_add_f32 v215, v215, v39
    s_branch xdone_47
xodd_46:
    s_nop 3
    ds_write_b128 v14, v[32:35] offset:0
    ds_write_b128 v14, v[36:39] offset:1024
    v_add_f32 v208, v208, v40
    v_add_f32 v209, v209, v41
    v_add_f32 v210, v210, v42
    v_add_f32 v211, v211, v43
    v_add_f32 v212, v212, v44
    v_add_f32 v213, v213, v45
    v_add_f32 v214, v214, v46
    v_add_f32 v215, v215, v47
xdone_47:
    s_waitcnt lgkmcnt(0)
    s_barrier
    v_add_u32 v14, s90, v232
    ds_read_b128 v[4:7], v14
    ds_read_b128 v[8:11], v14 offset:1024
    s_mov_b32 s72, 8388608
    s_add_u32 m0, s91, 0
    s_nop 0
    buffer_load_dwordx4 v239, s[32:35], s82 offen sc1 lds
    buffer_load_dwordx4 v239, s[32:35], s82 offen offset:1024 sc1 lds
    s_add_u32 s82, s82, 2048
    s_bitset0_b32 s82, 15
    s_add_u32 m0, s91, 8192
    s_nop 0
    buffer_load_dwordx4 v239, s[32:35], s82 offen sc1 lds
    buffer_load_dwordx4 v239, s[32:35], s82 offen offset:1024 sc1 lds
    s_add_u32 s82, s82, 2048
    s_bitset0_b32 s82, 15
    s_waitcnt lgkmcnt(0)
    s_add_u32 m0, s91, 16384
    v_add_f32 v208, v208, v4
    buffer_load_dwordx4 v239, s[32:35], s82 offen sc1 lds
    v_add_f32 v209, v209, v5
    buffer_load_dwordx4 v239, s[32:35], s82 offen offset:1024 sc1 lds
    v_add_f32 v210, v210, v6
    s_add_u32 s82, s82, 2048
    v_add_f32 v211, v211, v7
    s_bitset0_b32 s82, 15
    v_add_f32 v212, v212, v8
    s_add_u32 m0, s91, 32768
    v_add_f32 v213, v213, v9
    buffer_load_dwordx4 v239, s[32:35], s82 offen sc1 lds
    v_add_f32 v214, v214, v10
    buffer_load_dwordx4 v239, s[32:35], s82 offen offset:1024 sc1 lds
    v_add_f32 v215, v215, v11
    s_add_u32 s82, s82, 2048
    v_cvt_pk_bf16_f32 v4, v208, v209
    s_bitset0_b32 s82, 15
    v_cvt_pk_bf16_f32 v5, v210, v211
    v_cvt_pk_bf16_f32 v6, v212, v213
    v_cvt_pk_bf16_f32 v7, v214, v215
    s_nop 0
    v_permlane16_swap_b32 v4, v6
    v_permlane16_swap_b32 v5, v7
    buffer_store_dwordx4 v[4:7], v237, s[32:35], s72 offen sc1
    s_barrier
    s_add_u32 m0, s91, 24576
    s_nop 0
    buffer_load_dwordx4 v239, s[32:35], s82 offen sc1 lds
    buffer_load_dwordx4 v239, s[32:35], s82 offen offset:1024 sc1 lds
    s_add_u32 s82, s82, 2048
    s_bitset0_b32 s82, 15
    s_add_u32 m0, s91, 40960
    s_nop 0
    buffer_load_dwordx4 v239, s[32:35], s82 offen sc1 lds
    buffer_load_dwordx4 v239, s[32:35], s82 offen offset:1024 sc1 lds
    s_add_u32 s82, s82, 2048
    s_bitset0_b32 s82, 15
    ds_read_b128 v[160:163], v221 offset:0
    ds_read_b128 v[164:167], v221 offset:1024
    ds_read_b128 v[168:171], v221 offset:2048
    ds_read_b128 v[172:175], v221 offset:3072
    ds_read_b128 v[176:179], v221 offset:4096
    ds_read_b128 v[180:183], v221 offset:5120
    ds_read_b128 v[184:187], v221 offset:6144
    s_add_u32 s73, s80, 196608
    s_waitcnt vmcnt(11)
    ds_read_b64_tr_b16 v[144:145], v240 offset:0
    ds_read_b64_tr_b16 v[146:147], v240 offset:1024
    ds_read_b64_tr_b16 v[148:149], v241 offset:0
    ds_read_b64_tr_b16 v[150:151], v241 offset:1024
    ds_read_b64_tr_b16 v[188:189], v226 offset:0
    ds_read_b64_tr_b16 v[190:191], v226 offset:1024
    s_waitcnt lgkmcnt(2)
    v_mfma_f32_16x16x32_bf16 v[16:19], v[160:163], v[144:147], 0
    s_waitcnt lgkmcnt(0)
    v_mfma_f32_16x16x32_bf16 v[192:195], v[188:191], v[188:191], 0
    v_mfma_f32_16x16x32_bf16 v[196:199], v[200:203], v[188:191], 0
    s_add_u32 m0, s91, 0
    v_mfma_f32_16x16x32_bf16 v[20:23], v[160:163], v[148:151], 0
    buffer_load_dwordx4 v239, s[32:35], s82 offen sc1 lds
    v_mfma_f32_16x16x32_bf16 v[24:27], v[164:167], v[144:147], 0
    ds_read_b128 v[160:163], v221 offset:7168
    v_mfma_f32_16x16x32_bf16 v[28:31], v[164:167], v[148:151], 0
    s_waitcnt vmcnt(10)
    ds_read_b64_tr_b16 v[152:153], v240 offset:8192
    v_mfma_f32_16x16x32_bf16 v[32:35], v[168:171], v[144:147], 0
    ds_read_b128 v[164:167], v221 offset:8192
    ds_read_b64_tr_b16 v[188:189], v226 offset:8192
    v_mfma_f32_16x16x32_bf16 v[36:39], v[168:171], v[148:151], 0
    ds_read_b64_tr_b16 v[154:155], v240 offset:9216
    v_mfma_f32_16x16x32_bf16 v[40:43], v[172:175], v[144:147], 0
    ds_read_b128 v[168:171], v221 offset:9216
    ds_read_b64_tr_b16 v[190:191], v226 offset:9216
    v_mfma_f32_16x16x32_bf16 v[44:47], v[172:175], v[148:151], 0
    ds_read_b64_tr_b16 v[156:157], v241 offset:8192
    v_mfma_f32_16x16x32_bf16 v[48:51], v[176:179], v[144:147], 0
    ds_read_b128 v[172:175], v221 offset:10240
    v_mfma_f32_16x16x32_bf16 v[52:55], v[176:179], v[148:151], 0
    ds_read_b64_tr_b16 v[158:159], v241 offset:9216
    v_mfma_f32_16x16x32_bf16 v[56:59], v[180:183], v[144:147], 0
    ds_read_b128 v[176:179], v221 offset:11264
    v_mfma_f32_16x16x32_bf16 v[60:63], v[180:183], v[148:151], 0
    buffer_load_dwordx4 v239, s[32:35], s82 offen offset:1024 sc1 lds
    v_mfma_f32_16x16x32_bf16 v[64:67], v[184:187], v[144:147], 0
    ds_read_b128 v[180:183], v221 offset:12288
    s_add_u32 s82, s82, 2048
    v_mfma_f32_16x16x32_bf16 v[68:71], v[184:187], v[148:151], 0
    s_bitset0_b32 s82, 15
    s_waitcnt lgkmcnt(2)
    v_mfma_f32_16x16x32_bf16 v[16:19], v[160:163], v[152:155], v[16:19]
    v_mfma_f32_16x16x32_bf16 v[192:195], v[188:191], v[188:191], v[192:195]
    v_mfma_f32_16x16x32_bf16 v[196:199], v[200:203], v[188:191], v[196:199]
    ds_read_b128 v[184:187], v221 offset:13312
    s_add_u32 m0, s91, 8192
    v_mfma_f32_16x16x32_bf16 v[20:23], v[160:163], v[156:159], v[20:23]
    buffer_load_dwordx4 v239, s[32:35], s82 offen sc1 lds
    v_mfma_f32_16x16x32_bf16 v[24:27], v[164:167], v[152:155], v[24:27]
    ds_read_b128 v[160:163], v221 offset:14336
    v_mfma_f32_16x16x32_bf16 v[28:31], v[164:167], v[156:159], v[28:31]
    s_waitcnt vmcnt(10)
    ds_read_b64_tr_b16 v[144:145], v240 offset:16384
    v_mfma_f32_16x16x32_bf16 v[32:35], v[168:171], v[152:155], v[32:35]
    ds_read_b128 v[164:167], v221 offset:15360
    ds_read_b64_tr_b16 v[188:189], v226 offset:16384
    v_mfma_f32_16x16x32_bf16 v[36:39], v[168:171], v[156:159], v[36:39]
    ds_read_b64_tr_b16 v[146:147], v240 offset:17408
    v_mfma_f32_16x16x32_bf16 v[40:43], v[172:175], v[152:155], v[40:43]
    ds_read_b128 v[168:171], v221 offset:16384
    ds_read_b64_tr_b16 v[190:191], v226 offset:17408
    v_mfma_f32_16x16x32_bf16 v[44:47], v[172:175], v[156:159], v[44:47]
    ds_read_b64_tr_b16 v[148:149], v241 offset:16384
    s_waitcnt lgkmcnt(8)
    v_mfma_f32_16x16x32_bf16 v[48:51], v[176:179], v[152:155], v[48:51]
    ds_read_b128 v[172:175], v221 offset:17408
    v_mfma_f32_16x16x32_bf16 v[52:55], v[176:179], v[156:159], v[52:55]
    ds_read_b64_tr_b16 v[150:151], v241 offset:17408
    v_mfma_f32_16x16x32_bf16 v[56:59], v[180:183], v[152:155], v[56:59]
    ds_read_b128 v[176:179], v221 offset:18432
    v_mfma_f32_16x16x32_bf16 v[60:63], v[180:183], v[156:159], v[60:63]
    buffer_load_dwordx4 v239, s[32:35], s82 offen offset:1024 sc1 lds
    v_mfma_f32_16x16x32_bf16 v[64:67], v[184:187], v[152:155], v[64:67]
    ds_read_b128 v[180:183], v221 offset:19456
    s_add_u32 s82, s82, 2048
    v_mfma_f32_16x16x32_bf16 v[68:71], v[184:187], v[156:159], v[68:71]
    s_bitset0_b32 s82, 15
    s_waitcnt lgkmcnt(2)
    v_mfma_f32_16x16x32_bf16 v[16:19], v[160:163], v[144:147], v[16:19]
    v_mfma_f32_16x16x32_bf16 v[192:195], v[188:191], v[188:191], v[192:195]
    v_mfma_f32_16x16x32_bf16 v[196:199], v[200:203], v[188:191], v[196:199]
    ds_read_b128 v[184:187], v221 offset:20480
    s_add_u32 m0, s91, 16384
    v_mfma_f32_16x16x32_bf16 v[20:23], v[160:163], v[148:151], v[20:23]
    buffer_load_dwordx4 v239, s[32:35], s82 offen sc1 lds
    v_mfma_f32_16x16x32_bf16 v[24:27], v[164:167], v[144:147], v[24:27]
    ds_read_b128 v[160:163], v221 offset:21504
    v_mfma_f32_16x16x32_bf16 v[28:31], v[164:167], v[148:151], v[28:31]
    s_waitcnt vmcnt(10)
    ds_read_b64_tr_b16 v[152:153], v240 offset:32768
    v_mfma_f32_16x16x32_bf16 v[32:35], v[168:171], v[144:147], v[32:35]
    ds_read_b128 v[164:167], v221 offset:22528
    ds_read_b64_tr_b16 v[188:189], v226 offset:32768
    s_waitcnt vmcnt(9)
    s_barrier
    s_cmp_lg_u32 s44, 1
    s_cbranch_scc1 nosig_48
    s_lshl_b32 s67, s2, 4
    s_add_u32 s67, s67, 196608
    v_lshl_add_u32 v14, v1, 12, s67
    v_mov_b32 v12, s46
    v_mov_b32 v13, s47
    s_mov_b64 exec, 0xff
    buffer_store_dwordx2 v[12:13], v14, s[32:35], 0 offen sc1
    s_mov_b64 exec, -1
nosig_48:
    v_mfma_f32_16x16x32_bf16 v[36:39], v[168:171], v[148:151], v[36:39]
    ds_read_b64_tr_b16 v[154:155], v240 offset:33792
    v_mfma_f32_16x16x32_bf16 v[40:43], v[172:175], v[144:147], v[40:43]
    ds_read_b128 v[168:171], v221 offset:23552
    ds_read_b64_tr_b16 v[190:191], v226 offset:33792
    v_mfma_f32_16x16x32_bf16 v[44:47], v[172:175], v[148:151], v[44:47]
    ds_read_b64_tr_b16 v[156:157], v241 offset:32768
    s_waitcnt lgkmcnt(8)
    v_mfma_f32_16x16x32_bf16 v[48:51], v[176:179], v[144:147], v[48:51]
    ds_read_b128 v[172:175], v221 offset:24576
    v_mfma_f32_16x16x32_bf16 v[52:55], v[176:179], v[148:151], v[52:55]
    ds_read_b64_tr_b16 v[158:159], v241 offset:33792
    v_mfma_f32_16x16x32_bf16 v[56:59], v[180:183], v[144:147], v[56:59]
    ds_read_b128 v[176:179], v221 offset:25600
    v_mfma_f32_16x16x32_bf16 v[60:63], v[180:183], v[148:151], v[60:63]
    buffer_load_dwordx4 v239, s[32:35], s82 offen offset:1024 sc1 lds
    v_mfma_f32_16x16x32_bf16 v[64:67], v[184:187], v[144:147], v[64:67]
    ds_read_b128 v[180:183], v221 offset:26624
    s_add_u32 s82, s82, 2048
    v_mfma_f32_16x16x32_bf16 v[68:71], v[184:187], v[148:151], v[68:71]
    s_bitset0_b32 s82, 15
    s_waitcnt lgkmcnt(2)
    v_mfma_f32_16x16x32_bf16 v[16:19], v[160:163], v[152:155], v[16:19]
    v_mfma_f32_16x16x32_bf16 v[192:195], v[188:191], v[188:191], v[192:195]
    v_mfma_f32_16x16x32_bf16 v[196:199], v[200:203], v[188:191], v[196:199]
    ds_read_b128 v[184:187], v221 offset:27648
    s_add_u32 m0, s91, 32768
    v_mfma_f32_16x16x32_bf16 v[20:23], v[160:163], v[156:159], v[20:23]
    buffer_load_dwordx4 v239, s[32:35], s82 offen sc1 lds
    v_mfma_f32_16x16x32_bf16 v[24:27], v[164:167], v[152:155], v[24:27]
    ds_read_b128 v[160:163], v222 offset:0
    v_mfma_f32_16x16x32_bf16 v[28:31], v[164:167], v[156:159], v[28:31]
    s_waitcnt vmcnt(9)
    ds_read_b64_tr_b16 v[144:145], v240 offset:24576
    v_mfma_f32_16x16x32_bf16 v[32:35], v[168:171], v[152:155], v[32:35]
    ds_read_b128 v[164:167], v222 offset:1024
    v_mfma_f32_16x16x32_bf16 v[36:39], v[168:171], v[156:159], v[36:39]
    ds_read_b64_tr_b16 v[146:147], v240 offset:25600
    v_mfma_f32_16x16x32_bf16 v[40:43], v[172:175], v[152:155], v[40:43]
    ds_read_b128 v[168:171], v222 offset:2048
    v_mfma_f32_16x16x32_bf16 v[44:47], v[172:175], v[156:159], v[44:47]
    ds_read_b64_tr_b16 v[148:149], v241 offset:24576
    s_waitcnt lgkmcnt(6)
    v_mfma_f32_16x16x32_bf16 v[48:51], v[176:179], v[152:155], v[48:51]
    ds_read_b128 v[172:175], v222 offset:3072
    s_mov_b32 s42, 0x22222222
    v_mfma_f32_16x16x32_bf16 v[52:55], v[176:179], v[156:159], v[52:55]
    ds_read_b64_tr_b16 v[150:151], v241 offset:25600
    s_mov_b32 s43, 0x22222222
    v_mfma_f32_16x16x32_bf16 v[56:59], v[180:183], v[152:155], v[56:59]
    ds_read_b128 v[176:179], v222 offset:4096
    v_cndmask_b32 v192, v192, v193, s[42:43]
    v_mfma_f32_16x16x32_bf16 v[60:63], v[180:183], v[156:159], v[60:63]
    buffer_load_dwordx4 v239, s[32:35], s82 offen offset:1024 sc1 lds
    s_mov_b32 s42, 0x44444444
    v_mfma_f32_16x16x32_bf16 v[64:67], v[184:187], v[152:155], v[64:67]
    ds_read_b128 v[180:183], v222 offset:5120
    s_add_u32 s82, s82, 2048
    v_mfma_f32_16x16x32_bf16 v[68:71], v[184:187], v[156:159], v[68:71]
    s_bitset0_b32 s82, 15
    s_waitcnt lgkmcnt(2)
    v_mfma_f32_16x16x32_bf16 v[16:19], v[160:163], v[144:147], v[16:19]
    ds_read_b128 v[184:187], v222 offset:6144
    s_add_u32 m0, s91, 24576
    v_mfma_f32_16x16x32_bf16 v[20:23], v[160:163], v[148:151], v[20:23]
    buffer_load_dwordx4 v239, s[32:35], s82 offen sc1 lds
    s_mov_b32 s43, 0x44444444
    v_mfma_f32_16x16x32_bf16 v[24:27], v[164:167], v[144:147], v[24:27]
    ds_read_b128 v[160:163], v222 offset:7168
    v_cndmask_b32 v192, v192, v194, s[42:43]
    v_mfma_f32_16x16x32_bf16 v[28:31], v[164:167], v[148:151], v[28:31]
    s_waitcnt vmcnt(9)
    ds_read_b64_tr_b16 v[152:153], v240 offset:40960
    v_mfma_f32_16x16x32_bf16 v[32:35], v[168:171], v[144:147], v[32:35]
    ds_read_b128 v[164:167], v222 offset:8192
    s_mov_b32 s42, 0x88888888
    v_mfma_f32_16x16x32_bf16 v[36:39], v[168:171], v[148:151], v[36:39]
    ds_read_b64_tr_b16 v[154:155], v240 offset:41984
    s_mov_b32 s43, 0x88888888
    v_mfma_f32_16x16x32_bf16 v[40:43], v[172:175], v[144:147], v[40:43]
    ds_read_b128 v[168:171], v222 offset:9216
    v_cndmask_b32 v198, v192, v195, s[42:43]
    v_mfma_f32_16x16x32_bf16 v[44:47], v[172:175], v[148:151], v[44:47]
    ds_read_b64_tr_b16 v[156:157], v241 offset:40960
    s_waitcnt lgkmcnt(6)
    v_mfma_f32_16x16x32_bf16 v[48:51], v[176:179], v[144:147], v[48:51]
    ds_read_b128 v[172:175], v222 offset:10240
    v_mov_b32 v199, s46
    v_mfma_f32_16x16x32_bf16 v[52:55], v[176:179], v[148:151], v[52:55]
    ds_read_b64_tr_b16 v[158:159], v241 offset:41984
    s_mov_b32 s41, 12058624
    v_mfma_f32_16x16x32_bf16 v[56:59], v[180:183], v[144:147], v[56:59]
    ds_read_b128 v[176:179], v222 offset:11264
    s_mov_b32 exec_lo, 0x00f0000f
    s_mov_b32 exec_hi, 0xf0000f00
    buffer_store_dwordx4 v[196:199], v225, s[32:35], s41 offen sc1
    s_mov_b64 exec, -1
    v_mfma_f32_16x16x32_bf16 v[60:63], v[180:183], v[148:151], v[60:63]
    buffer_load_dwordx4 v239, s[32:35], s82 offen offset:1024 sc1 lds
    v_mfma_f32_16x16x32_bf16 v[64:67], v[184:187], v[144:147], v[64:67]
    ds_read_b128 v[180:183], v222 offset:12288
    s_add_u32 s82, s82, 2048
    v_mfma_f32_16x16x32_bf16 v[68:71], v[184:187], v[148:151], v[68:71]
    s_bitset0_b32 s82, 15
    s_waitcnt lgkmcnt(2)
    v_mfma_f32_16x16x32_bf16 v[16:19], v[160:163], v[152:155], v[16:19]
    ds_read_b128 v[184:187], v222 offset:13312
    s_add_u32 m0, s91, 40960
    v_mfma_f32_16x16x32_bf16 v[20:23], v[160:163], v[156:159], v[20:23]
    buffer_load_dwordx4 v239, s[32:35], s82 offen sc1 lds
    v_mfma_f32_16x16x32_bf16 v[24:27], v[164:167], v[152:155], v[24:27]
    ds_read_b128 v[160:163], v222 offset:14336
    v_mfma_f32_16x16x32_bf16 v[28:31], v[164:167], v[156:159], v[28:31]
    s_waitcnt vmcnt(10)
    ds_read_b64_tr_b16 v[144:145], v240 offset:0
    v_mfma_f32_16x16x32_bf16 v[32:35], v[168:171], v[152:155], v[32:35]
    ds_read_b128 v[164:167], v222 offset:15360
    v_mfma_f32_16x16x32_bf16 v[36:39], v[168:171], v[156:159], v[36:39]
    ds_read_b64_tr_b16 v[146:147], v240 offset:1024
    v_mfma_f32_16x16x32_bf16 v[40:43], v[172:175], v[152:155], v[40:43]
    ds_read_b128 v[168:171], v222 offset:16384
    v_mfma_f32_16x16x32_bf16 v[44:47], v[172:175], v[156:159], v[44:47]
    ds_read_b64_tr_b16 v[148:149], v241 offset:0
    s_waitcnt lgkmcnt(6)
    v_mfma_f32_16x16x32_bf16 v[48:51], v[176:179], v[152:155], v[48:51]
    ds_read_b128 v[172:175], v222 offset:17408
    v_mfma_f32_16x16x32_bf16 v[52:55], v[176:179], v[156:159], v[52:55]
    ds_read_b64_tr_b16 v[150:151], v241 offset:1024
    v_mfma_f32_16x16x32_bf16 v[56:59], v[180:183], v[152:155], v[56:59]
    ds_read_b128 v[176:179], v222 offset:18432
    v_mfma_f32_16x16x32_bf16 v[60:63], v[180:183], v[156:159], v[60:63]
    buffer_load_dwordx4 v239, s[32:35], s82 offen offset:1024 sc1 lds
    v_mfma_f32_16x16x32_bf16 v[64:67], v[184:187], v[152:155], v[64:67]
    ds_read_b128 v[180:183], v222 offset:19456
    s_add_u32 s82, s82, 2048
    v_mfma_f32_16x16x32_bf16 v[68:71], v[184:187], v[156:159], v[68:71]
    s_bitset0_b32 s82, 15
    s_waitcnt lgkmcnt(2)
    v_mfma_f32_16x16x32_bf16 v[16:19], v[160:163], v[144:147], v[16:19]
    ds_read_b128 v[184:187], v222 offset:20480
    s_add_u32 m0, s91, 0
    v_mfma_f32_16x16x32_bf16 v[20:23], v[160:163], v[148:151], v[20:23]
    buffer_load_dwordx4 v239, s[32:35], s82 offen sc1 lds
    v_mfma_f32_16x16x32_bf16 v[24:27], v[164:167], v[144:147], v[24:27]
    ds_read_b128 v[160:163], v222 offset:21504
    v_mfma_f32_16x16x32_bf16 v[28:31], v[164:167], v[148:151], v[28:31]
    s_waitcnt vmcnt(10)
    ds_read_b64_tr_b16 v[152:153], v240 offset:8192
    v_mfma_f32_16x16x32_bf16 v[32:35], v[168:171], v[144:147], v[32:35]
    ds_read_b128 v[164:167], v222 offset:22528
    v_mfma_f32_16x16x32_bf16 v[36:39], v[168:171], v[148:151], v[36:39]
    ds_read_b64_tr_b16 v[154:155], v240 offset:9216
    v_mfma_f32_16x16x32_bf16 v[40:43], v[172:175], v[144:147], v[40:43]
    ds_read_b128 v[168:171], v222 offset:23552
    v_mfma_f32_16x16x32_bf16 v[44:47], v[172:175], v[148:151], v[44:47]
    ds_read_b64_tr_b16 v[156:157], v241 offset:8192
    s_waitcnt lgkmcnt(6)
    v_mfma_f32_16x16x32_bf16 v[48:51], v[176:179], v[144:147], v[48:51]
    ds_read_b128 v[172:175], v222 offset:24576
    v_mfma_f32_16x16x32_bf16 v[52:55], v[176:179], v[148:151], v[52:55]
    ds_read_b64_tr_b16 v[158:159], v241 offset:9216
    v_mfma_f32_16x16x32_bf16 v[56:59], v[180:183], v[144:147], v[56:59]
    ds_read_b128 v[176:179], v222 offset:25600
    v_mfma_f32_16x16x32_bf16 v[60:63], v[180:183], v[148:151], v[60:63]
    buffer_load_dwordx4 v239, s[32:35], s82 offen offset:1024 sc1 lds
    v_mfma_f32_16x16x32_bf16 v[64:67], v[184:187], v[144:147], v[64:67]
    ds_read_b128 v[180:183], v222 offset:26624
    s_add_u32 s82, s82, 2048
    buffer_load_dwordx2 v[14:15], v231, s[32:35], s73 offen sc1
    v_mfma_f32_16x16x32_bf16 v[68:71], v[184:187], v[148:151], v[68:71]
    s_bitset0_b32 s82, 15
    s_waitcnt lgkmcnt(2)
    v_mfma_f32_16x16x32_bf16 v[16:19], v[160:163], v[152:155], v[16:19]
    ds_read_b128 v[184:187], v222 offset:27648
    s_add_u32 m0, s91, 8192
    v_mfma_f32_16x16x32_bf16 v[20:23], v[160:163], v[156:159], v[20:23]
    buffer_load_dwordx4 v239, s[32:35], s82 offen sc1 lds
    v_mfma_f32_16x16x32_bf16 v[24:27], v[164:167], v[152:155], v[24:27]
    ds_read_b128 v[160:163], v223 offset:0
    v_mfma_f32_16x16x32_bf16 v[28:31], v[164:167], v[156:159], v[28:31]
    s_waitcnt vmcnt(11)
    ds_read_b64_tr_b16 v[144:145], v240 offset:16384
    v_mfma_f32_16x16x32_bf16 v[32:35], v[168:171], v[152:155], v[32:35]
    ds_read_b128 v[164:167], v223 offset:1024
    v_mfma_f32_16x16x32_bf16 v[36:39], v[168:171], v[156:159], v[36:39]
    ds_read_b64_tr_b16 v[146:147], v240 offset:17408
    v_mfma_f32_16x16x32_bf16 v[40:43], v[172:175], v[152:155], v[40:43]
    ds_read_b128 v[168:171], v223 offset:2048
    v_mfma_f32_16x16x32_bf16 v[44:47], v[172:175], v[156:159], v[44:47]
    ds_read_b64_tr_b16 v[148:149], v241 offset:16384
    s_waitcnt lgkmcnt(6)
    v_mfma_f32_16x16x32_bf16 v[48:51], v[176:179], v[152:155], v[48:51]
    ds_read_b128 v[172:175], v223 offset:3072
    v_mfma_f32_16x16x32_bf16 v[52:55], v[176:179], v[156:159], v[52:55]
    ds_read_b64_tr_b16 v[150:151], v241 offset:17408
    v_mfma_f32_16x16x32_bf16 v[56:59], v[180:183], v[152:155], v[56:59]
    ds_read_b128 v[176:179], v223 offset:4096
    v_mfma_f32_16x16x32_bf16 v[60:63], v[180:183], v[156:159], v[60:63]
    buffer_load_dwordx4 v239, s[32:35], s82 offen offset:1024 sc1 lds
    v_mfma_f32_16x16x32_bf16 v[64:67], v[184:187], v[152:155], v[64:67]
    ds_read_b128 v[180:183], v223 offset:5120
    s_add_u32 s82, s82, 2048
    v_mfma_f32_16x16x32_bf16 v[68:71], v[184:187], v[156:159], v[68:71]
    s_bitset0_b32 s82, 15
    s_waitcnt lgkmcnt(2)
    v_mfma_f32_16x16x32_bf16 v[16:19], v[160:163], v[144:147], v[16:19]
    ds_read_b128 v[184:187], v223 offset:6144
    s_add_u32 m0, s91, 16384
    v_mfma_f32_16x16x32_bf16 v[20:23], v[160:163], v[148:151], v[20:23]
    buffer_load_dwordx4 v239, s[32:35], s82 offen sc1 lds
    v_mfma_f32_16x16x32_bf16 v[24:27], v[164:167], v[144:147], v[24:27]
    ds_read_b128 v[160:163], v223 offset:7168
    v_mfma_f32_16x16x32_bf16 v[28:31], v[164:167], v[148:151], v[28:31]
    s_waitcnt vmcnt(11)
    ds_read_b64_tr_b16 v[152:153], v240 offset:32768
    v_mfma_f32_16x16x32_bf16 v[32:35], v[168:171], v[144:147], v[32:35]
    ds_read_b128 v[164:167], v223 offset:8192
    v_mfma_f32_16x16x32_bf16 v[36:39], v[168:171], v[148:151], v[36:39]
    ds_read_b64_tr_b16 v[154:155], v240 offset:33792
    v_mfma_f32_16x16x32_bf16 v[40:43], v[172:175], v[144:147], v[40:43]
    ds_read_b128 v[168:171], v223 offset:9216
    v_mfma_f32_16x16x32_bf16 v[44:47], v[172:175], v[148:151], v[44:47]
    ds_read_b64_tr_b16 v[156:157], v241 offset:32768
    s_waitcnt lgkmcnt(6)
    v_mfma_f32_16x16x32_bf16 v[48:51], v[176:179], v[144:147], v[48:51]
    ds_read_b128 v[172:175], v223 offset:10240
    v_mfma_f32_16x16x32_bf16 v[52:55], v[176:179], v[148:151], v[52:55]
    ds_read_b64_tr_b16 v[158:159], v241 offset:33792
    v_mfma_f32_16x16x32_bf16 v[56:59], v[180:183], v[144:147], v[56:59]
    ds_read_b128 v[176:179], v223 offset:11264
    v_mfma_f32_16x16x32_bf16 v[60:63], v[180:183], v[148:151], v[60:63]
    buffer_load_dwordx4 v239, s[32:35], s82 offen offset:1024 sc1 lds
    v_mfma_f32_16x16x32_bf16 v[64:67], v[184:187], v[144:147], v[64:67]
    ds_read_b128 v[180:183], v223 offset:12288
    s_add_u32 s82, s82, 2048
    v_mfma_f32_16x16x32_bf16 v[68:71], v[184:187], v[148:151], v[68:71]
    s_bitset0_b32 s82, 15
    s_waitcnt lgkmcnt(2)
    v_mfma_f32_16x16x32_bf16 v[16:19], v[160:163], v[152:155], v[16:19]
    ds_read_b128 v[184:187], v223 offset:13312
    s_add_u32 m0, s91, 32768
    v_mfma_f32_16x16x32_bf16 v[20:23], v[160:163], v[156:159], v[20:23]
    buffer_load_dwordx4 v239, s[32:35], s82 offen sc1 lds
    v_mfma_f32_16x16x32_bf16 v[24:27], v[164:167], v[152:155], v[24:27]
    ds_read_b128 v[160:163], v223 offset:14336
    v_mfma_f32_16x16x32_bf16 v[28:31], v[164:167], v[156:159], v[28:31]
    s_waitcnt vmcnt(10)
    ds_read_b64_tr_b16 v[144:145], v240 offset:24576
    v_mfma_f32_16x16x32_bf16 v[32:35], v[168:171], v[152:155], v[32:35]
    ds_read_b128 v[164:167], v223 offset:15360
    v_mfma_f32_16x16x32_bf16 v[36:39], v[168:171], v[156:159], v[36:39]
    ds_read_b64_tr_b16 v[146:147], v240 offset:25600
    v_mfma_f32_16x16x32_bf16 v[40:43], v[172:175], v[152:155], v[40:43]
    ds_read_b128 v[168:171], v223 offset:16384
    v_mfma_f32_16x16x32_bf16 v[44:47], v[172:175], v[156:159], v[44:47]
    ds_read_b64_tr_b16 v[148:149], v241 offset:24576
    s_waitcnt lgkmcnt(6)
    v_mfma_f32_16x16x32_bf16 v[48:51], v[176:179], v[152:155], v[48:51]
    ds_read_b128 v[172:175], v223 offset:17408
    v_mfma_f32_16x16x32_bf16 v[52:55], v[176:179], v[156:159], v[52:55]
    ds_read_b64_tr_b16 v[150:151], v241 offset:25600
    v_mfma_f32_16x16x32_bf16 v[56:59], v[180:183], v[152:155], v[56:59]
    ds_read_b128 v[176:179], v223 offset:18432
    v_mfma_f32_16x16x32_bf16 v[60:63], v[180:183], v[156:159], v[60:63]
    buffer_load_dwordx4 v239, s[32:35], s82 offen offset:1024 sc1 lds
    s_add_u32 s82, s82, 1048576
    v_mfma_f32_16x16x32_bf16 v[64:67], v[184:187], v[152:155], v[64:67]
    ds_read_b128 v[180:183], v223 offset:19456
    s_add_u32 s82, s82, 2048
    v_mfma_f32_16x16x32_bf16 v[68:71], v[184:187], v[156:159], v[68:71]
    s_bitset0_b32 s82, 15
    s_waitcnt vmcnt(6)
    v_cmp_ne_u64 s[86:87], s[46:47], v[14:15]
    s_nop 0
    s_cmp_eq_u64 s[86:87], 0
    s_cbranch_scc0 slow_49
ok_50:
    s_barrier
    s_waitcnt lgkmcnt(2)
    v_mfma_f32_16x16x32_bf16 v[16:19], v[160:163], v[144:147], v[16:19]
    ds_read_b128 v[184:187], v223 offset:20480
    s_add_u32 m0, s91, 24576
    v_mfma_f32_16x16x32_bf16 v[20:23], v[160:163], v[148:151], v[20:23]
    buffer_load_dwordx4 v239, s[32:35], s82 offen sc1 lds
    v_mfma_f32_16x16x32_bf16 v[24:27], v[164:167], v[144:147], v[24:27]
    ds_read_b128 v[160:163], v223 offset:21504
    v_mfma_f32_16x16x32_bf16 v[28:31], v[164:167], v[148:151], v[28:31]
    ds_read_b64_tr_b16 v[152:153], v240 offset:40960
    v_mfma_f32_16x16x32_bf16 v[32:35], v[168:171], v[144:147], v[32:35]
    ds_read_b128 v[164:167], v223 offset:22528
    v_mfma_f32_16x16x32_bf16 v[36:39], v[168:171], v[148:151], v[36:39]
    ds_read_b64_tr_b16 v[154:155], v240 offset:41984
    v_mfma_f32_16x16x32_bf16 v[40:43], v[172:175], v[144:147], v[40:43]
    ds_read_b128 v[168:171], v223 offset:23552
    v_mfma_f32_16x16x32_bf16 v[44:47], v[172:175], v[148:151], v[44:47]
    ds_read_b64_tr_b16 v[156:157], v241 offset:40960
    s_waitcnt lgkmcnt(6)
    v_mfma_f32_16x16x32_bf16 v[48:51], v[176:179], v[144:147], v[48:51]
    ds_read_b128 v[172:175], v223 offset:24576
    v_mfma_f32_16x16x32_bf16 v[52:55], v[176:179], v[148:151], v[52:55]
    ds_read_b64_tr_b16 v[158:159], v241 offset:41984
    buffer_load_dwordx4 v[80:83], v224, s[32:35], s41 offen offset:0 sc1
    v_mfma_f32_16x16x32_bf16 v[56:59], v[180:183], v[144:147], v[56:59]
    ds_read_b128 v[176:179], v223 offset:25600
    v_mfma_f32_16x16x32_bf16 v[60:63], v[180:183], v[148:151], v[60:63]
    buffer_load_dwordx4 v239, s[32:35], s82 offen offset:1024 sc1 lds
    v_mfma_f32_16x16x32_bf16 v[64:67], v[184:187], v[144:147], v[64:67]
    ds_read_b128 v[180:183], v223 offset:26624
    s_add_u32 s82, s82, 2048
    v_mfma_f32_16x16x32_bf16 v[68:71], v[184:187], v[148:151], v[68:71]
    s_bitset0_b32 s82, 15
    s_waitcnt lgkmcnt(2)
    v_mfma_f32_16x16x32_bf16 v[16:19], v[160:163], v[152:155], v[16:19]
    ds_read_b128 v[184:187], v223 offset:27648
    s_add_u32 m0, s91, 40960
    v_mfma_f32_16x16x32_bf16 v[20:23], v[160:163], v[156:159], v[20:23]
    buffer_load_dwordx4 v239, s[32:35], s82 offen sc1 lds
    v_mfma_f32_16x16x32_bf16 v[24:27], v[164:167], v[152:155], v[24:27]
    ds_read_b128 v[160:163], v227 offset:0
    v_mfma_f32_16x16x32_bf16 v[28:31], v[164:167], v[156:159], v[28:31]
    buffer_load_dwordx4 v[84:87], v224, s[32:35], s41 offen offset:512 sc1
    ds_read_b64_tr_b16 v[144:145], v240 offset:0
    v_mfma_f32_16x16x32_bf16 v[32:35], v[168:171], v[152:155], v[32:35]
    ds_read_b128 v[164:167], v227 offset:1024
    v_mfma_f32_16x16x32_bf16 v[36:39], v[168:171], v[156:159], v[36:39]
    ds_read_b64_tr_b16 v[146:147], v240 offset:1024
    v_mfma_f32_16x16x32_bf16 v[40:43], v[172:175], v[152:155], v[40:43]
    ds_read_b128 v[168:171], v227 offset:2048
    v_mfma_f32_16x16x32_bf16 v[44:47], v[172:175], v[156:159], v[44:47]
    ds_read_b64_tr_b16 v[148:149], v241 offset:0
    s_waitcnt lgkmcnt(6)
    v_mfma_f32_16x16x32_bf16 v[48:51], v[176:179], v[152:155], v[48:51]
    ds_read_b128 v[172:175], v227 offset:3072
    v_mfma_f32_16x16x32_bf16 v[52:55], v[176:179], v[156:159], v[52:55]
    ds_read_b64_tr_b16 v[150:151], v241 offset:1024
    v_mfma_f32_16x16x32_bf16 v[56:59], v[180:183], v[152:155], v[56:59]
    ds_read_b128 v[176:179], v227 offset:4096
    v_mfma_f32_16x16x32_bf16 v[60:63], v[180:183], v[156:159], v[60:63]
    buffer_load_dwordx4 v239, s[32:35], s82 offen offset:1024 sc1 lds
    v_mfma_f32_16x16x32_bf16 v[64:67], v[184:187], v[152:155], v[64:67]
    ds_read_b128 v[180:183], v227 offset:5120
    s_add_u32 s82, s82, 2048
    v_mfma_f32_16x16x32_bf16 v[68:71], v[184:187], v[156:159], v[68:71]
    s_bitset0_b32 s82, 15
    s_waitcnt lgkmcnt(2)
    v_mfma_f32_16x16x32_bf16 v[16:19], v[160:163], v[144:147], v[16:19]
    ds_read_b128 v[184:187], v227 offset:6144
    s_add_u32 m0, s91, 0
    v_mfma_f32_16x16x32_bf16 v[20:23], v[160:163], v[148:151], v[20:23]
    buffer_load_dwordx4 v239, s[32:35], s82 offen sc1 lds
    v_mfma_f32_16x16x32_bf16 v[24:27], v[164:167], v[144:147], v[24:27]
    ds_read_b128 v[160:163], v227 offset:7168
    v_mfma_f32_16x16x32_bf16 v[28:31], v[164:167], v[148:151], v[28:31]
    s_waitcnt vmcnt(11)
    ds_read_b64_tr_b16 v[152:153], v240 offset:8192
    v_mfma_f32_16x16x32_bf16 v[32:35], v[168:171], v[144:147], v[32:35]
    ds_read_b128 v[164:167], v227 offset:8192
    v_mfma_f32_16x16x32_bf16 v[36:39], v[168:171], v[148:151], v[36:39]
    ds_read_b64_tr_b16 v[154:155], v240 offset:9216
    v_mfma_f32_16x16x32_bf16 v[40:43], v[172:175], v[144:147], v[40:43]
    ds_read_b128 v[168:171], v227 offset:9216
    v_mfma_f32_16x16x32_bf16 v[44:47], v[172:175], v[148:151], v[44:47]
    ds_read_b64_tr_b16 v[156:157], v241 offset:8192
    s_waitcnt lgkmcnt(6)
    v_mfma_f32_16x16x32_bf16 v[48:51], v[176:179], v[144:147], v[48:51]
    ds_read_b128 v[172:175], v227 offset:10240
    v_mfma_f32_16x16x32_bf16 v[52:55], v[176:179], v[148:151], v[52:55]
    ds_read_b64_tr_b16 v[158:159], v241 offset:9216
    v_mfma_f32_16x16x32_bf16 v[56:59], v[180:183], v[144:147], v[56:59]
    ds_read_b128 v[176:179], v227 offset:11264
    v_mfma_f32_16x16x32_bf16 v[60:63], v[180:183], v[148:151], v[60:63]
    buffer_load_dwordx4 v239, s[32:35], s82 offen offset:1024 sc1 lds
    v_mfma_f32_16x16x32_bf16 v[64:67], v[184:187], v[144:147], v[64:67]
    ds_read_b128 v[180:183], v227 offset:12288
    s_add_u32 s82, s82, 2048
    v_mfma_f32_16x16x32_bf16 v[68:71], v[184:187], v[148:151], v[68:71]
    s_bitset0_b32 s82, 15
    s_waitcnt lgkmcnt(2)
    v_mfma_f32_16x16x32_bf16 v[16:19], v[160:163], v[152:155], v[16:19]
    ds_read_b128 v[184:187], v227 offset:13312
    s_add_u32 m0, s91, 8192
    v_mfma_f32_16x16x32_bf16 v[20:23], v[160:163], v[156:159], v[20:23]
    buffer_load_dwordx4 v239, s[32:35], s82 offen sc1 lds
    v_mfma_f32_16x16x32_bf16 v[24:27], v[164:167], v[152:155], v[24:27]
    ds_read_b128 v[160:163], v227 offset:14336
    v_mfma_f32_16x16x32_bf16 v[28:31], v[164:167], v[156:159], v[28:31]
    s_waitcnt vmcnt(11)
    ds_read_b64_tr_b16 v[144:145], v240 offset:16384
    v_mfma_f32_16x16x32_bf16 v[32:35], v[168:171], v[152:155], v[32:35]
    ds_read_b128 v[164:167], v227 offset:15360
    v_mfma_f32_16x16x32_bf16 v[36:39], v[168:171], v[156:159], v[36:39]
    ds_read_b64_tr_b16 v[146:147], v240 offset:17408
    v_mfma_f32_16x16x32_bf16 v[40:43], v[172:175], v[152:155], v[40:43]
    ds_read_b128 v[168:171], v227 offset:16384
    v_mfma_f32_16x16x32_bf16 v[44:47], v[172:175], v[156:159], v[44:47]
    ds_read_b64_tr_b16 v[148:149], v241 offset:16384
    s_waitcnt lgkmcnt(6)
    v_mfma_f32_16x16x32_bf16 v[48:51], v[176:179], v[152:155], v[48:51]
    ds_read_b128 v[172:175], v227 offset:17408
    v_mfma_f32_16x16x32_bf16 v[52:55], v[176:179], v[156:159], v[52:55]
    ds_read_b64_tr_b16 v[150:151], v241 offset:17408
    v_mfma_f32_16x16x32_bf16 v[56:59], v[180:183], v[152:155], v[56:59]
    ds_read_b128 v[176:179], v227 offset:18432
    v_mfma_f32_16x16x32_bf16 v[60:63], v[180:183], v[156:159], v[60:63]
    buffer_load_dwordx4 v239, s[32:35], s82 offen offset:1024 sc1 lds
    v_mfma_f32_16x16x32_bf16 v[64:67], v[184:187], v[152:155], v[64:67]
    ds_read_b128 v[180:183], v227 offset:19456
    s_add_u32 s82, s82, 2048
    v_mfma_f32_16x16x32_bf16 v[68:71], v[184:187], v[156:159], v[68:71]
    s_bitset0_b32 s82, 15
    s_waitcnt lgkmcnt(2)
    v_mfma_f32_16x16x32_bf16 v[16:19], v[160:163], v[144:147], v[16:19]
    ds_read_b128 v[184:187], v227 offset:20480
    s_add_u32 m0, s91, 16384
    s_waitcnt vmcnt(5)
    v_mfma_f32_16x16x32_bf16 v[20:23], v[160:163], v[148:151], v[20:23]
    buffer_load_dwordx4 v239, s[32:35], s82 offen sc1 lds
    v_sad_u32 v8, v83, s46, 0
    v_mfma_f32_16x16x32_bf16 v[24:27], v[164:167], v[144:147], v[24:27]
    ds_read_b128 v[160:163], v227 offset:21504
    v_add_f32 v80, v80, v84
    v_sad_u32 v8, v87, s46, v8
    v_mfma_f32_16x16x32_bf16 v[28:31], v[164:167], v[148:151], v[28:31]
    ds_read_b64_tr_b16 v[152:153], v240 offset:32768
    v_mfma_f32_16x16x32_bf16 v[32:35], v[168:171], v[144:147], v[32:35]
    ds_read_b128 v[164:167], v227 offset:22528
    v_add_f32 v82, v82, v86
    v_cmp_ne_u32 s[86:87], 0, v8
    s_nop 0
    s_cmp_eq_u64 s[86:87], 0
    s_cbranch_scc0 gslow_51
gok_52:
    v_mfma_f32_16x16x32_bf16 v[36:39], v[168:171], v[148:151], v[36:39]
    ds_read_b64_tr_b16 v[154:155], v240 offset:33792
    v_mov_b32 v81, v80
    v_mov_b32 v83, v82
    v_mfma_f32_16x16x32_bf16 v[40:43], v[172:175], v[144:147], v[40:43]
    ds_read_b128 v[168:171], v227 offset:23552
    v_mov_b32 v12, 0x3727c5ac
    v_permlane32_swap_b32 v80, v81
    v_mfma_f32_16x16x32_bf16 v[44:47], v[172:175], v[148:151], v[44:47]
    ds_read_b64_tr_b16 v[156:157], v241 offset:32768
    s_waitcnt lgkmcnt(6)
    v_mfma_f32_16x16x32_bf16 v[48:51], v[176:179], v[144:147], v[48:51]
    ds_read_b128 v[172:175], v227 offset:24576
    v_permlane32_swap_b32 v82, v83
    v_add_f32 v80, v80, v81
    v_mfma_f32_16x16x32_bf16 v[52:55], v[176:179], v[148:151], v[52:55]
    ds_read_b64_tr_b16 v[158:159], v241 offset:33792
    v_add_f32 v82, v82, v83
    v_mul_f32 v80, 0xbb000000, v80
    v_mfma_f32_16x16x32_bf16 v[56:59], v[180:183], v[144:147], v[56:59]
    ds_read_b128 v[176:179], v227 offset:25600
    v_fmac_f32 v12, 0x3b000000, v82
    v_cvt_pk_bf16_f32 v11, v80, 0
    v_mfma_f32_16x16x32_bf16 v[60:63], v[180:183], v[148:151], v[60:63]
    buffer_load_dwordx4 v239, s[32:35], s82 offen offset:1024 sc1 lds
    v_fma_f32 v12, -v80, v80, v12
    v_lshlrev_b32 v81, 16, v11
    v_mfma_f32_16x16x32_bf16 v[64:67], v[184:187], v[144:147], v[64:67]
    ds_read_b128 v[180:183], v227 offset:26624
    s_add_u32 s82, s82, 2048
    v_max_f32 v12, 0x3727c5ac, v12
    v_mfma_f32_16x16x32_bf16 v[68:71], v[184:187], v[148:151], v[68:71]
    s_bitset0_b32 s82, 15
    s_waitcnt lgkmcnt(2)
    v_mfma_f32_16x16x32_bf16 v[16:19], v[160:163], v[152:155], v[16:19]
    ds_read_b128 v[184:187], v227 offset:27648
    s_add_u32 m0, s91, 32768
    v_sub_f32 v81, v80, v81
    v_mfma_f32_16x16x32_bf16 v[20:23], v[160:163], v[156:159], v[20:23]
    buffer_load_dwordx4 v239, s[32:35], s82 offen sc1 lds
    v_rcp_f32 v12, v12
    v_mfma_f32_16x16x32_bf16 v[24:27], v[164:167], v[152:155], v[24:27]
    ds_read_b128 v[160:163], v221 offset:0
    v_cvt_pk_bf16_f32 v10, v80, v81
    v_mfma_f32_16x16x32_bf16 v[28:31], v[164:167], v[156:159], v[28:31]
    ds_read_b64_tr_b16 v[144:145], v240 offset:24576
    v_mfma_f32_16x16x32_bf16 v[32:35], v[168:171], v[152:155], v[32:35]
    ds_read_b128 v[164:167], v221 offset:1024
    ds_read_b64_tr_b16 v[188:189], v226 offset:24576
    v_mfma_f32_16x16x32_bf16 v[36:39], v[168:171], v[156:159], v[36:39]
    ds_read_b64_tr_b16 v[146:147], v240 offset:25600
    v_mfma_f32_16x16x32_bf16 v[40:43], v[172:175], v[152:155], v[40:43]
    ds_read_b128 v[168:171], v221 offset:2048
    ds_read_b64_tr_b16 v[190:191], v226 offset:25600
    v_mfma_f32_16x16x32_bf16 v[44:47], v[172:175], v[156:159], v[44:47]
    ds_read_b64_tr_b16 v[148:149], v241 offset:24576
    s_waitcnt lgkmcnt(8)
    v_mfma_f32_16x16x32_bf16 v[48:51], v[176:179], v[152:155], v[48:51]
    ds_read_b128 v[172:175], v221 offset:3072
    v_mfma_f32_16x16x32_bf16 v[52:55], v[176:179], v[156:159], v[52:55]
    ds_read_b64_tr_b16 v[150:151], v241 offset:25600
    v_mfma_f32_16x16x32_bf16 v[56:59], v[180:183], v[152:155], v[56:59]
    ds_read_b128 v[176:179], v221 offset:4096
    v_mfma_f32_16x16x32_bf16 v[60:63], v[180:183], v[156:159], v[60:63]
    buffer_load_dwordx4 v239, s[32:35], s82 offen offset:1024 sc1 lds
    v_mfma_f32_16x16x32_bf16 v[64:67], v[184:187], v[152:155], v[64:67]
    ds_read_b128 v[180:183], v221 offset:5120
    s_add_u32 s82, s82, 2048
    v_mfma_f32_16x16x32_bf16 v[68:71], v[184:187], v[156:159], v[68:71]
    s_bitset0_b32 s82, 15
    v_mfma_f32_16x16x4_4b_bf16 v[16:31], v[248:249], v[10:11], v[16:31]
    s_mul_i32 s71, s81, 3712
    s_add_u32 s71, s71, 29360128
    v_mfma_f32_16x16x4_4b_bf16 v[32:47], v[250:251], v[10:11], v[32:47]
    v_lshrrev_b32 v9, 1, v232
    v_lshrrev_b32 v13, 2, v232
    v_mfma_f32_16x16x4_4b_bf16 v[48:63], v[252:253], v[10:11], v[48:63]
    v_mfma_f32_16x16x4_4b_bf16 v[64:79], v[254:255], v[10:11], v[64:79]
    s_mov_b32 exec_hi, 0
    buffer_store_dword v12, v13, s[32:35], s71 offen offset:3584 sc1
    s_mov_b32 exec_hi, -1
    s_nop 1
    v_max_f32 v16, 0, v16
    v_max_f32 v17, 0, v17
    v_max_f32 v18, 0, v18
    v_max_f32 v19, 0, v19
    v_pk_mul_f32 v[16:17], v[16:17], v[24:25]
    v_pk_mul_f32 v[18:19], v[18:19], v[26:27]
    v_max_f32 v32, 0, v32
    v_max_f32 v33, 0, v33
    v_max_f32 v34, 0, v34
    v_max_f32 v35, 0, v35
    v_pk_mul_f32 v[32:33], v[32:33], v[40:41]
    v_pk_mul_f32 v[34:35], v[34:35], v[42:43]
    v_cvt_pk_bf16_f32 v24, v16, v17
    v_cvt_pk_bf16_f32 v25, v18, v19
    v_cvt_pk_bf16_f32 v26, v32, v33
    v_cvt_pk_bf16_f32 v27, v34, v35
    buffer_store_dwordx4 v[24:27], v232, s[32:35], s71 offen offset:0 sc1
    v_max_f32 v20, 0, v20
    v_max_f32 v21, 0, v21
    v_max_f32 v22, 0, v22
    v_max_f32 v23, 0, v23
    v_pk_mul_f32 v[20:21], v[20:21], v[28:29]
    v_pk_mul_f32 v[22:23], v[22:23], v[30:31]
    v_max_f32 v36, 0, v36
    v_max_f32 v37, 0, v37
    v_max_f32 v38, 0, v38
    v_max_f32 v39, 0, v39
    v_pk_mul_f32 v[36:37], v[36:37], v[44:45]
    v_pk_mul_f32 v[38:39], v[38:39], v[46:47]
    v_cvt_pk_bf16_f32 v28, v20, v21
    v_cvt_pk_bf16_f32 v29, v22, v23
    v_cvt_pk_bf16_f32 v30, v36, v37
    v_cvt_pk_bf16_f32 v31, v38, v39
    buffer_store_dwordx4 v[28:31], v232, s[32:35], s71 offen offset:1024 sc1
    v_max_f32 v48, 0, v48
    v_max_f32 v49, 0, v49
    v_max_f32 v50, 0, v50
    v_max_f32 v51, 0, v51
    v_pk_mul_f32 v[48:49], v[48:49], v[56:57]
    v_pk_mul_f32 v[50:51], v[50:51], v[58:59]
    v_max_f32 v52, 0, v52
    v_max_f32 v53, 0, v53
    v_max_f32 v54, 0, v54
    v_max_f32 v55, 0, v55
    v_pk_mul_f32 v[52:53], v[52:53], v[60:61]
    v_pk_mul_f32 v[54:55], v[54:55], v[62:63]
    v_cvt_pk_bf16_f32 v56, v48, v49
    v_cvt_pk_bf16_f32 v57, v50, v51
    v_cvt_pk_bf16_f32 v58, v52, v53
    v_cvt_pk_bf16_f32 v59, v54, v55
    v_permlane32_swap_b32 v64, v66
    v_permlane32_swap_b32 v65, v67
    v_permlane32_swap_b32 v68, v70
    v_permlane32_swap_b32 v69, v71
    v_max_f32 v64, 0, v64
    v_max_f32 v65, 0, v65
    v_pk_mul_f32 v[64:65], v[64:65], v[66:67]
    v_max_f32 v68, 0, v68
    v_max_f32 v69, 0, v69
    v_pk_mul_f32 v[68:69], v[68:69], v[70:71]
    v_cvt_pk_bf16_f32 v66, v64, v65
    v_cvt_pk_bf16_f32 v67, v68, v69
    s_waitcnt lgkmcnt(2)
    v_mfma_f32_16x16x32_bf16 v[80:83], v[160:163], v[144:147], 0
    v_mfma_f32_16x16x32_bf16 v[192:195], v[188:191], v[188:191], 0
    v_mfma_f32_16x16x32_bf16 v[196:199], v[200:203], v[188:191], 0
    ds_read_b128 v[184:187], v221 offset:6144
    s_add_u32 m0, s91, 24576
    v_mfma_f32_16x16x32_bf16 v[84:87], v[160:163], v[148:151], 0
    buffer_load_dwordx4 v239, s[32:35], s82 offen sc1 lds
    buffer_store_dwordx4 v[56:59], v232, s[32:35], s71 offen offset:2048 sc1
    v_mfma_f32_16x16x32_bf16 v[88:91], v[164:167], v[144:147], 0
    ds_read_b128 v[160:163], v221 offset:7168
    v_mfma_f32_16x16x32_bf16 v[92:95], v[164:167], v[148:151], 0
    s_waitcnt vmcnt(13)
    ds_read_b64_tr_b16 v[152:153], v240 offset:40960
    v_mfma_f32_16x16x32_bf16 v[96:99], v[168:171], v[144:147], 0
    ds_read_b128 v[164:167], v221 offset:8192
    ds_read_b64_tr_b16 v[188:189], v226 offset:40960
    v_mfma_f32_16x16x32_bf16 v[100:103], v[168:171], v[148:151], 0
    ds_read_b64_tr_b16 v[154:155], v240 offset:41984
    v_mfma_f32_16x16x32_bf16 v[104:107], v[172:175], v[144:147], 0
    ds_read_b128 v[168:171], v221 offset:9216
    ds_read_b64_tr_b16 v[190:191], v226 offset:41984
    v_mfma_f32_16x16x32_bf16 v[108:111], v[172:175], v[148:151], 0
    ds_read_b64_tr_b16 v[156:157], v241 offset:40960
    s_waitcnt lgkmcnt(8)
    v_mfma_f32_16x16x32_bf16 v[112:115], v[176:179], v[144:147], 0
    ds_read_b128 v[172:175], v221 offset:10240
    v_mfma_f32_16x16x32_bf16 v[116:119], v[176:179], v[148:151], 0
    ds_read_b64_tr_b16 v[158:159], v241 offset:41984
    buffer_store_dwordx2 v[66:67], v9, s[32:35], s71 offen offset:3072 sc1
    v_mfma_f32_16x16x32_bf16 v[120:123], v[180:183], v[144:147], 0
    ds_read_b128 v[176:179], v221 offset:11264
    v_mfma_f32_16x16x32_bf16 v[124:127], v[180:183], v[148:151], 0
    buffer_load_dwordx4 v239, s[32:35], s82 offen offset:1024 sc1 lds
    v_mfma_f32_16x16x32_bf16 v[128:131], v[184:187], v[144:147], 0
    ds_read_b128 v[180:183], v221 offset:12288
    s_add_u32 s82, s82, 2048
    v_mfma_f32_16x16x32_bf16 v[132:135], v[184:187], v[148:151], 0
    s_bitset0_b32 s82, 15
    s_waitcnt lgkmcnt(2)
    v_mfma_f32_16x16x32_bf16 v[80:83], v[160:163], v[152:155], v[80:83]
    v_mfma_f32_16x16x32_bf16 v[192:195], v[188:191], v[188:191], v[192:195]
    v_mfma_f32_16x16x32_bf16 v[196:199], v[200:203], v[188:191], v[196:199]
    ds_read_b128 v[184:187], v221 offset:13312
    s_add_u32 m0, s91, 40960
    v_mfma_f32_16x16x32_bf16 v[84:87], v[160:163], v[156:159], v[84:87]
    buffer_load_dwordx4 v239, s[32:35], s82 offen sc1 lds
    v_mfma_f32_16x16x32_bf16 v[88:91], v[164:167], v[152:155], v[88:91]
    ds_read_b128 v[160:163], v221 offset:14336
    v_mfma_f32_16x16x32_bf16 v[92:95], v[164:167], v[156:159], v[92:95]
    s_waitcnt vmcnt(14)
    ds_read_b64_tr_b16 v[144:145], v240 offset:0
    v_mfma_f32_16x16x32_bf16 v[96:99], v[168:171], v[152:155], v[96:99]
    ds_read_b128 v[164:167], v221 offset:15360
    ds_read_b64_tr_b16 v[188:189], v226 offset:0
    v_mfma_f32_16x16x32_bf16 v[100:103], v[168:171], v[156:159], v[100:103]
    ds_read_b64_tr_b16 v[146:147], v240 offset:1024
    v_mfma_f32_16x16x32_bf16 v[104:107], v[172:175], v[152:155], v[104:107]
    ds_read_b128 v[168:171], v221 offset:16384
    ds_read_b64_tr_b16 v[190:191], v226 offset:1024
    v_mfma_f32_16x16x32_bf16 v[108:111], v[172:175], v[156:159], v[108:111]
    ds_read_b64_tr_b16 v[148:149], v241 offset:0
    s_waitcnt lgkmcnt(8)
    v_mfma_f32_16x16x32_bf16 v[112:115], v[176:179], v[152:155], v[112:115]
    ds_read_b128 v[172:175], v221 offset:17408
    v_mfma_f32_16x16x32_bf16 v[116:119], v[176:179], v[156:159], v[116:119]
    ds_read_b64_tr_b16 v[150:151], v241 offset:1024
    v_mfma_f32_16x16x32_bf16 v[120:123], v[180:183], v[152:155], v[120:123]
    ds_read_b128 v[176:179], v221 offset:18432
    v_mfma_f32_16x16x32_bf16 v[124:127], v[180:183], v[156:159], v[124:127]
    buffer_load_dwordx4 v239, s[32:35], s82 offen offset:1024 sc1 lds
    v_mfma_f32_16x16x32_bf16 v[128:131], v[184:187], v[152:155], v[128:131]
    ds_read_b128 v[180:183], v221 offset:19456
    s_add_u32 s82, s82, 2048
    v_mfma_f32_16x16x32_bf16 v[132:135], v[184:187], v[156:159], v[132:135]
    s_bitset0_b32 s82, 15
    s_waitcnt lgkmcnt(2)
    v_mfma_f32_16x16x32_bf16 v[80:83], v[160:163], v[144:147], v[80:83]
    v_mfma_f32_16x16x32_bf16 v[192:195], v[188:191], v[188:191], v[192:195]
    v_mfma_f32_16x16x32_bf16 v[196:199], v[200:203], v[188:191], v[196:199]
    ds_read_b128 v[184:187], v221 offset:20480
    s_add_u32 m0, s91, 0
    v_mfma_f32_16x16x32_bf16 v[84:87], v[160:163], v[148:151], v[84:87]
    buffer_load_dwordx4 v239, s[32:35], s82 offen sc1 lds
    v_mfma_f32_16x16x32_bf16 v[88:91], v[164:167], v[144:147], v[88:91]
    ds_read_b128 v[160:163], v221 offset:21504
    v_mfma_f32_16x16x32_bf16 v[92:95], v[164:167], v[148:151], v[92:95]
    s_waitcnt vmcnt(14)
    ds_read_b64_tr_b16 v[152:153], v240 offset:8192
    v_mfma_f32_16x16x32_bf16 v[96:99], v[168:171], v[144:147], v[96:99]
    ds_read_b128 v[164:167], v221 offset:22528
    ds_read_b64_tr_b16 v[188:189], v226 offset:8192
    v_mfma_f32_16x16x32_bf16 v[100:103], v[168:171], v[148:151], v[100:103]
    ds_read_b64_tr_b16 v[154:155], v240 offset:9216
    v_mfma_f32_16x16x32_bf16 v[104:107], v[172:175], v[144:147], v[104:107]
    ds_read_b128 v[168:171], v221 offset:23552
    ds_read_b64_tr_b16 v[190:191], v226 offset:9216
    v_mfma_f32_16x16x32_bf16 v[108:111], v[172:175], v[148:151], v[108:111]
    ds_read_b64_tr_b16 v[156:157], v241 offset:8192
    s_waitcnt lgkmcnt(8)
    v_mfma_f32_16x16x32_bf16 v[112:115], v[176:179], v[144:147], v[112:115]
    ds_read_b128 v[172:175], v221 offset:24576
    v_mfma_f32_16x16x32_bf16 v[116:119], v[176:179], v[148:151], v[116:119]
    ds_read_b64_tr_b16 v[158:159], v241 offset:9216
    v_mfma_f32_16x16x32_bf16 v[120:123], v[180:183], v[144:147], v[120:123]
    ds_read_b128 v[176:179], v221 offset:25600
    v_mfma_f32_16x16x32_bf16 v[124:127], v[180:183], v[148:151], v[124:127]
    buffer_load_dwordx4 v239, s[32:35], s82 offen offset:1024 sc1 lds
    v_mfma_f32_16x16x32_bf16 v[128:131], v[184:187], v[144:147], v[128:131]
    ds_read_b128 v[180:183], v221 offset:26624
    s_add_u32 s82, s82, 2048
    v_mfma_f32_16x16x32_bf16 v[132:135], v[184:187], v[148:151], v[132:135]
    s_bitset0_b32 s82, 15
    s_waitcnt lgkmcnt(2)
    v_mfma_f32_16x16x32_bf16 v[80:83], v[160:163], v[152:155], v[80:83]
    v_mfma_f32_16x16x32_bf16 v[192:195], v[188:191], v[188:191], v[192:195]
    v_mfma_f32_16x16x32_bf16 v[196:199], v[200:203], v[188:191], v[196:199]
    ds_read_b128 v[184:187], v221 offset:27648
    s_add_u32 m0, s91, 8192
    v_mfma_f32_16x16x32_bf16 v[84:87], v[160:163], v[156:159], v[84:87]
    buffer_load_dwordx4 v239, s[32:35], s82 offen sc1 lds
    v_mfma_f32_16x16x32_bf16 v[88:91], v[164:167], v[152:155], v[88:91]
    ds_read_b128 v[160:163], v222 offset:0
    v_mfma_f32_16x16x32_bf16 v[92:95], v[164:167], v[156:159], v[92:95]
    s_waitcnt vmcnt(14)
    ds_read_b64_tr_b16 v[144:145], v240 offset:16384
    v_mfma_f32_16x16x32_bf16 v[96:99], v[168:171], v[152:155], v[96:99]
    ds_read_b128 v[164:167], v222 offset:1024
    v_mfma_f32_16x16x32_bf16 v[100:103], v[168:171], v[156:159], v[100:103]
    ds_read_b64_tr_b16 v[146:147], v240 offset:17408
    v_mfma_f32_16x16x32_bf16 v[104:107], v[172:175], v[152:155], v[104:107]
    ds_read_b128 v[168:171], v222 offset:2048
    v_mfma_f32_16x16x32_bf16 v[108:111], v[172:175], v[156:159], v[108:111]
    ds_read_b64_tr_b16 v[148:149], v241 offset:16384
    s_waitcnt lgkmcnt(6)
    v_mfma_f32_16x16x32_bf16 v[112:115], v[176:179], v[152:155], v[112:115]
    ds_read_b128 v[172:175], v222 offset:3072
    s_mov_b32 s42, 0x22222222
    v_mfma_f32_16x16x32_bf16 v[116:119], v[176:179], v[156:159], v[116:119]
    ds_read_b64_tr_b16 v[150:151], v241 offset:17408
    s_mov_b32 s43, 0x22222222
    v_mfma_f32_16x16x32_bf16 v[120:123], v[180:183], v[152:155], v[120:123]
    ds_read_b128 v[176:179], v222 offset:4096
    v_cndmask_b32 v192, v192, v193, s[42:43]
    v_mfma_f32_16x16x32_bf16 v[124:127], v[180:183], v[156:159], v[124:127]
    buffer_load_dwordx4 v239, s[32:35], s82 offen offset:1024 sc1 lds
    s_mov_b32 s42, 0x44444444
    v_mfma_f32_16x16x32_bf16 v[128:131], v[184:187], v[152:155], v[128:131]
    ds_read_b128 v[180:183], v222 offset:5120
    s_add_u32 s82, s82, 2048
    v_mfma_f32_16x16x32_bf16 v[132:135], v[184:187], v[156:159], v[132:135]
    s_bitset0_b32 s82, 15
    s_waitcnt lgkmcnt(2)
    v_mfma_f32_16x16x32_bf16 v[80:83], v[160:163], v[144:147], v[80:83]
    ds_read_b128 v[184:187], v222 offset:6144
    s_add_u32 m0, s91, 16384
    v_mfma_f32_16x16x32_bf16 v[84:87], v[160:163], v[148:151], v[84:87]
    buffer_load_dwordx4 v239, s[32:35], s82 offen sc1 lds
    s_mov_b32 s43, 0x44444444
    v_mfma_f32_16x16x32_bf16 v[88:91], v[164:167], v[144:147], v[88:91]
    ds_read_b128 v[160:163], v222 offset:7168
    v_cndmask_b32 v192, v192, v194, s[42:43]
    v_mfma_f32_16x16x32_bf16 v[92:95], v[164:167], v[148:151], v[92:95]
    s_waitcnt vmcnt(14)
    ds_read_b64_tr_b16 v[152:153], v240 offset:32768
    v_mfma_f32_16x16x32_bf16 v[96:99], v[168:171], v[144:147], v[96:99]
    ds_read_b128 v[164:167], v222 offset:8192
    s_mov_b32 s42, 0x88888888
    v_mfma_f32_16x16x32_bf16 v[100:103], v[168:171], v[148:151], v[100:103]
    ds_read_b64_tr_b16 v[154:155], v240 offset:33792
    s_mov_b32 s43, 0x88888888
    v_mfma_f32_16x16x32_bf16 v[104:107], v[172:175], v[144:147], v[104:107]
    ds_read_b128 v[168:171], v222 offset:9216
    v_cndmask_b32 v198, v192, v195, s[42:43]
    v_mfma_f32_16x16x32_bf16 v[108:111], v[172:175], v[148:151], v[108:111]
    ds_read_b64_tr_b16 v[156:157], v241 offset:32768
    s_waitcnt lgkmcnt(6)
    v_mfma_f32_16x16x32_bf16 v[112:115], v[176:179], v[144:147], v[112:115]
    ds_read_b128 v[172:175], v222 offset:10240
    v_mov_b32 v199, s46
    v_mfma_f32_16x16x32_bf16 v[116:119], v[176:179], v[148:151], v[116:119]
    ds_read_b64_tr_b16 v[158:159], v241 offset:33792
    s_mov_b32 s41, 12189696
    v_mfma_f32_16x16x32_bf16 v[120:123], v[180:183], v[144:147], v[120:123]
    ds_read_b128 v[176:179], v222 offset:11264
    s_mov_b32 exec_lo, 0x00f0000f
    s_mov_b32 exec_hi, 0xf0000f00
    buffer_store_dwordx4 v[196:199], v225, s[32:35], s41 offen sc1
    s_mov_b64 exec, -1
    v_mfma_f32_16x16x32_bf16 v[124:127], v[180:183], v[148:151], v[124:127]
    buffer_load_dwordx4 v239, s[32:35], s82 offen offset:1024 sc1 lds
    v_mfma_f32_16x16x32_bf16 v[128:131], v[184:187], v[144:147], v[128:131]
    ds_read_b128 v[180:183], v222 offset:12288
    s_add_u32 s82, s82, 2048
    s_waitcnt vmcnt(10)
    s_lshl_b32 s70, s81, 6
    s_add_u32 s70, s70, 0
    v_mov_b32 v214, s46
    v_mov_b32 v215, s47
    v_mov_b32 v216, s70
    s_mov_b64 exec, 1
    buffer_store_dwordx2 v[214:215], v216, s[32:35], s62 offen sc1
    s_mov_b64 exec, -1
    v_mfma_f32_16x16x32_bf16 v[132:135], v[184:187], v[148:151], v[132:135]
    s_bitset0_b32 s82, 15
    s_waitcnt lgkmcnt(2)
    v_mfma_f32_16x16x32_bf16 v[80:83], v[160:163], v[152:155], v[80:83]
    ds_read_b128 v[184:187], v222 offset:13312
    s_add_u32 m0, s91, 32768
    v_mfma_f32_16x16x32_bf16 v[84:87], v[160:163], v[156:159], v[84:87]
    buffer_load_dwordx4 v239, s[32:35], s82 offen sc1 lds
    v_mfma_f32_16x16x32_bf16 v[88:91], v[164:167], v[152:155], v[88:91]
    ds_read_b128 v[160:163], v222 offset:14336
    v_mfma_f32_16x16x32_bf16 v[92:95], v[164:167], v[156:159], v[92:95]
    s_waitcnt vmcnt(11)
    ds_read_b64_tr_b16 v[144:145], v240 offset:24576
    v_mfma_f32_16x16x32_bf16 v[96:99], v[168:171], v[152:155], v[96:99]
    ds_read_b128 v[164:167], v222 offset:15360
    v_mfma_f32_16x16x32_bf16 v[100:103], v[168:171], v[156:159], v[100:103]
    ds_read_b64_tr_b16 v[146:147], v240 offset:25600
    v_mfma_f32_16x16x32_bf16 v[104:107], v[172:175], v[152:155], v[104:107]
    ds_read_b128 v[168:171], v222 offset:16384
    v_mfma_f32_16x16x32_bf16 v[108:111], v[172:175], v[156:159], v[108:111]
    ds_read_b64_tr_b16 v[148:149], v241 offset:24576
    s_waitcnt lgkmcnt(6)
    v_mfma_f32_16x16x32_bf16 v[112:115], v[176:179], v[152:155], v[112:115]
    ds_read_b128 v[172:175], v222 offset:17408
    v_mfma_f32_16x16x32_bf16 v[116:119], v[176:179], v[156:159], v[116:119]
    ds_read_b64_tr_b16 v[150:151], v241 offset:25600
    v_mfma_f32_16x16x32_bf16 v[120:123], v[180:183], v[152:155], v[120:123]
    ds_read_b128 v[176:179], v222 offset:18432
    v_mfma_f32_16x16x32_bf16 v[124:127], v[180:183], v[156:159], v[124:127]
    buffer_load_dwordx4 v239, s[32:35], s82 offen offset:1024 sc1 lds
    v_mfma_f32_16x16x32_bf16 v[128:131], v[184:187], v[152:155], v[128:131]
    ds_read_b128 v[180:183], v222 offset:19456
    s_add_u32 s82, s82, 2048
    v_mfma_f32_16x16x32_bf16 v[132:135], v[184:187], v[156:159], v[132:135]
    s_bitset0_b32 s82, 15
    s_waitcnt lgkmcnt(2)
    v_mfma_f32_16x16x32_bf16 v[80:83], v[160:163], v[144:147], v[80:83]
    ds_read_b128 v[184:187], v222 offset:20480
    s_add_u32 m0, s91, 24576
    v_mfma_f32_16x16x32_bf16 v[84:87], v[160:163], v[148:151], v[84:87]
    buffer_load_dwordx4 v239, s[32:35], s82 offen sc1 lds
    s_lshl_b32 s72, s54, 5
    v_mfma_f32_16x16x32_bf16 v[88:91], v[164:167], v[144:147], v[88:91]
    ds_read_b128 v[160:163], v222 offset:21504
    s_lshl_b32 s70, s44, 3
    v_mfma_f32_16x16x32_bf16 v[92:95], v[164:167], v[148:151], v[92:95]
    s_waitcnt vmcnt(11)
    ds_read_b64_tr_b16 v[152:153], v240 offset:40960
    v_mfma_f32_16x16x32_bf16 v[96:99], v[168:171], v[144:147], v[96:99]
    ds_read_b128 v[164:167], v222 offset:22528
    s_add_u32 s72, s72, s70
    v_mfma_f32_16x16x32_bf16 v[100:103], v[168:171], v[148:151], v[100:103]
    ds_read_b64_tr_b16 v[154:155], v240 offset:41984
    v_and_b32 v220, 7, v1
    v_mfma_f32_16x16x32_bf16 v[104:107], v[172:175], v[144:147], v[104:107]
    ds_read_b128 v[168:171], v222 offset:23552
    v_add_lshl_u32 v220, v220, s72, 6
    v_mfma_f32_16x16x32_bf16 v[108:111], v[172:175], v[148:151], v[108:111]
    ds_read_b64_tr_b16 v[156:157], v241 offset:40960
    s_waitcnt lgkmcnt(6)
    v_mfma_f32_16x16x32_bf16 v[112:115], v[176:179], v[144:147], v[112:115]
    ds_read_b128 v[172:175], v222 offset:24576
    s_lshl_b32 s49, s54, 5
    v_mfma_f32_16x16x32_bf16 v[116:119], v[176:179], v[148:151], v[116:119]
    ds_read_b64_tr_b16 v[158:159], v241 offset:41984
    s_lshl_b32 s45, s44, 3
    v_mfma_f32_16x16x32_bf16 v[120:123], v[180:183], v[144:147], v[120:123]
    ds_read_b128 v[176:179], v222 offset:25600
    s_add_u32 s49, s49, s45
    v_mfma_f32_16x16x32_bf16 v[124:127], v[180:183], v[148:151], v[124:127]
    buffer_load_dwordx4 v239, s[32:35], s82 offen offset:1024 sc1 lds
    s_mul_i32 s49, s49, 3712
    v_mfma_f32_16x16x32_bf16 v[128:131], v[184:187], v[144:147], v[128:131]
    ds_read_b128 v[180:183], v222 offset:26624
    s_add_u32 s82, s82, 2048
    v_mfma_f32_16x16x32_bf16 v[132:135], v[184:187], v[148:151], v[132:135]
    s_bitset0_b32 s82, 15
    s_waitcnt lgkmcnt(2)
    v_mfma_f32_16x16x32_bf16 v[80:83], v[160:163], v[152:155], v[80:83]
    ds_read_b128 v[184:187], v222 offset:27648
    s_add_u32 m0, s91, 40960
    v_mfma_f32_16x16x32_bf16 v[84:87], v[160:163], v[156:159], v[84:87]
    buffer_load_dwordx4 v239, s[32:35], s82 offen sc1 lds
    s_add_u32 s49, s49, 29360128
    v_mfma_f32_16x16x32_bf16 v[88:91], v[164:167], v[152:155], v[88:91]
    ds_read_b128 v[160:163], v223 offset:0
    s_mul_i32 s45, s65, 14848
    v_mfma_f32_16x16x32_bf16 v[92:95], v[164:167], v[156:159], v[92:95]
    s_waitcnt vmcnt(11)
    ds_read_b64_tr_b16 v[144:145], v240 offset:0
    v_mfma_f32_16x16x32_bf16 v[96:99], v[168:171], v[152:155], v[96:99]
    ds_read_b128 v[164:167], v223 offset:1024
    s_sub_u32 s95, s49, s45
    v_mfma_f32_16x16x32_bf16 v[100:103], v[168:171], v[156:159], v[100:103]
    ds_read_b64_tr_b16 v[146:147], v240 offset:1024
    s_add_u32 s49, s49, s45
    v_mfma_f32_16x16x32_bf16 v[104:107], v[172:175], v[152:155], v[104:107]
    ds_read_b128 v[168:171], v223 offset:2048
    v_lshrrev_b32 v15, 1, v232
    v_mfma_f32_16x16x32_bf16 v[108:111], v[172:175], v[156:159], v[108:111]
    ds_read_b64_tr_b16 v[148:149], v241 offset:0
    s_waitcnt lgkmcnt(6)
    v_mfma_f32_16x16x32_bf16 v[112:115], v[176:179], v[152:155], v[112:115]
    ds_read_b128 v[172:175], v223 offset:3072
    s_lshr_b32 s45, s44, 1
    v_mfma_f32_16x16x32_bf16 v[116:119], v[176:179], v[156:159], v[116:119]
    ds_read_b64_tr_b16 v[150:151], v241 offset:1024
    s_lshl_b32 s45, s45, 6
    v_mfma_f32_16x16x32_bf16 v[120:123], v[180:183], v[152:155], v[120:123]
    ds_read_b128 v[176:179], v223 offset:4096
    v_lshl_add_u32 v14, v2, 2, s45
    v_mfma_f32_16x16x32_bf16 v[124:127], v[180:183], v[156:159], v[124:127]
    buffer_load_dwordx4 v239, s[32:35], s82 offen offset:1024 sc1 lds
    v_mfma_f32_16x16x32_bf16 v[128:131], v[184:187], v[152:155], v[128:131]
    ds_read_b128 v[180:183], v223 offset:5120
    s_add_u32 s82, s82, 2048
    v_mfma_f32_16x16x32_bf16 v[132:135], v[184:187], v[156:159], v[132:135]
    s_bitset0_b32 s82, 15
    s_waitcnt lgkmcnt(2)
    v_mfma_f32_16x16x32_bf16 v[80:83], v[160:163], v[144:147], v[80:83]
    ds_read_b128 v[184:187], v223 offset:6144
    s_add_u32 m0, s91, 0
    v_mfma_f32_16x16x32_bf16 v[84:87], v[160:163], v[148:151], v[84:87]
    buffer_load_dwordx4 v239, s[32:35], s82 offen sc1 lds
    v_mfma_f32_16x16x32_bf16 v[88:91], v[164:167], v[144:147], v[88:91]
    ds_read_b128 v[160:163], v223 offset:7168
    v_mfma_f32_16x16x32_bf16 v[92:95], v[164:167], v[148:151], v[92:95]
    s_waitcnt vmcnt(11)
    ds_read_b64_tr_b16 v[152:153], v240 offset:8192
    v_mfma_f32_16x16x32_bf16 v[96:99], v[168:171], v[144:147], v[96:99]
    ds_read_b128 v[164:167], v223 offset:8192
    v_mfma_f32_16x16x32_bf16 v[100:103], v[168:171], v[148:151], v[100:103]
    ds_read_b64_tr_b16 v[154:155], v240 offset:9216
    v_mfma_f32_16x16x32_bf16 v[104:107], v[172:175], v[144:147], v[104:107]
    ds_read_b128 v[168:171], v223 offset:9216
    v_mfma_f32_16x16x32_bf16 v[108:111], v[172:175], v[148:151], v[108:111]
    ds_read_b64_tr_b16 v[156:157], v241 offset:8192
    s_waitcnt lgkmcnt(6)
    v_mfma_f32_16x16x32_bf16 v[112:115], v[176:179], v[144:147], v[112:115]
    ds_read_b128 v[172:175], v223 offset:10240
    v_mfma_f32_16x16x32_bf16 v[116:119], v[176:179], v[148:151], v[116:119]
    ds_read_b64_tr_b16 v[158:159], v241 offset:9216
    v_mfma_f32_16x16x32_bf16 v[120:123], v[180:183], v[144:147], v[120:123]
    ds_read_b128 v[176:179], v223 offset:11264
    v_mfma_f32_16x16x32_bf16 v[124:127], v[180:183], v[148:151], v[124:127]
    buffer_load_dwordx4 v239, s[32:35], s82 offen offset:1024 sc1 lds
    v_mfma_f32_16x16x32_bf16 v[128:131], v[184:187], v[144:147], v[128:131]
    ds_read_b128 v[180:183], v223 offset:12288
    s_add_u32 s82, s82, 2048
    buffer_load_dwordx2 v[218:219], v220, s[32:35], s62 offen sc1
    v_mfma_f32_16x16x32_bf16 v[132:135], v[184:187], v[148:151], v[132:135]
    s_bitset0_b32 s82, 15
    s_waitcnt lgkmcnt(2)
    v_mfma_f32_16x16x32_bf16 v[80:83], v[160:163], v[152:155], v[80:83]
    ds_read_b128 v[184:187], v223 offset:13312
    s_add_u32 m0, s91, 8192
    v_mfma_f32_16x16x32_bf16 v[84:87], v[160:163], v[156:159], v[84:87]
    buffer_load_dwordx4 v239, s[32:35], s82 offen sc1 lds
    v_mfma_f32_16x16x32_bf16 v[88:91], v[164:167], v[152:155], v[88:91]
    ds_read_b128 v[160:163], v223 offset:14336
    v_mfma_f32_16x16x32_bf16 v[92:95], v[164:167], v[156:159], v[92:95]
    s_waitcnt vmcnt(11)
    ds_read_b64_tr_b16 v[144:145], v240 offset:16384
    v_mfma_f32_16x16x32_bf16 v[96:99], v[168:171], v[152:155], v[96:99]
    ds_read_b128 v[164:167], v223 offset:15360
    v_mfma_f32_16x16x32_bf16 v[100:103], v[168:171], v[156:159], v[100:103]
    ds_read_b64_tr_b16 v[146:147], v240 offset:17408
    v_mfma_f32_16x16x32_bf16 v[104:107], v[172:175], v[152:155], v[104:107]
    ds_read_b128 v[168:171], v223 offset:16384
    v_mfma_f32_16x16x32_bf16 v[108:111], v[172:175], v[156:159], v[108:111]
    ds_read_b64_tr_b16 v[148:149], v241 offset:16384
    s_waitcnt lgkmcnt(6)
    v_mfma_f32_16x16x32_bf16 v[112:115], v[176:179], v[152:155], v[112:115]
    ds_read_b128 v[172:175], v223 offset:17408
    v_mfma_f32_16x16x32_bf16 v[116:119], v[176:179], v[156:159], v[116:119]
    ds_read_b64_tr_b16 v[150:151], v241 offset:17408
    v_mfma_f32_16x16x32_bf16 v[120:123], v[180:183], v[152:155], v[120:123]
    ds_read_b128 v[176:179], v223 offset:18432
    v_mfma_f32_16x16x32_bf16 v[124:127], v[180:183], v[156:159], v[124:127]
    buffer_load_dwordx4 v239, s[32:35], s82 offen offset:1024 sc1 lds
    v_mfma_f32_16x16x32_bf16 v[128:131], v[184:187], v[152:155], v[128:131]
    ds_read_b128 v[180:183], v223 offset:19456
    s_add_u32 s82, s82, 2048
    v_mfma_f32_16x16x32_bf16 v[132:135], v[184:187], v[156:159], v[132:135]
    s_bitset0_b32 s82, 15
    s_waitcnt lgkmcnt(2)
    v_mfma_f32_16x16x32_bf16 v[80:83], v[160:163], v[144:147], v[80:83]
    ds_read_b128 v[184:187], v223 offset:20480
    v_mfma_f32_16x16x32_bf16 v[84:87], v[160:163], v[148:151], v[84:87]
    v_mfma_f32_16x16x32_bf16 v[88:91], v[164:167], v[144:147], v[88:91]
    ds_read_b128 v[160:163], v223 offset:21504
    v_mfma_f32_16x16x32_bf16 v[92:95], v[164:167], v[148:151], v[92:95]
    s_waitcnt vmcnt(9)
    ds_read_b64_tr_b16 v[152:153], v240 offset:32768
    v_mfma_f32_16x16x32_bf16 v[96:99], v[168:171], v[144:147], v[96:99]
    ds_read_b128 v[164:167], v223 offset:22528
    v_mfma_f32_16x16x32_bf16 v[100:103], v[168:171], v[148:151], v[100:103]
    ds_read_b64_tr_b16 v[154:155], v240 offset:33792
    v_mfma_f32_16x16x32_bf16 v[104:107], v[172:175], v[144:147], v[104:107]
    ds_read_b128 v[168:171], v223 offset:23552
    v_mfma_f32_16x16x32_bf16 v[108:111], v[172:175], v[148:151], v[108:111]
    ds_read_b64_tr_b16 v[156:157], v241 offset:32768
    s_waitcnt lgkmcnt(6)
    v_mfma_f32_16x16x32_bf16 v[112:115], v[176:179], v[144:147], v[112:115]
    ds_read_b128 v[172:175], v223 offset:24576
    v_mfma_f32_16x16x32_bf16 v[116:119], v[176:179], v[148:151], v[116:119]
    ds_read_b64_tr_b16 v[158:159], v241 offset:33792
    buffer_load_dwordx4 v[16:19], v224, s[32:35], s41 offen offset:0 sc1
    v_mfma_f32_16x16x32_bf16 v[120:123], v[180:183], v[144:147], v[120:123]
    ds_read_b128 v[176:179], v223 offset:25600
    v_mfma_f32_16x16x32_bf16 v[124:127], v[180:183], v[148:151], v[124:127]
    v_mfma_f32_16x16x32_bf16 v[128:131], v[184:187], v[144:147], v[128:131]
    ds_read_b128 v[180:183], v223 offset:26624
    v_mfma_f32_16x16x32_bf16 v[132:135], v[184:187], v[148:151], v[132:135]
    s_waitcnt lgkmcnt(2)
    v_mfma_f32_16x16x32_bf16 v[80:83], v[160:163], v[152:155], v[80:83]
    ds_read_b128 v[184:187], v223 offset:27648
    s_add_u32 m0, s91, 16384
    v_mfma_f32_16x16x32_bf16 v[84:87], v[160:163], v[156:159], v[84:87]
    s_mov_b32 s68, 8387584
    s_mov_b32 s69, 7340032
    v_mfma_f32_16x16x32_bf16 v[88:91], v[164:167], v[152:155], v[88:91]
    ds_read_b128 v[160:163], v227 offset:0
    buffer_load_dwordx4 v242, s[32:35], s69 offen sc1 lds
    v_mfma_f32_16x16x32_bf16 v[92:95], v[164:167], v[156:159], v[92:95]
    buffer_load_dwordx4 v[20:23], v224, s[32:35], s41 offen offset:512 sc1
    s_waitcnt vmcnt(10)
    ds_read_b64_tr_b16 v[144:145], v240 offset:24576
    v_mfma_f32_16x16x32_bf16 v[96:99], v[168:171], v[152:155], v[96:99]
    ds_read_b128 v[164:167], v227 offset:1024
    buffer_load_dwordx4 v242, s[32:35], s68 offen offset:1024 sc1 lds
    v_mfma_f32_16x16x32_bf16 v[100:103], v[168:171], v[156:159], v[100:103]
    ds_read_b64_tr_b16 v[146:147], v240 offset:25600
    v_mfma_f32_16x16x32_bf16 v[104:107], v[172:175], v[152:155], v[104:107]
    ds_read_b128 v[168:171], v227 offset:2048
    v_mfma_f32_16x16x32_bf16 v[108:111], v[172:175], v[156:159], v[108:111]
    ds_read_b64_tr_b16 v[148:149], v241 offset:24576
    s_waitcnt lgkmcnt(6)
    v_mfma_f32_16x16x32_bf16 v[112:115], v[176:179], v[152:155], v[112:115]
    ds_read_b128 v[172:175], v227 offset:3072
    v_mfma_f32_16x16x32_bf16 v[116:119], v[176:179], v[156:159], v[116:119]
    ds_read_b64_tr_b16 v[150:151], v241 offset:25600
    v_mfma_f32_16x16x32_bf16 v[120:123], v[180:183], v[152:155], v[120:123]
    ds_read_b128 v[176:179], v227 offset:4096
    v_mfma_f32_16x16x32_bf16 v[124:127], v[180:183], v[156:159], v[124:127]
    v_mfma_f32_16x16x32_bf16 v[128:131], v[184:187], v[152:155], v[128:131]
    ds_read_b128 v[180:183], v227 offset:5120
    v_mfma_f32_16x16x32_bf16 v[132:135], v[184:187], v[156:159], v[132:135]
    s_waitcnt vmcnt(6)
    v_cmp_ne_u64 s[86:87], s[46:47], v[218:219]
    s_nop 0
    s_cmp_eq_u64 s[86:87], 0
    s_cbranch_scc0 slow_53
ok_54:
    s_waitcnt lgkmcnt(2)
    v_mfma_f32_16x16x32_bf16 v[80:83], v[160:163], v[144:147], v[80:83]
    ds_read_b128 v[184:187], v227 offset:6144
    v_mfma_f32_16x16x32_bf16 v[84:87], v[160:163], v[148:151], v[84:87]
    s_add_u32 s45, s49, 0
    buffer_load_dwordx4 v[32:35], v232, s[32:35], s45 offen offset:0 sc1
    v_mfma_f32_16x16x32_bf16 v[88:91], v[164:167], v[144:147], v[88:91]
    ds_read_b128 v[160:163], v227 offset:7168
    v_mfma_f32_16x16x32_bf16 v[92:95], v[164:167], v[148:151], v[92:95]
    ds_read_b64_tr_b16 v[152:153], v240 offset:40960
    v_mfma_f32_16x16x32_bf16 v[96:99], v[168:171], v[144:147], v[96:99]
    ds_read_b128 v[164:167], v227 offset:8192
    v_mfma_f32_16x16x32_bf16 v[100:103], v[168:171], v[148:151], v[100:103]
    buffer_load_dwordx4 v[36:39], v232, s[32:35], s45 offen offset:1024 sc1
    ds_read_b64_tr_b16 v[154:155], v240 offset:41984
    v_mfma_f32_16x16x32_bf16 v[104:107], v[172:175], v[144:147], v[104:107]
    ds_read_b128 v[168:171], v227 offset:9216
    v_mfma_f32_16x16x32_bf16 v[108:111], v[172:175], v[148:151], v[108:111]
    ds_read_b64_tr_b16 v[156:157], v241 offset:40960
    s_waitcnt lgkmcnt(6)
    v_mfma_f32_16x16x32_bf16 v[112:115], v[176:179], v[144:147], v[112:115]
    ds_read_b128 v[172:175], v227 offset:10240
    v_mfma_f32_16x16x32_bf16 v[116:119], v[176:179], v[148:151], v[116:119]
    s_add_u32 s45, s49, 3712
    buffer_load_dwordx4 v[40:43], v232, s[32:35], s45 offen offset:0 sc1
    ds_read_b64_tr_b16 v[158:159], v241 offset:41984
    v_mfma_f32_16x16x32_bf16 v[120:123], v[180:183], v[144:147], v[120:123]
    ds_read_b128 v[176:179], v227 offset:11264
    v_mfma_f32_16x16x32_bf16 v[124:127], v[180:183], v[148:151], v[124:127]
    v_mfma_f32_16x16x32_bf16 v[128:131], v[184:187], v[144:147], v[128:131]
    ds_read_b128 v[180:183], v227 offset:12288
    v_mfma_f32_16x16x32_bf16 v[132:135], v[184:187], v[148:151], v[132:135]
    buffer_load_dwordx4 v[44:47], v232, s[32:35], s45 offen offset:1024 sc1
    s_waitcnt lgkmcnt(2)
    v_mfma_f32_16x16x32_bf16 v[80:83], v[160:163], v[152:155], v[80:83]
    ds_read_b128 v[184:187], v227 offset:13312
    v_mfma_f32_16x16x32_bf16 v[84:87], v[160:163], v[156:159], v[84:87]
    v_mfma_f32_16x16x32_bf16 v[88:91], v[164:167], v[152:155], v[88:91]
    ds_read_b128 v[160:163], v227 offset:14336
    v_mfma_f32_16x16x32_bf16 v[92:95], v[164:167], v[156:159], v[92:95]
    s_add_u32 s45, s49, 7424
    buffer_load_dwordx4 v[48:51], v232, s[32:35], s45 offen offset:0 sc1
    ds_read_b64_tr_b16 v[144:145], v240 offset:0
    v_mfma_f32_16x16x32_bf16 v[96:99], v[168:171], v[152:155], v[96:99]
    ds_read_b128 v[164:167], v227 offset:15360
    v_mfma_f32_16x16x32_bf16 v[100:103], v[168:171], v[156:159], v[100:103]
    ds_read_b64_tr_b16 v[146:147], v240 offset:1024
    v_mfma_f32_16x16x32_bf16 v[104:107], v[172:175], v[152:155], v[104:107]
    ds_read_b128 v[168:171], v227 offset:16384
    v_mfma_f32_16x16x32_bf16 v[108:111], v[172:175], v[156:159], v[108:111]
    buffer_load_dwordx4 v[52:55], v232, s[32:35], s45 offen offset:1024 sc1
    ds_read_b64_tr_b16 v[148:149], v241 offset:0
    s_waitcnt lgkmcnt(6)
    v_mfma_f32_16x16x32_bf16 v[112:115], v[176:179], v[152:155], v[112:115]
    ds_read_b128 v[172:175], v227 offset:17408
    v_mfma_f32_16x16x32_bf16 v[116:119], v[176:179], v[156:159], v[116:119]
    ds_read_b64_tr_b16 v[150:151], v241 offset:1024
    v_mfma_f32_16x16x32_bf16 v[120:123], v[180:183], v[152:155], v[120:123]
    ds_read_b128 v[176:179], v227 offset:18432
    v_mfma_f32_16x16x32_bf16 v[124:127], v[180:183], v[156:159], v[124:127]
    s_add_u32 s45, s49, 11136
    buffer_load_dwordx4 v[56:59], v232, s[32:35], s45 offen offset:0 sc1
    v_mfma_f32_16x16x32_bf16 v[128:131], v[184:187], v[152:155], v[128:131]
    ds_read_b128 v[180:183], v227 offset:19456
    v_mfma_f32_16x16x32_bf16 v[132:135], v[184:187], v[156:159], v[132:135]
    s_waitcnt lgkmcnt(2)
    v_mfma_f32_16x16x32_bf16 v[80:83], v[160:163], v[144:147], v[80:83]
    ds_read_b128 v[184:187], v227 offset:20480
    s_waitcnt vmcnt(8)
    v_mfma_f32_16x16x32_bf16 v[84:87], v[160:163], v[148:151], v[84:87]
    buffer_load_dwordx4 v[60:63], v232, s[32:35], s45 offen offset:1024 sc1
    v_mfma_f32_16x16x32_bf16 v[88:91], v[164:167], v[144:147], v[88:91]
    ds_read_b128 v[160:163], v227 offset:21504
    v_sad_u32 v8, v19, s46, 0
    v_mfma_f32_16x16x32_bf16 v[92:95], v[164:167], v[148:151], v[92:95]
    ds_read_b64_tr_b16 v[152:153], v240 offset:8192
    v_mfma_f32_16x16x32_bf16 v[96:99], v[168:171], v[144:147], v[96:99]
    ds_read_b128 v[164:167], v227 offset:22528
    v_add_f32 v16, v16, v20
    v_mfma_f32_16x16x32_bf16 v[100:103], v[168:171], v[148:151], v[100:103]
    s_add_u32 s45, s49, 0
    buffer_load_dwordx4 v[64:67], v232, s[32:35], s45 offen offset:2048 sc1
    ds_read_b64_tr_b16 v[154:155], v240 offset:9216
    v_mfma_f32_16x16x32_bf16 v[104:107], v[172:175], v[144:147], v[104:107]
    ds_read_b128 v[168:171], v227 offset:23552
    v_sad_u32 v8, v23, s46, v8
    v_mfma_f32_16x16x32_bf16 v[108:111], v[172:175], v[148:151], v[108:111]
    ds_read_b64_tr_b16 v[156:157], v241 offset:8192
    s_waitcnt lgkmcnt(6)
    v_mfma_f32_16x16x32_bf16 v[112:115], v[176:179], v[144:147], v[112:115]
    ds_read_b128 v[172:175], v227 offset:24576
    v_add_f32 v18, v18, v22
    v_mfma_f32_16x16x32_bf16 v[116:119], v[176:179], v[148:151], v[116:119]
    s_add_u32 s45, s49, 3712
    buffer_load_dwordx4 v[68:71], v232, s[32:35], s45 offen offset:2048 sc1
    ds_read_b64_tr_b16 v[158:159], v241 offset:9216
    v_mfma_f32_16x16x32_bf16 v[120:123], v[180:183], v[144:147], v[120:123]
    ds_read_b128 v[176:179], v227 offset:25600
    v_cmp_ne_u32 s[86:87], 0, v8
    s_nop 0
    s_cmp_eq_u64 s[86:87], 0
    s_cbranch_scc0 gslow_55
gok_56:
    v_mfma_f32_16x16x32_bf16 v[124:127], v[180:183], v[148:151], v[124:127]
    v_mov_b32 v17, v16
    v_mov_b32 v19, v18
    v_mfma_f32_16x16x32_bf16 v[128:131], v[184:187], v[144:147], v[128:131]
    ds_read_b128 v[180:183], v227 offset:26624
    v_mov_b32 v12, 0x3727c5ac
    v_mfma_f32_16x16x32_bf16 v[132:135], v[184:187], v[148:151], v[132:135]
    s_add_u32 s45, s49, 7424
    buffer_load_dwordx4 v[72:75], v232, s[32:35], s45 offen offset:2048 sc1
    s_waitcnt lgkmcnt(2)
    v_mfma_f32_16x16x32_bf16 v[80:83], v[160:163], v[152:155], v[80:83]
    ds_read_b128 v[184:187], v227 offset:27648
    v_permlane32_swap_b32 v16, v17
    v_mfma_f32_16x16x32_bf16 v[84:87], v[160:163], v[156:159], v[84:87]
    v_permlane32_swap_b32 v18, v19
    v_add_f32 v16, v16, v17
    v_mfma_f32_16x16x32_bf16 v[88:91], v[164:167], v[152:155], v[88:91]
    v_add_f32 v18, v18, v19
    v_mul_f32 v16, 0xbb000000, v16
    v_mfma_f32_16x16x32_bf16 v[92:95], v[164:167], v[156:159], v[92:95]
    s_add_u32 s45, s49, 11136
    buffer_load_dwordx4 v[76:79], v232, s[32:35], s45 offen offset:2048 sc1
    v_mfma_f32_16x16x32_bf16 v[96:99], v[168:171], v[152:155], v[96:99]
    v_fmac_f32 v12, 0x3b000000, v18
    v_cvt_pk_bf16_f32 v11, v16, 0
    v_mfma_f32_16x16x32_bf16 v[100:103], v[168:171], v[156:159], v[100:103]
    v_fma_f32 v12, -v16, v16, v12
    v_lshlrev_b32 v17, 16, v11
    v_mfma_f32_16x16x32_bf16 v[104:107], v[172:175], v[152:155], v[104:107]
    v_max_f32 v12, 0x3727c5ac, v12
    v_sub_f32 v17, v16, v17
    v_mfma_f32_16x16x32_bf16 v[108:111], v[172:175], v[156:159], v[108:111]
    s_add_u32 s45, s49, 0
    buffer_load_dwordx2 v[204:205], v15, s[32:35], s45 offen offset:3072 sc1
    s_waitcnt lgkmcnt(0)
    v_mfma_f32_16x16x32_bf16 v[112:115], v[176:179], v[152:155], v[112:115]
    v_rcp_f32 v12, v12
    v_cvt_pk_bf16_f32 v10, v16, v17
    v_mfma_f32_16x16x32_bf16 v[116:119], v[176:179], v[156:159], v[116:119]
    v_mfma_f32_16x16x32_bf16 v[120:123], v[180:183], v[152:155], v[120:123]
    v_mfma_f32_16x16x32_bf16 v[124:127], v[180:183], v[156:159], v[124:127]
    s_add_u32 s45, s49, 3712
    buffer_load_dwordx2 v[206:207], v15, s[32:35], s45 offen offset:3072 sc1
    v_mfma_f32_16x16x32_bf16 v[128:131], v[184:187], v[152:155], v[128:131]
    v_mfma_f32_16x16x32_bf16 v[132:135], v[184:187], v[156:159], v[132:135]
    s_add_u32 s45, s49, 7424
    buffer_load_dwordx2 v[208:209], v15, s[32:35], s45 offen offset:3072 sc1
    s_add_u32 s45, s49, 11136
    buffer_load_dwordx2 v[210:211], v15, s[32:35], s45 offen offset:3072 sc1
    s_add_u32 s45, s95, 14848
    buffer_load_dwordx4 v[212:215], v232, s[32:35], s45 offen offset:0 sc1
    v_mfma_f32_16x16x4_4b_bf16 v[80:95], v[248:249], v[10:11], v[80:95]
    v_mfma_f32_16x16x4_4b_bf16 v[96:111], v[250:251], v[10:11], v[96:111]
    v_mfma_f32_16x16x4_4b_bf16 v[112:127], v[252:253], v[10:11], v[112:127]
    v_mfma_f32_16x16x4_4b_bf16 v[128:143], v[254:255], v[10:11], v[128:143]
    buffer_load_dwordx4 v[188:191], v232, s[32:35], s45 offen offset:1024 sc1
    s_mul_i32 s71, s81, 3712
    s_add_u32 s71, s71, 33161216
    v_lshrrev_b32 v9, 1, v232
    v_lshrrev_b32 v13, 2, v232
    s_mov_b32 exec_hi, 0
    buffer_store_dword v12, v13, s[32:35], s71 offen offset:3584 sc1
    s_mov_b32 exec_hi, -1
    s_nop 0
    v_max_f32 v80, 0, v80
    v_max_f32 v81, 0, v81
    v_max_f32 v82, 0, v82
    v_max_f32 v83, 0, v83
    v_pk_mul_f32 v[80:81], v[80:81], v[88:89]
    v_pk_mul_f32 v[82:83], v[82:83], v[90:91]
    v_max_f32 v96, 0, v96
    s_add_u32 s45, s95, 18560
    buffer_load_dwordx4 v[192:195], v232, s[32:35], s45 offen offset:0 sc1
    v_max_f32 v97, 0, v97
    v_max_f32 v98, 0, v98
    v_max_f32 v99, 0, v99
    v_pk_mul_f32 v[96:97], v[96:97], v[104:105]
    v_pk_mul_f32 v[98:99], v[98:99], v[106:107]
    v_cvt_pk_bf16_f32 v88, v80, v81
    v_cvt_pk_bf16_f32 v89, v82, v83
    v_cvt_pk_bf16_f32 v90, v96, v97
    v_cvt_pk_bf16_f32 v91, v98, v99
    buffer_store_dwordx4 v[88:91], v232, s[32:35], s71 offen offset:0 sc1
    v_max_f32 v84, 0, v84
    v_max_f32 v85, 0, v85
    buffer_load_dwordx4 v[196:199], v232, s[32:35], s45 offen offset:1024 sc1
    v_max_f32 v86, 0, v86
    v_max_f32 v87, 0, v87
    v_pk_mul_f32 v[84:85], v[84:85], v[92:93]
    v_pk_mul_f32 v[86:87], v[86:87], v[94:95]
    v_max_f32 v100, 0, v100
    v_max_f32 v101, 0, v101
    v_max_f32 v102, 0, v102
    v_max_f32 v103, 0, v103
    v_pk_mul_f32 v[100:101], v[100:101], v[108:109]
    v_pk_mul_f32 v[102:103], v[102:103], v[110:111]
    v_cvt_pk_bf16_f32 v92, v84, v85
    v_cvt_pk_bf16_f32 v93, v86, v87
    s_add_u32 s45, s95, 22272
    buffer_load_dwordx4 v[200:203], v232, s[32:35], s45 offen offset:0 sc1
    v_cvt_pk_bf16_f32 v94, v100, v101
    v_cvt_pk_bf16_f32 v95, v102, v103
    buffer_store_dwordx4 v[92:95], v232, s[32:35], s71 offen offset:1024 sc1
    s_waitcnt vmcnt(24)
    ds_read_b64_tr_b16 v[80:81], v243 offset:0
    ds_read_b64_tr_b16 v[82:83], v243 offset:512
    ds_read_b64_tr_b16 v[84:85], v243 offset:1024
    ds_read_b64_tr_b16 v[86:87], v243 offset:1536
    v_max_f32 v112, 0, v112
    v_max_f32 v113, 0, v113
    v_max_f32 v114, 0, v114
    v_max_f32 v115, 0, v115
    v_pk_mul_f32 v[112:113], v[112:113], v[120:121]
    v_pk_mul_f32 v[114:115], v[114:115], v[122:123]
    v_max_f32 v116, 0, v116
    v_max_f32 v117, 0, v117
    v_max_f32 v118, 0, v118
    buffer_load_dwordx4 v[16:19], v232, s[32:35], s45 offen offset:1024 sc1
    v_max_f32 v119, 0, v119
    v_pk_mul_f32 v[116:117], v[116:117], v[124:125]
    v_pk_mul_f32 v[118:119], v[118:119], v[126:127]
    v_cvt_pk_bf16_f32 v120, v112, v113
    v_cvt_pk_bf16_f32 v121, v114, v115
    v_cvt_pk_bf16_f32 v122, v116, v117
    v_cvt_pk_bf16_f32 v123, v118, v119
    buffer_store_dwordx4 v[120:123], v232, s[32:35], s71 offen offset:2048 sc1
    v_permlane32_swap_b32 v128, v130
    v_permlane32_swap_b32 v129, v131
    v_permlane32_swap_b32 v132, v134
    v_permlane32_swap_b32 v133, v135
    v_max_f32 v128, 0, v128
    v_max_f32 v129, 0, v129
    v_pk_mul_f32 v[128:129], v[128:129], v[130:131]
    v_max_f32 v132, 0, v132
    v_max_f32 v133, 0, v133
    v_pk_mul_f32 v[132:133], v[132:133], v[134:135]
    v_cvt_pk_bf16_f32 v130, v128, v129
    v_cvt_pk_bf16_f32 v131, v132, v133
    s_waitcnt lgkmcnt(0)
    s_barrier
    s_waitcnt vmcnt(25)
    v_mfma_f32_16x16x32_bf16 v[144:147], a[0:3], v[32:35], 0
    buffer_store_dwordx2 v[130:131], v9, s[32:35], s71 offen offset:3072 sc1
    v_mfma_f32_16x16x32_bf16 v[148:151], a[4:7], v[32:35], 0
    s_add_u32 s45, s95, 25984
    buffer_load_dwordx4 v[20:23], v232, s[32:35], s45 offen offset:0 sc1
    v_mfma_f32_16x16x32_bf16 v[152:155], a[8:11], v[32:35], 0
    v_mfma_f32_16x16x32_bf16 v[156:159], a[12:15], v[32:35], 0
    s_waitcnt vmcnt(26)
    v_mfma_f32_16x16x32_bf16 v[160:163], a[0:3], v[36:39], 0
    v_mfma_f32_16x16x32_bf16 v[164:167], a[4:7], v[36:39], 0
    v_mfma_f32_16x16x32_bf16 v[168:171], a[8:11], v[36:39], 0
    buffer_load_dwordx4 v[24:27], v232, s[32:35], s45 offen offset:1024 sc1
    v_mfma_f32_16x16x32_bf16 v[172:175], a[12:15], v[36:39], 0
    s_waitcnt vmcnt(26)
    v_mfma_f32_16x16x32_bf16 v[144:147], a[16:19], v[40:43], v[144:147]
    v_mfma_f32_16x16x32_bf16 v[148:151], a[20:23], v[40:43], v[148:151]
    v_mfma_f32_16x16x32_bf16 v[152:155], a[24:27], v[40:43], v[152:155]
    v_mfma_f32_16x16x32_bf16 v[156:159], a[28:31], v[40:43], v[156:159]
    s_add_u32 s45, s95, 14848
    buffer_load_dwordx4 v[28:31], v232, s[32:35], s45 offen offset:2048 sc1
    s_waitcnt vmcnt(26)
    v_mfma_f32_16x16x32_bf16 v[160:163], a[16:19], v[44:47], v[160:163]
    v_mfma_f32_16x16x32_bf16 v[164:167], a[20:23], v[44:47], v[164:167]
    v_mfma_f32_16x16x32_bf16 v[168:171], a[24:27], v[44:47], v[168:171]
    v_mfma_f32_16x16x32_bf16 v[172:175], a[28:31], v[44:47], v[172:175]
    s_waitcnt vmcnt(25)
    v_mfma_f32_16x16x32_bf16 v[144:147], a[32:35], v[48:51], v[144:147]
    s_add_u32 s45, s95, 18560
    buffer_load_dwordx4 v[176:179], v232, s[32:35], s45 offen offset:2048 sc1
    v_mfma_f32_16x16x32_bf16 v[148:151], a[36:39], v[48:51], v[148:151]
    v_mfma_f32_16x16x32_bf16 v[152:155], a[40:43], v[48:51], v[152:155]
    v_mfma_f32_16x16x32_bf16 v[156:159], a[44:47], v[48:51], v[156:159]
    s_waitcnt vmcnt(25)
    v_mfma_f32_16x16x32_bf16 v[160:163], a[32:35], v[52:55], v[160:163]
    v_mfma_f32_16x16x32_bf16 v[164:167], a[36:39], v[52:55], v[164:167]
    s_add_u32 s45, s95, 22272
    buffer_load_dwordx4 v[180:183], v232, s[32:35], s45 offen offset:2048 sc1
    v_mfma_f32_16x16x32_bf16 v[168:171], a[40:43], v[52:55], v[168:171]
    v_mfma_f32_16x16x32_bf16 v[172:175], a[44:47], v[52:55], v[172:175]
    s_waitcnt vmcnt(25)
    v_mfma_f32_16x16x32_bf16 v[144:147], a[48:51], v[56:59], v[144:147]
    v_mfma_f32_16x16x32_bf16 v[148:151], a[52:55], v[56:59], v[148:151]
    v_mfma_f32_16x16x32_bf16 v[152:155], a[56:59], v[56:59], v[152:155]
    s_add_u32 s45, s95, 25984
    buffer_load_dwordx4 v[184:187], v232, s[32:35], s45 offen offset:2048 sc1
    v_mfma_f32_16x16x32_bf16 v[156:159], a[60:63], v[56:59], v[156:159]
    s_waitcnt vmcnt(25)
    v_mfma_f32_16x16x32_bf16 v[160:163], a[48:51], v[60:63], v[160:163]
    v_mfma_f32_16x16x32_bf16 v[164:167], a[52:55], v[60:63], v[164:167]
    v_mfma_f32_16x16x32_bf16 v[168:171], a[56:59], v[60:63], v[168:171]
    v_mfma_f32_16x16x32_bf16 v[172:175], a[60:63], v[60:63], v[172:175]
    s_add_u32 s45, s95, 14848
    buffer_load_dwordx2 v[216:217], v15, s[32:35], s45 offen offset:3072 sc1
    s_waitcnt vmcnt(24)
    v_swap_b32 v66, v68
    v_swap_b32 v67, v69
    s_nop 1
    v_mfma_f32_16x16x32_bf16 v[144:147], a[64:67], v[64:67], v[144:147]
    v_mfma_f32_16x16x32_bf16 v[148:151], a[68:71], v[64:67], v[148:151]
    v_mfma_f32_16x16x32_bf16 v[152:155], a[72:75], v[64:67], v[152:155]
    v_mfma_f32_16x16x32_bf16 v[156:159], a[76:79], v[64:67], v[156:159]
    v_mfma_f32_16x16x32_bf16 v[160:163], a[64:67], v[68:71], v[160:163]
    s_add_u32 s45, s95, 18560
    buffer_load_dwordx2 v[218:219], v15, s[32:35], s45 offen offset:3072 sc1
    v_mfma_f32_16x16x32_bf16 v[164:167], a[68:71], v[68:71], v[164:167]
    v_mfma_f32_16x16x32_bf16 v[168:171], a[72:75], v[68:71], v[168:171]
    v_mfma_f32_16x16x32_bf16 v[172:175], a[76:79], v[68:71], v[172:175]
    s_waitcnt vmcnt(23)
    v_swap_b32 v74, v76
    v_swap_b32 v75, v77
    s_nop 1
    v_mfma_f32_16x16x32_bf16 v[144:147], a[80:83], v[72:75], v[144:147]
    v_mfma_f32_16x16x32_bf16 v[148:151], a[84:87], v[72:75], v[148:151]
    s_add_u32 s45, s95, 22272
    buffer_load_dwordx2 v[220:221], v15, s[32:35], s45 offen offset:3072 sc1
    v_mfma_f32_16x16x32_bf16 v[152:155], a[88:91], v[72:75], v[152:155]
    v_mfma_f32_16x16x32_bf16 v[156:159], a[92:95], v[72:75], v[156:159]
    v_mfma_f32_16x16x32_bf16 v[160:163], a[80:83], v[76:79], v[160:163]
    v_mfma_f32_16x16x32_bf16 v[164:167], a[84:87], v[76:79], v[164:167]
    v_mfma_f32_16x16x32_bf16 v[168:171], a[88:91], v[76:79], v[168:171]
    s_add_u32 s45, s95, 25984
    buffer_load_dwordx2 v[222:223], v15, s[32:35], s45 offen offset:3072 sc1
    v_mfma_f32_16x16x32_bf16 v[172:175], a[92:95], v[76:79], v[172:175]
    s_waitcnt vmcnt(21)
    v_swap_b32 v205, v206
    v_swap_b32 v209, v210
    v_swap_b32 v206, v208
    v_swap_b32 v207, v209
    s_nop 1
    v_mfma_f32_16x16x32_bf16 v[144:147], a[96:99], v[204:207], v[144:147]
    v_mfma_f32_16x16x32_bf16 v[148:151], a[100:103], v[204:207], v[148:151]
    v_mfma_f32_16x16x32_bf16 v[152:155], a[104:107], v[204:207], v[152:155]
    v_mfma_f32_16x16x32_bf16 v[156:159], a[108:111], v[204:207], v[156:159]
    buffer_load_dword v224, v14, s[32:35], s49 offen offset:3584 sc1
    v_mfma_f32_16x16x32_bf16 v[160:163], a[96:99], v[208:211], v[160:163]
    v_mfma_f32_16x16x32_bf16 v[164:167], a[100:103], v[208:211], v[164:167]
    v_mfma_f32_16x16x32_bf16 v[168:171], a[104:107], v[208:211], v[168:171]
    v_mfma_f32_16x16x32_bf16 v[172:175], a[108:111], v[208:211], v[172:175]
    s_waitcnt vmcnt(21)
    v_mfma_f32_16x16x32_bf16 v[144:147], a[112:115], v[212:215], v[144:147]
    v_mfma_f32_16x16x32_bf16 v[148:151], a[116:119], v[212:215], v[148:151]
    v_mfma_f32_16x16x32_bf16 v[152:155], a[120:123], v[212:215], v[152:155]
    s_waitcnt vmcnt(11)
    s_lshl_b32 s70, s81, 6
    s_add_u32 s70, s70, 65536
    v_mov_b32 v4, s46
    v_mov_b32 v5, s47
    v_mov_b32 v6, s70
    s_mov_b64 exec, 1
    buffer_store_dwordx2 v[4:5], v6, s[32:35], s62 offen sc1
    s_mov_b64 exec, -1
    v_mfma_f32_16x16x32_bf16 v[156:159], a[124:127], v[212:215], v[156:159]
    s_add_u32 s73, s62, 65536
    s_lshl_b32 s68, s54, 5
    v_mfma_f32_16x16x32_bf16 v[160:163], a[112:115], v[188:191], v[160:163]
    s_mov_b32 s36, s26
    s_mov_b32 s37, s27
    v_mfma_f32_16x16x32_bf16 v[164:167], a[116:119], v[188:191], v[164:167]
    s_mov_b32 s38, 2097152
    s_mov_b32 s39, 0x20000
    v_mfma_f32_16x16x32_bf16 v[168:171], a[120:123], v[188:191], v[168:171]
    s_lshl_b32 s56, s54, 15
    s_lshr_b32 s57, s44, 1
    v_mfma_f32_16x16x32_bf16 v[172:175], a[124:127], v[188:191], v[172:175]
    s_lshl_b32 s57, s57, 14
    s_add_u32 s56, s56, s57
    v_mfma_f32_16x16x32_bf16 v[144:147], a[128:131], v[192:195], v[144:147]
    s_lshl_b32 s57, s55, 7
    s_add_u32 s56, s56, s57
    v_mfma_f32_16x16x32_bf16 v[148:151], a[132:135], v[192:195], v[148:151]
    s_and_b32 s57, s44, 1
    s_lshl_b32 s57, s57, 6
    v_mfma_f32_16x16x32_bf16 v[152:155], a[136:139], v[192:195], v[152:155]
    s_add_u32 s56, s56, s57
    s_add_u32 s57, s56, 1048576
    v_mfma_f32_16x16x32_bf16 v[156:159], a[140:143], v[192:195], v[156:159]
    v_and_b32 v244, 1, v3
    v_lshrrev_b32 v245, 1, v3
    v_mfma_f32_16x16x32_bf16 v[160:163], a[128:131], v[196:199], v[160:163]
    v_lshlrev_b32 v246, 10, v2
    v_lshl_add_u32 v246, v244, 5, v246
    v_mfma_f32_16x16x32_bf16 v[164:167], a[132:135], v[196:199], v[164:167]
    v_lshl_add_u32 v246, v245, 4, v246
    s_lshl_b32 s69, s44, 3
    v_mfma_f32_16x16x32_bf16 v[168:171], a[136:139], v[196:199], v[168:171]
    s_add_u32 s68, s68, s69
    v_and_b32 v8, 7, v1
    v_mfma_f32_16x16x32_bf16 v[172:175], a[140:143], v[196:199], v[172:175]
    v_add_lshl_u32 v8, v8, s68, 6
    v_mfma_f32_16x16x32_bf16 v[144:147], a[144:147], v[200:203], v[144:147]
    v_mfma_f32_16x16x32_bf16 v[148:151], a[148:151], v[200:203], v[148:151]
    v_mfma_f32_16x16x32_bf16 v[152:155], a[152:155], v[200:203], v[152:155]
    v_mfma_f32_16x16x32_bf16 v[156:159], a[156:159], v[200:203], v[156:159]
    v_mfma_f32_16x16x32_bf16 v[160:163], a[144:147], v[16:19], v[160:163]
    v_mfma_f32_16x16x32_bf16 v[164:167], a[148:151], v[16:19], v[164:167]
    v_mfma_f32_16x16x32_bf16 v[168:171], a[152:155], v[16:19], v[168:171]
    v_mfma_f32_16x16x32_bf16 v[172:175], a[156:159], v[16:19], v[172:175]
    s_waitcnt vmcnt(11)
    v_mfma_f32_16x16x32_bf16 v[144:147], a[160:163], v[20:23], v[144:147]
    v_mfma_f32_16x16x32_bf16 v[148:151], a[164:167], v[20:23], v[148:151]
    v_mfma_f32_16x16x32_bf16 v[152:155], a[168:171], v[20:23], v[152:155]
    v_mfma_f32_16x16x32_bf16 v[156:159], a[172:175], v[20:23], v[156:159]
    s_waitcnt vmcnt(10)
    v_mfma_f32_16x16x32_bf16 v[160:163], a[160:163], v[24:27], v[160:163]
    v_mfma_f32_16x16x32_bf16 v[164:167], a[164:167], v[24:27], v[164:167]
    v_mfma_f32_16x16x32_bf16 v[168:171], a[168:171], v[24:27], v[168:171]
    v_mfma_f32_16x16x32_bf16 v[172:175], a[172:175], v[24:27], v[172:175]
    s_waitcnt vmcnt(8)
    v_swap_b32 v30, v176
    v_swap_b32 v31, v177
    s_nop 1
    v_mfma_f32_16x16x32_bf16 v[144:147], a[176:179], v[28:31], v[144:147]
    v_mfma_f32_16x16x32_bf16 v[148:151], a[180:183], v[28:31], v[148:151]
    v_mfma_f32_16x16x32_bf16 v[152:155], a[184:187], v[28:31], v[152:155]
    v_mfma_f32_16x16x32_bf16 v[156:159], a[188:191], v[28:31], v[156:159]
    v_mfma_f32_16x16x32_bf16 v[160:163], a[176:179], v[176:179], v[160:163]
    v_mfma_f32_16x16x32_bf16 v[164:167], a[180:183], v[176:179], v[164:167]
    v_mfma_f32_16x16x32_bf16 v[168:171], a[184:187], v[176:179], v[168:171]
    v_mfma_f32_16x16x32_bf16 v[172:175], a[188:191], v[176:179], v[172:175]
    s_waitcnt vmcnt(6)
    v_swap_b32 v182, v184
    v_swap_b32 v183, v185
    s_nop 1
    v_mfma_f32_16x16x32_bf16 v[144:147], a[192:195], v[180:183], v[144:147]
    v_mfma_f32_16x16x32_bf16 v[148:151], a[196:199], v[180:183], v[148:151]
    v_mfma_f32_16x16x32_bf16 v[152:155], a[200:203], v[180:183], v[152:155]
    v_mfma_f32_16x16x32_bf16 v[156:159], a[204:207], v[180:183], v[156:159]
    v_mfma_f32_16x16x32_bf16 v[160:163], a[192:195], v[184:187], v[160:163]
    v_mfma_f32_16x16x32_bf16 v[164:167], a[196:199], v[184:187], v[164:167]
    v_mfma_f32_16x16x32_bf16 v[168:171], a[200:203], v[184:187], v[168:171]
    v_mfma_f32_16x16x32_bf16 v[172:175], a[204:207], v[184:187], v[172:175]
    s_waitcnt vmcnt(2)
    v_swap_b32 v217, v218
    v_swap_b32 v221, v222
    v_swap_b32 v218, v220
    v_swap_b32 v219, v221
    s_nop 1
    v_mfma_f32_16x16x32_bf16 v[144:147], a[208:211], v[216:219], v[144:147]
    v_mfma_f32_16x16x32_bf16 v[148:151], a[212:215], v[216:219], v[148:151]
    v_mfma_f32_16x16x32_bf16 v[152:155], a[216:219], v[216:219], v[152:155]
    v_mfma_f32_16x16x32_bf16 v[156:159], a[220:223], v[216:219], v[156:159]
    v_mfma_f32_16x16x32_bf16 v[160:163], a[208:211], v[220:223], v[160:163]
    buffer_load_dwordx2 v[10:11], v8, s[32:35], s73 offen sc1
    v_mfma_f32_16x16x32_bf16 v[164:167], a[212:215], v[220:223], v[164:167]
    v_mfma_f32_16x16x32_bf16 v[168:171], a[216:219], v[220:223], v[168:171]
    v_mfma_f32_16x16x32_bf16 v[172:175], a[220:223], v[220:223], v[172:175]
    v_add_u32 v13, 134912, v232
    s_mul_i32 s68, s44, 6144
    v_lshlrev_b32 v128, 16, v80
    v_and_b32 v129, 0xffff0000, v80
    v_lshlrev_b32 v130, 16, v81
    v_and_b32 v131, 0xffff0000, v81
    v_lshlrev_b32 v132, 16, v82
    v_and_b32 v133, 0xffff0000, v82
    v_lshlrev_b32 v134, 16, v83
    v_and_b32 v135, 0xffff0000, v83
    s_cmp_lg_u32 s44, 0
    s_cbranch_scc1 red_59
    ds_write_b128 v13, v[152:155] offset:10240
    v_mov_b32 v120, v144
    ds_write_b128 v13, v[156:159] offset:11264
    v_mov_b32 v121, v145
    ds_write_b128 v13, v[160:163] offset:14336
    v_mov_b32 v122, v146
    ds_write_b128 v13, v[164:167] offset:15360
    v_mov_b32 v123, v147
    ds_write_b128 v13, v[168:171] offset:18432
    v_mov_b32 v124, v148
    ds_write_b128 v13, v[172:175] offset:19456
    v_mov_b32 v125, v149
    v_mov_b32 v126, v150
    v_mov_b32 v127, v151
    s_branch reddone_57
red_59:
    s_cmp_lg_u32 s44, 1
    s_cbranch_scc1 red_60
    ds_write_b128 v13, v[144:147] offset:0
    v_mov_b32 v120, v152
    ds_write_b128 v13, v[148:151] offset:1024
    v_mov_b32 v121, v153
    ds_write_b128 v13, v[160:163] offset:16384
    v_mov_b32 v122, v154
    ds_write_b128 v13, v[164:167] offset:17408
    v_mov_b32 v123, v155
    ds_write_b128 v13, v[168:171] offset:20480
    v_mov_b32 v124, v156
    ds_write_b128 v13, v[172:175] offset:21504
    v_mov_b32 v125, v157
    v_mov_b32 v126, v158
    v_mov_b32 v127, v159
    s_branch reddone_57
red_60:
    s_cmp_lg_u32 s44, 2
    s_cbranch_scc1 red_61
    ds_write_b128 v13, v[144:147] offset:2048
    v_mov_b32 v120, v160
    ds_write_b128 v13, v[148:151] offset:3072
    v_mov_b32 v121, v161
    ds_write_b128 v13, v[152:155] offset:6144
    v_mov_b32 v122, v162
    ds_write_b128 v13, v[156:159] offset:7168
    v_mov_b32 v123, v163
    ds_write_b128 v13, v[168:171] offset:22528
    v_mov_b32 v124, v164
    ds_write_b128 v13, v[172:175] offset:23552
    v_mov_b32 v125, v165
    v_mov_b32 v126, v166
    v_mov_b32 v127, v167
    s_branch reddone_57
red_61:
    ds_write_b128 v13, v[144:147] offset:4096
    v_mov_b32 v120, v168
    ds_write_b128 v13, v[148:151] offset:5120
    v_mov_b32 v121, v169
    ds_write_b128 v13, v[152:155] offset:8192
    v_mov_b32 v122, v170
    ds_write_b128 v13, v[156:159] offset:9216
    v_mov_b32 v123, v171
    ds_write_b128 v13, v[160:163] offset:12288
    v_mov_b32 v124, v172
    ds_write_b128 v13, v[164:167] offset:13312
    v_mov_b32 v125, v173
    v_mov_b32 v126, v174
    v_mov_b32 v127, v175
reddone_57:
    v_add_u32 v13, s68, v13
    s_waitcnt vmcnt(2)
    v_mov_b32 v225, v224
    s_waitcnt lgkmcnt(0)
    s_barrier
    ds_read_b128 v[144:147], v13 offset:0
    ds_read_b128 v[148:151], v13 offset:2048
    ds_read_b128 v[152:155], v13 offset:4096
    ds_read_b128 v[156:159], v13 offset:1024
    ds_read_b128 v[160:163], v13 offset:3072
    ds_read_b128 v[164:167], v13 offset:5120
    s_waitcnt vmcnt(0)
    v_cmp_ne_u64 s[86:87], s[46:47], v[10:11]
    s_nop 0
    s_cmp_eq_u64 s[86:87], 0
    s_cbranch_scc0 slow_62
ok_63:
    s_add_u32 s49, s49, 3801088
    s_add_u32 s95, s95, 3801088
    s_add_u32 s45, s49, 0
    buffer_load_dwordx4 v[32:35], v232, s[32:35], s45 offen offset:0 sc1
    buffer_load_dwordx4 v[36:39], v232, s[32:35], s45 offen offset:1024 sc1
    s_add_u32 s45, s49, 3712
    buffer_load_dwordx4 v[40:43], v232, s[32:35], s45 offen offset:0 sc1
    buffer_load_dwordx4 v[44:47], v232, s[32:35], s45 offen offset:1024 sc1
    s_add_u32 s45, s49, 7424
    buffer_load_dwordx4 v[48:51], v232, s[32:35], s45 offen offset:0 sc1
    buffer_load_dwordx4 v[52:55], v232, s[32:35], s45 offen offset:1024 sc1
    s_add_u32 s45, s49, 11136
    buffer_load_dwordx4 v[56:59], v232, s[32:35], s45 offen offset:0 sc1
    s_waitcnt lgkmcnt(5)
    v_pk_add_f32 v[120:121], v[120:121], v[144:145]
    v_pk_add_f32 v[122:123], v[122:123], v[146:147]
    s_waitcnt lgkmcnt(4)
    v_pk_add_f32 v[120:121], v[120:121], v[148:149]
    v_pk_add_f32 v[122:123], v[122:123], v[150:151]
    buffer_load_dwordx4 v[60:63], v232, s[32:35], s45 offen offset:1024 sc1
    s_waitcnt lgkmcnt(3)
    v_pk_add_f32 v[120:121], v[120:121], v[152:153]
    v_pk_add_f32 v[122:123], v[122:123], v[154:155]
    v_pk_fma_f32 v[120:121], v[120:121], v[224:225], v[128:129]
    v_pk_fma_f32 v[122:123], v[122:123], v[224:225], v[130:131]
    v_cvt_pk_bf16_f32 v136, v120, v121
    v_cvt_pk_bf16_f32 v137, v122, v123
    s_add_u32 s45, s49, 0
    buffer_load_dwordx4 v[64:67], v232, s[32:35], s45 offen offset:2048 sc1
    s_waitcnt lgkmcnt(2)
    v_pk_add_f32 v[124:125], v[124:125], v[156:157]
    v_pk_add_f32 v[126:127], v[126:127], v[158:159]
    s_waitcnt lgkmcnt(1)
    v_pk_add_f32 v[124:125], v[124:125], v[160:161]
    v_pk_add_f32 v[126:127], v[126:127], v[162:163]
    s_add_u32 s45, s49, 3712
    buffer_load_dwordx4 v[68:71], v232, s[32:35], s45 offen offset:2048 sc1
    s_waitcnt lgkmcnt(0)
    v_pk_add_f32 v[124:125], v[124:125], v[164:165]
    v_pk_add_f32 v[126:127], v[126:127], v[166:167]
    v_pk_fma_f32 v[124:125], v[124:125], v[224:225], v[132:133]
    v_pk_fma_f32 v[126:127], v[126:127], v[224:225], v[134:135]
    v_cvt_pk_bf16_f32 v138, v124, v125
    v_cvt_pk_bf16_f32 v139, v126, v127
    s_add_u32 s45, s49, 7424
    buffer_load_dwordx4 v[72:75], v232, s[32:35], s45 offen offset:2048 sc1
    s_add_u32 s45, s49, 11136
    buffer_load_dwordx4 v[76:79], v232, s[32:35], s45 offen offset:2048 sc1
    v_permlane16_swap_b32 v136, v138
    v_permlane16_swap_b32 v137, v139
    buffer_store_dwordx4 v[136:139], v246, s[36:39], s56 offen sc1
    s_add_u32 s45, s49, 0
    buffer_load_dwordx2 v[204:205], v15, s[32:35], s45 offen offset:3072 sc1
    s_add_u32 s45, s49, 3712
    buffer_load_dwordx2 v[206:207], v15, s[32:35], s45 offen offset:3072 sc1
    s_add_u32 s45, s49, 7424
    buffer_load_dwordx2 v[208:209], v15, s[32:35], s45 offen offset:3072 sc1
    s_add_u32 s45, s49, 11136
    buffer_load_dwordx2 v[210:211], v15, s[32:35], s45 offen offset:3072 sc1
    s_waitcnt vmcnt(16)
    v_mfma_f32_16x16x32_bf16 v[88:91], a[0:3], v[32:35], 0
    v_mfma_f32_16x16x32_bf16 v[92:95], a[4:7], v[32:35], 0
    s_add_u32 s45, s95, 14848
    buffer_load_dwordx4 v[212:215], v232, s[32:35], s45 offen offset:0 sc1
    v_mfma_f32_16x16x32_bf16 v[96:99], a[8:11], v[32:35], 0
    v_mfma_f32_16x16x32_bf16 v[100:103], a[12:15], v[32:35], 0
    s_waitcnt vmcnt(16)
    v_mfma_f32_16x16x32_bf16 v[104:107], a[0:3], v[36:39], 0
    v_mfma_f32_16x16x32_bf16 v[108:111], a[4:7], v[36:39], 0
    v_mfma_f32_16x16x32_bf16 v[112:115], a[8:11], v[36:39], 0
    buffer_load_dwordx4 v[188:191], v232, s[32:35], s45 offen offset:1024 sc1
    v_mfma_f32_16x16x32_bf16 v[116:119], a[12:15], v[36:39], 0
    s_waitcnt vmcnt(16)
    v_mfma_f32_16x16x32_bf16 v[88:91], a[16:19], v[40:43], v[88:91]
    v_mfma_f32_16x16x32_bf16 v[92:95], a[20:23], v[40:43], v[92:95]
    v_mfma_f32_16x16x32_bf16 v[96:99], a[24:27], v[40:43], v[96:99]
    v_mfma_f32_16x16x32_bf16 v[100:103], a[28:31], v[40:43], v[100:103]
    s_add_u32 s45, s95, 18560
    buffer_load_dwordx4 v[192:195], v232, s[32:35], s45 offen offset:0 sc1
    s_waitcnt vmcnt(16)
    v_mfma_f32_16x16x32_bf16 v[104:107], a[16:19], v[44:47], v[104:107]
    v_mfma_f32_16x16x32_bf16 v[108:111], a[20:23], v[44:47], v[108:111]
    v_mfma_f32_16x16x32_bf16 v[112:115], a[24:27], v[44:47], v[112:115]
    v_mfma_f32_16x16x32_bf16 v[116:119], a[28:31], v[44:47], v[116:119]
    s_waitcnt vmcnt(15)
    v_mfma_f32_16x16x32_bf16 v[88:91], a[32:35], v[48:51], v[88:91]
    buffer_load_dwordx4 v[196:199], v232, s[32:35], s45 offen offset:1024 sc1
    v_mfma_f32_16x16x32_bf16 v[92:95], a[36:39], v[48:51], v[92:95]
    v_mfma_f32_16x16x32_bf16 v[96:99], a[40:43], v[48:51], v[96:99]
    v_mfma_f32_16x16x32_bf16 v[100:103], a[44:47], v[48:51], v[100:103]
    s_waitcnt vmcnt(15)
    v_mfma_f32_16x16x32_bf16 v[104:107], a[32:35], v[52:55], v[104:107]
    v_mfma_f32_16x16x32_bf16 v[108:111], a[36:39], v[52:55], v[108:111]
    s_add_u32 s45, s95, 22272
    buffer_load_dwordx4 v[200:203], v232, s[32:35], s45 offen offset:0 sc1
    v_mfma_f32_16x16x32_bf16 v[112:115], a[40:43], v[52:55], v[112:115]
    v_mfma_f32_16x16x32_bf16 v[116:119], a[44:47], v[52:55], v[116:119]
    s_waitcnt vmcnt(15)
    v_mfma_f32_16x16x32_bf16 v[88:91], a[48:51], v[56:59], v[88:91]
    v_mfma_f32_16x16x32_bf16 v[92:95], a[52:55], v[56:59], v[92:95]
    v_mfma_f32_16x16x32_bf16 v[96:99], a[56:59], v[56:59], v[96:99]
    buffer_load_dwordx4 v[16:19], v232, s[32:35], s45 offen offset:1024 sc1
    v_mfma_f32_16x16x32_bf16 v[100:103], a[60:63], v[56:59], v[100:103]
    s_waitcnt vmcnt(15)
    v_mfma_f32_16x16x32_bf16 v[104:107], a[48:51], v[60:63], v[104:107]
    v_mfma_f32_16x16x32_bf16 v[108:111], a[52:55], v[60:63], v[108:111]
    v_mfma_f32_16x16x32_bf16 v[112:115], a[56:59], v[60:63], v[112:115]
    v_mfma_f32_16x16x32_bf16 v[116:119], a[60:63], v[60:63], v[116:119]
    s_add_u32 s45, s95, 25984
    buffer_load_dwordx4 v[20:23], v232, s[32:35], s45 offen offset:0 sc1
    s_waitcnt vmcnt(14)
    v_swap_b32 v66, v68
    v_swap_b32 v67, v69
    s_nop 1
    v_mfma_f32_16x16x32_bf16 v[88:91], a[64:67], v[64:67], v[88:91]
    v_mfma_f32_16x16x32_bf16 v[92:95], a[68:71], v[64:67], v[92:95]
    v_mfma_f32_16x16x32_bf16 v[96:99], a[72:75], v[64:67], v[96:99]
    v_mfma_f32_16x16x32_bf16 v[100:103], a[76:79], v[64:67], v[100:103]
    v_mfma_f32_16x16x32_bf16 v[104:107], a[64:67], v[68:71], v[104:107]
    buffer_load_dwordx4 v[24:27], v232, s[32:35], s45 offen offset:1024 sc1
    v_mfma_f32_16x16x32_bf16 v[108:111], a[68:71], v[68:71], v[108:111]
    v_mfma_f32_16x16x32_bf16 v[112:115], a[72:75], v[68:71], v[112:115]
    v_mfma_f32_16x16x32_bf16 v[116:119], a[76:79], v[68:71], v[116:119]
    s_waitcnt vmcnt(13)
    v_swap_b32 v74, v76
    v_swap_b32 v75, v77
    s_nop 1
    v_mfma_f32_16x16x32_bf16 v[88:91], a[80:83], v[72:75], v[88:91]
    v_mfma_f32_16x16x32_bf16 v[92:95], a[84:87], v[72:75], v[92:95]
    s_add_u32 s45, s95, 14848
    buffer_load_dwordx4 v[28:31], v232, s[32:35], s45 offen offset:2048 sc1
    v_mfma_f32_16x16x32_bf16 v[96:99], a[88:91], v[72:75], v[96:99]
    v_mfma_f32_16x16x32_bf16 v[100:103], a[92:95], v[72:75], v[100:103]
    v_mfma_f32_16x16x32_bf16 v[104:107], a[80:83], v[76:79], v[104:107]
    v_mfma_f32_16x16x32_bf16 v[108:111], a[84:87], v[76:79], v[108:111]
    v_mfma_f32_16x16x32_bf16 v[112:115], a[88:91], v[76:79], v[112:115]
    s_add_u32 s45, s95, 18560
    buffer_load_dwordx4 v[176:179], v232, s[32:35], s45 offen offset:2048 sc1
    v_mfma_f32_16x16x32_bf16 v[116:119], a[92:95], v[76:79], v[116:119]
    s_waitcnt vmcnt(10)
    v_swap_b32 v205, v206
    v_swap_b32 v209, v210
    v_swap_b32 v206, v208
    v_swap_b32 v207, v209
    s_nop 1
    v_mfma_f32_16x16x32_bf16 v[88:91], a[96:99], v[204:207], v[88:91]
    v_mfma_f32_16x16x32_bf16 v[92:95], a[100:103], v[204:207], v[92:95]
    v_mfma_f32_16x16x32_bf16 v[96:99], a[104:107], v[204:207], v[96:99]
    v_mfma_f32_16x16x32_bf16 v[100:103], a[108:111], v[204:207], v[100:103]
    s_add_u32 s45, s95, 22272
    buffer_load_dwordx4 v[180:183], v232, s[32:35], s45 offen offset:2048 sc1
    v_mfma_f32_16x16x32_bf16 v[104:107], a[96:99], v[208:211], v[104:107]
    s_barrier
    v_mfma_f32_16x16x32_bf16 v[108:111], a[100:103], v[208:211], v[108:111]
    v_mfma_f32_16x16x32_bf16 v[112:115], a[104:107], v[208:211], v[112:115]
    v_mfma_f32_16x16x32_bf16 v[116:119], a[108:111], v[208:211], v[116:119]
    s_waitcnt vmcnt(10)
    v_mfma_f32_16x16x32_bf16 v[88:91], a[112:115], v[212:215], v[88:91]
    s_add_u32 s45, s95, 25984
    buffer_load_dwordx4 v[184:187], v232, s[32:35], s45 offen offset:2048 sc1
    v_mfma_f32_16x16x32_bf16 v[92:95], a[116:119], v[212:215], v[92:95]
    v_mfma_f32_16x16x32_bf16 v[96:99], a[120:123], v[212:215], v[96:99]
    v_mfma_f32_16x16x32_bf16 v[100:103], a[124:127], v[212:215], v[100:103]
    s_waitcnt vmcnt(10)
    v_mfma_f32_16x16x32_bf16 v[104:107], a[112:115], v[188:191], v[104:107]
    v_mfma_f32_16x16x32_bf16 v[108:111], a[116:119], v[188:191], v[108:111]
    s_add_u32 s45, s95, 14848
    buffer_load_dwordx2 v[216:217], v15, s[32:35], s45 offen offset:3072 sc1
    v_mfma_f32_16x16x32_bf16 v[112:115], a[120:123], v[188:191], v[112:115]
    v_mfma_f32_16x16x32_bf16 v[116:119], a[124:127], v[188:191], v[116:119]
    s_waitcnt vmcnt(10)
    v_mfma_f32_16x16x32_bf16 v[88:91], a[128:131], v[192:195], v[88:91]
    v_mfma_f32_16x16x32_bf16 v[92:95], a[132:135], v[192:195], v[92:95]
    v_mfma_f32_16x16x32_bf16 v[96:99], a[136:139], v[192:195], v[96:99]
    s_add_u32 s45, s95, 18560
    buffer_load_dwordx2 v[218:219], v15, s[32:35], s45 offen offset:3072 sc1
    v_mfma_f32_16x16x32_bf16 v[100:103], a[140:143], v[192:195], v[100:103]
    s_waitcnt vmcnt(10)
    v_mfma_f32_16x16x32_bf16 v[104:107], a[128:131], v[196:199], v[104:107]
    v_mfma_f32_16x16x32_bf16 v[108:111], a[132:135], v[196:199], v[108:111]
    v_mfma_f32_16x16x32_bf16 v[112:115], a[136:139], v[196:199], v[112:115]
    v_mfma_f32_16x16x32_bf16 v[116:119], a[140:143], v[196:199], v[116:119]
    s_add_u32 s45, s95, 22272
    buffer_load_dwordx2 v[220:221], v15, s[32:35], s45 offen offset:3072 sc1
    s_waitcnt vmcnt(10)
    v_mfma_f32_16x16x32_bf16 v[88:91], a[144:147], v[200:203], v[88:91]
    v_mfma_f32_16x16x32_bf16 v[92:95], a[148:151], v[200:203], v[92:95]
    v_mfma_f32_16x16x32_bf16 v[96:99], a[152:155], v[200:203], v[96:99]
    v_mfma_f32_16x16x32_bf16 v[100:103], a[156:159], v[200:203], v[100:103]
    s_waitcnt vmcnt(9)
    v_mfma_f32_16x16x32_bf16 v[104:107], a[144:147], v[16:19], v[104:107]
    s_add_u32 s45, s95, 25984
    buffer_load_dwordx2 v[222:223], v15, s[32:35], s45 offen offset:3072 sc1
    v_mfma_f32_16x16x32_bf16 v[108:111], a[148:151], v[16:19], v[108:111]
    v_mfma_f32_16x16x32_bf16 v[112:115], a[152:155], v[16:19], v[112:115]
    v_mfma_f32_16x16x32_bf16 v[116:119], a[156:159], v[16:19], v[116:119]
    s_waitcnt vmcnt(9)
    v_mfma_f32_16x16x32_bf16 v[88:91], a[160:163], v[20:23], v[88:91]
    v_mfma_f32_16x16x32_bf16 v[92:95], a[164:167], v[20:23], v[92:95]
    buffer_load_dword v226, v14, s[32:35], s49 offen offset:3584 sc1
    v_mfma_f32_16x16x32_bf16 v[96:99], a[168:171], v[20:23], v[96:99]
    v_mfma_f32_16x16x32_bf16 v[100:103], a[172:175], v[20:23], v[100:103]
    s_waitcnt vmcnt(9)
    v_mfma_f32_16x16x32_bf16 v[104:107], a[160:163], v[24:27], v[104:107]
    v_mfma_f32_16x16x32_bf16 v[108:111], a[164:167], v[24:27], v[108:111]
    v_mfma_f32_16x16x32_bf16 v[112:115], a[168:171], v[24:27], v[112:115]
    v_mfma_f32_16x16x32_bf16 v[116:119], a[172:175], v[24:27], v[116:119]
    s_waitcnt vmcnt(7)
    v_swap_b32 v30, v176
    v_swap_b32 v31, v177
    s_nop 1
    v_mfma_f32_16x16x32_bf16 v[88:91], a[176:179], v[28:31], v[88:91]
    v_mfma_f32_16x16x32_bf16 v[92:95], a[180:183], v[28:31], v[92:95]
    v_mfma_f32_16x16x32_bf16 v[96:99], a[184:187], v[28:31], v[96:99]
    v_mfma_f32_16x16x32_bf16 v[100:103], a[188:191], v[28:31], v[100:103]
    v_mfma_f32_16x16x32_bf16 v[104:107], a[176:179], v[176:179], v[104:107]
    v_mfma_f32_16x16x32_bf16 v[108:111], a[180:183], v[176:179], v[108:111]
    v_mfma_f32_16x16x32_bf16 v[112:115], a[184:187], v[176:179], v[112:115]
    v_mfma_f32_16x16x32_bf16 v[116:119], a[188:191], v[176:179], v[116:119]
    s_waitcnt vmcnt(5)
    v_swap_b32 v182, v184
    v_swap_b32 v183, v185
    s_nop 1
    v_mfma_f32_16x16x32_bf16 v[88:91], a[192:195], v[180:183], v[88:91]
    v_mfma_f32_16x16x32_bf16 v[92:95], a[196:199], v[180:183], v[92:95]
    v_mfma_f32_16x16x32_bf16 v[96:99], a[200:203], v[180:183], v[96:99]
    v_mfma_f32_16x16x32_bf16 v[100:103], a[204:207], v[180:183], v[100:103]
    v_mfma_f32_16x16x32_bf16 v[104:107], a[192:195], v[184:187], v[104:107]
    v_mfma_f32_16x16x32_bf16 v[108:111], a[196:199], v[184:187], v[108:111]
    v_mfma_f32_16x16x32_bf16 v[112:115], a[200:203], v[184:187], v[112:115]
    v_mfma_f32_16x16x32_bf16 v[116:119], a[204:207], v[184:187], v[116:119]
    s_waitcnt vmcnt(1)
    v_swap_b32 v217, v218
    v_swap_b32 v221, v222
    v_swap_b32 v218, v220
    v_swap_b32 v219, v221
    s_nop 1
    v_mfma_f32_16x16x32_bf16 v[88:91], a[208:211], v[216:219], v[88:91]
    v_mfma_f32_16x16x32_bf16 v[92:95], a[212:215], v[216:219], v[92:95]
    v_mfma_f32_16x16x32_bf16 v[96:99], a[216:219], v[216:219], v[96:99]
    v_mfma_f32_16x16x32_bf16 v[100:103], a[220:223], v[216:219], v[100:103]
    v_mfma_f32_16x16x32_bf16 v[104:107], a[208:211], v[220:223], v[104:107]
    v_mfma_f32_16x16x32_bf16 v[108:111], a[212:215], v[220:223], v[108:111]
    v_mfma_f32_16x16x32_bf16 v[112:115], a[216:219], v[220:223], v[112:115]
    v_mfma_f32_16x16x32_bf16 v[116:119], a[220:223], v[220:223], v[116:119]
    v_add_u32 v13, 134912, v232
    s_mul_i32 s68, s44, 6144
    v_lshlrev_b32 v128, 16, v84
    v_and_b32 v129, 0xffff0000, v84
    v_lshlrev_b32 v130, 16, v85
    v_and_b32 v131, 0xffff0000, v85
    v_lshlrev_b32 v132, 16, v86
    v_and_b32 v133, 0xffff0000, v86
    v_lshlrev_b32 v134, 16, v87
    v_and_b32 v135, 0xffff0000, v87
    s_cmp_lg_u32 s44, 0
    s_cbranch_scc1 red_66
    ds_write_b128 v13, v[96:99] offset:10240
    v_mov_b32 v120, v88
    ds_write_b128 v13, v[100:103] offset:11264
    v_mov_b32 v121, v89
    ds_write_b128 v13, v[104:107] offset:14336
    v_mov_b32 v122, v90
    ds_write_b128 v13, v[108:111] offset:15360
    v_mov_b32 v123, v91
    ds_write_b128 v13, v[112:115] offset:18432
    v_mov_b32 v124, v92
    ds_write_b128 v13, v[116:119] offset:19456
    v_mov_b32 v125, v93
    v_mov_b32 v126, v94
    v_mov_b32 v127, v95
    s_branch reddone_64
red_66:
    s_cmp_lg_u32 s44, 1
    s_cbranch_scc1 red_67
    ds_write_b128 v13, v[88:91] offset:0
    v_mov_b32 v120, v96
    ds_write_b128 v13, v[92:95] offset:1024
    v_mov_b32 v121, v97
    ds_write_b128 v13, v[104:107] offset:16384
    v_mov_b32 v122, v98
    ds_write_b128 v13, v[108:111] offset:17408
    v_mov_b32 v123, v99
    ds_write_b128 v13, v[112:115] offset:20480
    v_mov_b32 v124, v100
    ds_write_b128 v13, v[116:119] offset:21504
    v_mov_b32 v125, v101
    v_mov_b32 v126, v102
    v_mov_b32 v127, v103
    s_branch reddone_64
red_67:
    s_cmp_lg_u32 s44, 2
    s_cbranch_scc1 red_68
    ds_write_b128 v13, v[88:91] offset:2048
    v_mov_b32 v120, v104
    ds_write_b128 v13, v[92:95] offset:3072
    v_mov_b32 v121, v105
    ds_write_b128 v13, v[96:99] offset:6144
    v_mov_b32 v122, v106
    ds_write_b128 v13, v[100:103] offset:7168
    v_mov_b32 v123, v107
    ds_write_b128 v13, v[112:115] offset:22528
    v_mov_b32 v124, v108
    ds_write_b128 v13, v[116:119] offset:23552
    v_mov_b32 v125, v109
    v_mov_b32 v126, v110
    v_mov_b32 v127, v111
    s_branch reddone_64
red_68:
    ds_write_b128 v13, v[88:91] offset:4096
    v_mov_b32 v120, v112
    ds_write_b128 v13, v[92:95] offset:5120
    v_mov_b32 v121, v113
    ds_write_b128 v13, v[96:99] offset:8192
    v_mov_b32 v122, v114
    ds_write_b128 v13, v[100:103] offset:9216
    v_mov_b32 v123, v115
    ds_write_b128 v13, v[104:107] offset:12288
    v_mov_b32 v124, v116
    ds_write_b128 v13, v[108:111] offset:13312
    v_mov_b32 v125, v117
    v_mov_b32 v126, v118
    v_mov_b32 v127, v119
reddone_64:
    v_add_u32 v13, s68, v13
    s_waitcnt vmcnt(0)
    v_mov_b32 v227, v226
    s_waitcnt lgkmcnt(0)
    s_barrier
    ds_read_b128 v[144:147], v13 offset:0
    ds_read_b128 v[148:151], v13 offset:2048
    ds_read_b128 v[152:155], v13 offset:4096
    ds_read_b128 v[156:159], v13 offset:1024
    ds_read_b128 v[160:163], v13 offset:3072
    ds_read_b128 v[164:167], v13 offset:5120
    s_waitcnt lgkmcnt(5)
    v_pk_add_f32 v[120:121], v[120:121], v[144:145]
    v_pk_add_f32 v[122:123], v[122:123], v[146:147]
    s_waitcnt lgkmcnt(4)
    v_pk_add_f32 v[120:121], v[120:121], v[148:149]
    v_pk_add_f32 v[122:123], v[122:123], v[150:151]
    s_waitcnt lgkmcnt(3)
    v_pk_add_f32 v[120:121], v[120:121], v[152:153]
    v_pk_add_f32 v[122:123], v[122:123], v[154:155]
    v_pk_fma_f32 v[120:121], v[120:121], v[226:227], v[128:129]
    v_pk_fma_f32 v[122:123], v[122:123], v[226:227], v[130:131]
    v_cvt_pk_bf16_f32 v136, v120, v121
    v_cvt_pk_bf16_f32 v137, v122, v123
    s_waitcnt lgkmcnt(2)
    v_pk_add_f32 v[124:125], v[124:125], v[156:157]
    v_pk_add_f32 v[126:127], v[126:127], v[158:159]
    s_waitcnt lgkmcnt(1)
    v_pk_add_f32 v[124:125], v[124:125], v[160:161]
    v_pk_add_f32 v[126:127], v[126:127], v[162:163]
    s_waitcnt lgkmcnt(0)
    v_pk_add_f32 v[124:125], v[124:125], v[164:165]
    v_pk_add_f32 v[126:127], v[126:127], v[166:167]
    v_pk_fma_f32 v[124:125], v[124:125], v[226:227], v[132:133]
    v_pk_fma_f32 v[126:127], v[126:127], v[226:227], v[134:135]
    v_cvt_pk_bf16_f32 v138, v124, v125
    v_cvt_pk_bf16_f32 v139, v126, v127
    s_nop 0
    v_permlane16_swap_b32 v136, v138
    v_permlane16_swap_b32 v137, v139
    buffer_store_dwordx4 v[136:139], v246, s[36:39], s57 offen sc1
    s_or_b32 s68, s2, s44
    s_cmp_lg_u32 s68, 0
    s_cbranch_scc1 L_nononce
    v_mov_b32 v11, 0
    v_mov_b32 v12, s46
    v_mov_b32 v13, s47
    s_mov_b64 exec, 1
    buffer_store_dwordx2 v[12:13], v11, s[32:35], 0 offen
    s_mov_b64 exec, -1
L_nononce:
    s_branch L_fin
slow_2:
    s_mov_b32 s66, 0
slow_2_l:
    buffer_load_dwordx2 v[12:13], v231, s[32:35], s79 offen sc1
    s_waitcnt vmcnt(0)
    v_cmp_ne_u64 s[86:87], s[46:47], v[12:13]
    s_nop 0
    s_cmp_eq_u64 s[86:87], 0
    s_cbranch_scc1 ok_3
    s_add_u32 s66, s66, 1
    s_cmp_lt_u32 s66, 200000
    s_cbranch_scc1 slow_2_l
    s_endpgm
slow_7:
    s_mov_b32 s66, 0
slow_7_l:
    buffer_load_dwordx2 v[12:13], v231, s[32:35], s64 offen sc1
    s_waitcnt vmcnt(0)
    v_cmp_ne_u64 s[86:87], s[46:47], v[12:13]
    s_nop 0
    s_cmp_eq_u64 s[86:87], 0
    s_cbranch_scc1 ok_8
    s_add_u32 s66, s66, 1
    s_cmp_lt_u32 s66, 200000
    s_cbranch_scc1 slow_7_l
    s_endpgm
slow_10:
    s_mov_b32 s66, 0
slow_10_l:
    buffer_load_dwordx2 v[14:15], v231, s[32:35], s73 offen sc1
    s_waitcnt vmcnt(0)
    v_cmp_ne_u64 s[86:87], s[46:47], v[14:15]
    s_nop 0
    s_cmp_eq_u64 s[86:87], 0
    s_cbranch_scc1 ok_11
    s_add_u32 s66, s66, 1
    s_cmp_lt_u32 s66, 200000
    s_cbranch_scc1 slow_10_l
    s_endpgm
slow_15:
    s_mov_b32 s66, 0
slow_15_l:
    buffer_load_dwordx2 v[14:15], v231, s[32:35], s73 offen sc1
    s_waitcnt vmcnt(0)
    v_cmp_ne_u64 s[86:87], s[46:47], v[14:15]
    s_nop 0
    s_cmp_eq_u64 s[86:87], 0
    s_cbranch_scc1 ok_16
    s_add_u32 s66, s66, 1
    s_cmp_lt_u32 s66, 200000
    s_cbranch_scc1 slow_15_l
    s_endpgm
gslow_17:
    s_mov_b32 s66, 0
gslow_17_l:
    buffer_load_dwordx4 v[80:83], v224, s[32:35], s41 offen offset:0 sc1
    buffer_load_dwordx4 v[84:87], v224, s[32:35], s41 offen offset:512 sc1
    s_waitcnt vmcnt(0)
    v_sad_u32 v8, v83, s46, 0
    v_sad_u32 v8, v87, s46, v8
    v_add_f32 v80, v80, v84
    v_add_f32 v82, v82, v86
    v_cmp_ne_u32 s[86:87], 0, v8
    s_nop 0
    s_cmp_eq_u64 s[86:87], 0
    s_cbranch_scc1 gok_18
    s_add_u32 s66, s66, 1
    s_cmp_lt_u32 s66, 200000
    s_cbranch_scc1 gslow_17_l
    s_endpgm
slow_19:
    s_mov_b32 s66, 0
slow_19_l:
    buffer_load_dwordx2 v[218:219], v220, s[32:35], s62 offen sc1
    s_waitcnt vmcnt(0)
    v_cmp_ne_u64 s[86:87], s[46:47], v[218:219]
    s_nop 0
    s_cmp_eq_u64 s[86:87], 0
    s_cbranch_scc1 ok_20
    s_add_u32 s66, s66, 1
    s_cmp_lt_u32 s66, 200000
    s_cbranch_scc1 slow_19_l
    s_endpgm
gslow_21:
    s_mov_b32 s66, 0
gslow_21_l:
    buffer_load_dwordx4 v[16:19], v224, s[32:35], s41 offen offset:0 sc1
    buffer_load_dwordx4 v[20:23], v224, s[32:35], s41 offen offset:512 sc1
    s_waitcnt vmcnt(0)
    v_sad_u32 v8, v19, s46, 0
    v_sad_u32 v8, v23, s46, v8
    v_add_f32 v16, v16, v20
    v_add_f32 v18, v18, v22
    v_cmp_ne_u32 s[86:87], 0, v8
    s_nop 0
    s_cmp_eq_u64 s[86:87], 0
    s_cbranch_scc1 gok_22
    s_add_u32 s66, s66, 1
    s_cmp_lt_u32 s66, 200000
    s_cbranch_scc1 gslow_21_l
    s_endpgm
slow_28:
    s_mov_b32 s66, 0
slow_28_l:
    buffer_load_dwordx2 v[10:11], v8, s[32:35], s73 offen sc1
    s_waitcnt vmcnt(0)
    v_cmp_ne_u64 s[86:87], s[46:47], v[10:11]
    s_nop 0
    s_cmp_eq_u64 s[86:87], 0
    s_cbranch_scc1 ok_29
    s_add_u32 s66, s66, 1
    s_cmp_lt_u32 s66, 200000
    s_cbranch_scc1 slow_28_l
    s_endpgm
slow_36:
    s_mov_b32 s66, 0
slow_36_l:
    buffer_load_dwordx2 v[4:5], v231, s[32:35], s73 offen sc1
    s_waitcnt vmcnt(0)
    v_cmp_ne_u64 s[86:87], s[46:47], v[4:5]
    s_nop 0
    s_cmp_eq_u64 s[86:87], 0
    s_cbranch_scc1 ok_37
    s_add_u32 s66, s66, 1
    s_cmp_lt_u32 s66, 200000
    s_cbranch_scc1 slow_36_l
    s_endpgm
slow_41:
    s_mov_b32 s66, 0
slow_41_l:
    buffer_load_dwordx2 v[12:13], v231, s[32:35], s64 offen sc1
    s_waitcnt vmcnt(0)
    v_cmp_ne_u64 s[86:87], s[46:47], v[12:13]
    s_nop 0
    s_cmp_eq_u64 s[86:87], 0
    s_cbranch_scc1 ok_42
    s_add_u32 s66, s66, 1
    s_cmp_lt_u32 s66, 200000
    s_cbranch_scc1 slow_41_l
    s_endpgm
slow_44:
    s_mov_b32 s66, 0
slow_44_l:
    buffer_load_dwordx2 v[14:15], v231, s[32:35], s73 offen sc1
    s_waitcnt vmcnt(0)
    v_cmp_ne_u64 s[86:87], s[46:47], v[14:15]
    s_nop 0
    s_cmp_eq_u64 s[86:87], 0
    s_cbranch_scc1 ok_45
    s_add_u32 s66, s66, 1
    s_cmp_lt_u32 s66, 200000
    s_cbranch_scc1 slow_44_l
    s_endpgm
slow_49:
    s_mov_b32 s66, 0
slow_49_l:
    buffer_load_dwordx2 v[14:15], v231, s[32:35], s73 offen sc1
    s_waitcnt vmcnt(0)
    v_cmp_ne_u64 s[86:87], s[46:47], v[14:15]
    s_nop 0
    s_cmp_eq_u64 s[86:87], 0
    s_cbranch_scc1 ok_50
    s_add_u32 s66, s66, 1
    s_cmp_lt_u32 s66, 200000
    s_cbranch_scc1 slow_49_l
    s_endpgm
gslow_51:
    s_mov_b32 s66, 0
gslow_51_l:
    buffer_load_dwordx4 v[80:83], v224, s[32:35], s41 offen offset:0 sc1
    buffer_load_dwordx4 v[84:87], v224, s[32:35], s41 offen offset:512 sc1
    s_waitcnt vmcnt(0)
    v_sad_u32 v8, v83, s46, 0
    v_sad_u32 v8, v87, s46, v8
    v_add_f32 v80, v80, v84
    v_add_f32 v82, v82, v86
    v_cmp_ne_u32 s[86:87], 0, v8
    s_nop 0
    s_cmp_eq_u64 s[86:87], 0
    s_cbranch_scc1 gok_52
    s_add_u32 s66, s66, 1
    s_cmp_lt_u32 s66, 200000
    s_cbranch_scc1 gslow_51_l
    s_endpgm
slow_53:
    s_mov_b32 s66, 0
slow_53_l:
    buffer_load_dwordx2 v[218:219], v220, s[32:35], s62 offen sc1
    s_waitcnt vmcnt(0)
    v_cmp_ne_u64 s[86:87], s[46:47], v[218:219]
    s_nop 0
    s_cmp_eq_u64 s[86:87], 0
    s_cbranch_scc1 ok_54
    s_add_u32 s66, s66, 1
    s_cmp_lt_u32 s66, 200000
    s_cbranch_scc1 slow_53_l
    s_endpgm
gslow_55:
    s_mov_b32 s66, 0
gslow_55_l:
    buffer_load_dwordx4 v[16:19], v224, s[32:35], s41 offen offset:0 sc1
    buffer_load_dwordx4 v[20:23], v224, s[32:35], s41 offen offset:512 sc1
    s_waitcnt vmcnt(0)
    v_sad_u32 v8, v19, s46, 0
    v_sad_u32 v8, v23, s46, v8
    v_add_f32 v16, v16, v20
    v_add_f32 v18, v18, v22
    v_cmp_ne_u32 s[86:87], 0, v8
    s_nop 0
    s_cmp_eq_u64 s[86:87], 0
    s_cbranch_scc1 gok_56
    s_add_u32 s66, s66, 1
    s_cmp_lt_u32 s66, 200000
    s_cbranch_scc1 gslow_55_l
    s_endpgm
slow_62:
    s_mov_b32 s66, 0
slow_62_l:
    buffer_load_dwordx2 v[10:11], v8, s[32:35], s73 offen sc1
    s_waitcnt vmcnt(0)
    v_cmp_ne_u64 s[86:87], s[46:47], v[10:11]
    s_nop 0
    s_cmp_eq_u64 s[86:87], 0
    s_cbranch_scc1 ok_63
    s_add_u32 s66, s66, 1
    s_cmp_lt_u32 s66, 200000
    s_cbranch_scc1 slow_62_l
    s_endpgm
L_fin:
L_end:
    s_endpgm
    .p2align 4
L_tab:
    .short 5120, 5120, 5120, 5120, 5120, 5120, 5120, 5120, 5112, 5112, 5112, 5112, 5112, 5112, 5112, 5104
    .short 5104, 5104, 5104, 5104, 5104, 5104, 5104, 5104, 5096, 5096, 5096, 5096, 5096, 5096, 5096, 5088
    .short 5088, 5088, 5088, 5088, 5088, 5088, 5088, 5088, 5080, 5080, 5080, 5080, 5080, 5080, 5080, 5072
    .short 5072, 5072, 5072, 5072, 5072, 5072, 5072, 5072, 5064, 5064, 5064, 5064, 5064, 5064, 5064, 5056
    .short 5056, 5056, 5056, 5056, 5056, 5056, 5056, 5056, 5048, 5048, 5048, 5048, 5048, 5048, 5048, 5040
    .short 5040, 5040, 5040, 5040, 5040, 5040, 5040, 5040, 5032, 5032, 5032, 5032, 5032, 5032, 5032, 5024
    .short 5024, 5024, 5024, 5024, 5024, 5024, 5024, 5024, 5016, 5016, 5016, 5016, 5016, 5016, 5016, 5008
    .short 5008, 5008, 5008, 5008, 5008, 5008, 5008, 5008, 5000, 5000, 5000, 5000, 5000, 5000, 5000, 4992
    .short 4992, 4992, 4992, 4992, 4992, 4992, 4992, 4992, 4984, 4984, 4984, 4984, 4984, 4984, 4984, 4976
    .short 4976, 4976, 4976, 4976, 4976, 4976, 4976, 4976, 4968, 4968, 4968, 4968, 4968, 4968, 4968, 4960
    .short 4960, 4960, 4960, 4960, 4960, 4960, 4960, 4960, 4952, 4952, 4952, 4952, 4952, 4952, 4952, 4944
    .short 4944, 4944, 4944, 4944, 4944, 4944, 4944, 4944, 4936, 4936, 4936, 4936, 4936, 4936, 4936, 4928
    .short 4928, 4928, 4928, 4928, 4928, 4928, 4928, 4928, 4920, 4920, 4920, 4920, 4920, 4920, 4920, 4912
    .short 4912, 4912, 4912, 4912, 4912, 4912, 4912, 4912, 4904, 4904, 4904, 4904, 4904, 4904, 4904, 4896
    .short 4896, 4896, 4896, 4896, 4896, 4896, 4896, 4896, 4888, 4888, 4888, 4888, 4888, 4888, 4888, 4880
    .short 4880, 4880, 4880, 4880, 4880, 4880, 4880, 4880, 4872, 4872, 4872, 4872, 4872, 4872, 4872, 4864
    .short 4864, 4864, 4864, 4864, 4864, 4864, 4864, 4864, 4856, 4856, 4856, 4856, 4856, 4856, 4856, 4848
    .short 4848, 4848, 4848, 4848, 4848, 4848, 4848, 4848, 4840, 4840, 4840, 4840, 4840, 4840, 4840, 4832
    .short 4832, 4832, 4832, 4832, 4832, 4832, 4832, 4832, 4824, 4824, 4824, 4824, 4824, 4824, 4824, 4816
    .short 4816, 4816, 4816, 4816, 4816, 4816, 4816, 4816, 4808, 4808, 4808, 4808, 4808, 4808, 4808, 4800
    .short 4800, 4800, 4800, 4800, 4800, 4800, 4800, 4800, 4792, 4792, 4792, 4792, 4792, 4792, 4792, 4784
    .short 4784, 4784, 4784, 4784, 4784, 4784, 4784, 4784, 4776, 4776, 4776, 4776, 4776, 4776, 4776, 4768
    .short 4768, 4768, 4768, 4768, 4768, 4768, 4768, 4768, 4760, 4760, 4760, 4760, 4760, 4760, 4760, 4752
    .short 4752, 4752, 4752, 4752, 4752, 4752, 4752, 4752, 4744, 4744, 4744, 4744, 4744, 4744, 4744, 4736
    .short 4736, 4736, 4736, 4736, 4736, 4736, 4736, 4736, 4728, 4728, 4728, 4728, 4728, 4728, 4728, 4720
    .short 4720, 4720, 4720, 4720, 4720, 4720, 4720, 4720, 4712, 4712, 4712, 4712, 4712, 4712, 4712, 4704
    .short 4704, 4704, 4704, 4704, 4704, 4704, 4704, 4704, 4696, 4696, 4696, 4696, 4696, 4696, 4696, 4688
    .short 4688, 4688, 4688, 4688, 4688, 4688, 4688, 4688, 4680, 4680, 4680, 4680, 4680, 4680, 4680, 4672
    .short 4672, 4672, 4672, 4672, 4672, 4672, 4672, 4672, 4664, 4664, 4664, 4664, 4664, 4664, 4664, 4656
    .short 4656, 4656, 4656, 4656, 4656, 4656, 4656, 4656, 4648, 4648, 4648, 4648, 4648, 4648, 4648, 4640
    .short 4640, 4640, 4640, 4640, 4640, 4640, 4640, 4640, 4632, 4632, 4632, 4632, 4632, 4632, 4632, 4624
    .short 4624, 4624, 4624, 4624, 4624, 4624, 4624, 4624, 4616, 4616, 4616, 4616, 4616, 4616, 4616, 4608
    .short 4608, 4608, 4608, 4608, 4608, 4608, 4608, 4608, 4600, 4600, 4600, 4600, 4600, 4600, 4600, 4592
    .short 4592, 4592, 4592, 4592, 4592, 4592, 4592, 4592, 4584, 4584, 4584, 4584, 4584, 4584, 4584, 4576
    .short 4576, 4576, 4576, 4576, 4576, 4576, 4576, 4576, 4568, 4568, 4568, 4568, 4568, 4568, 4568, 4560
    .short 4560, 4560, 4560, 4560, 4560, 4560, 4560, 4560, 4552, 4552, 4552, 4552, 4552, 4552, 4552, 4544
    .short 4544, 4544, 4544, 4544, 4544, 4544, 4544, 4544, 4536, 4536, 4536, 4536, 4536, 4536, 4536, 4528
    .short 4528, 4528, 4528, 4528, 4528, 4528, 4528, 4528, 4520, 4520, 4520, 4520, 4520, 4520, 4520, 4512
    .short 4512, 4512, 4512, 4512, 4512, 4512, 4512, 4512, 4504, 4504, 4504, 4504, 4504, 4504, 4504, 4496
    .short 4496, 4496, 4496, 4496, 4496, 4496, 4496, 4496, 4488, 4488, 4488, 4488, 4488, 4488, 4488, 4480
    .short 4480, 4480, 4480, 4480, 4480, 4480, 4480, 4480, 4472, 4472, 4472, 4472, 4472, 4472, 4472, 4464
    .short 4464, 4464, 4464, 4464, 4464, 4464, 4464, 4464, 4456, 4456, 4456, 4456, 4456, 4456, 4456, 4448
    .short 4448, 4448, 4448, 4448, 4448, 4448, 4448, 4448, 4440, 4440, 4440, 4440, 4440, 4440, 4440, 4432
    .short 4432, 4432, 4432, 4432, 4432, 4432, 4432, 4432, 4424, 4424, 4424, 4424, 4424, 4424, 4424, 4416
    .short 4416, 4416, 4416, 4416, 4416, 4416, 4416, 4416, 4408, 4408, 4408, 4408, 4408, 4408, 4408, 4400
    .short 4400, 4400, 4400, 4400, 4400, 4400, 4400, 4400, 4392, 4392, 4392, 4392, 4392, 4392, 4392, 4384
    .short 4384, 4384, 4384, 4384, 4384, 4384, 4384, 4384, 4376, 4376, 4376, 4376, 4376, 4376, 4376, 4368
    .short 4368, 4368, 4368, 4368, 4368, 4368, 4368, 4368, 4360, 4360, 4360, 4360, 4360, 4360, 4360, 4352
    .short 4352, 4352, 4352, 4352, 4352, 4352, 4352, 4352, 4344, 4344, 4344, 4344, 4344, 4344, 4344, 4336
    .short 4336, 4336, 4336, 4336, 4336, 4336, 4336, 4336, 4328, 4328, 4328, 4328, 4328, 4328, 4328, 4320
    .short 4320, 4320, 4320, 4320, 4320, 4320, 4320, 4320, 4312, 4312, 4312, 4312, 4312, 4312, 4312, 4304
    .short 4304, 4304, 4304, 4304, 4304, 4304, 4304, 4304, 4296, 4296, 4296, 4296, 4296, 4296, 4296, 4288
    .short 4288, 4288, 4288, 4288, 4288, 4288, 4288, 4288, 4280, 4280, 4280, 4280, 4280, 4280, 4280, 4272
    .short 4272, 4272, 4272, 4272, 4272, 4272, 4272, 4272, 4264, 4264, 4264, 4264, 4264, 4264, 4264, 4256
    .short 4256, 4256, 4256, 4256, 4256, 4256, 4256, 4256, 4248, 4248, 4248, 4248, 4248, 4248, 4248, 4240
    .short 4240, 4240, 4240, 4240, 4240, 4240, 4240, 4240, 4232, 4232, 4232, 4232, 4232, 4232, 4232, 4224
    .short 4224, 4224, 4224, 4224, 4224, 4224, 4224, 4224, 4216, 4216, 4216, 4216, 4216, 4216, 4216, 4208
    .short 4208, 4208, 4208, 4208, 4208, 4208, 4208, 4208, 4200, 4200, 4200, 4200, 4200, 4200, 4200, 4192
    .short 4192, 4192, 4192, 4192, 4192, 4192, 4192, 4192, 4184, 4184, 4184, 4184, 4184, 4184, 4184, 4176
    .short 4176, 4176, 4176, 4176, 4176, 4176, 4176, 4176, 4168, 4168, 4168, 4168, 4168, 4168, 4168, 4160
    .short 4160, 4160, 4160, 4160, 4160, 4160, 4160, 4160, 4152, 4152, 4152, 4152, 4152, 4152, 4152, 4144
    .short 4144, 4144, 4144, 4144, 4144, 4144, 4144, 4144, 4136, 4136, 4136, 4136, 4136, 4136, 4136, 4128
    .short 4128, 4128, 4128, 4128, 4128, 4128, 4128, 4128, 4120, 4120, 4120, 4120, 4120, 4120, 4120, 4112
    .short 4112, 4112, 4112, 4112, 4112, 4112, 4112, 4112, 4104, 4104, 4104, 4104, 4104, 4104, 4104, 4096
    .short 4096, 4096, 4096, 4096, 4096, 4096, 4088, 4088, 4088, 3960, 3960, 3960, 3960, 3960, 4080, 4080
    .short 4080, 3952, 3952, 3952, 3952, 3952, 4072, 4072, 4072, 3944, 3944, 3944, 3944, 3944, 4064, 4064
    .short 4064, 3936, 3936, 3936, 3936, 3936, 4056, 4056, 4056, 3928, 3928, 3928, 3928, 3928, 4048, 4048
    .short 4048, 3920, 3920, 3920, 3920, 3920, 4040, 4040, 4040, 3912, 3912, 3912, 3912, 3912, 4032, 4032
    .short 4032, 3904, 3904, 3904, 3904, 3904, 4024, 4024, 4024, 3896, 3896, 3896, 3896, 3896, 4016, 4016
    .short 4016, 3888, 3888, 3888, 3888, 3888, 4008, 4008, 4008, 3880, 3880, 3880, 3880, 3880, 4000, 4000
    .short 4000, 3872, 3872, 3872, 3872, 3872, 3992, 3992, 3992, 3864, 3864, 3864, 3864, 3864, 3984, 3984
    .short 3984, 3856, 3856, 3856, 3856, 3856, 3976, 3976, 3976, 3848, 3848, 3848, 3848, 3848, 3968, 3968
    .short 3968, 3840, 3840, 3840, 3840, 3840, 3832, 3832, 3832, 3704, 3704, 3704, 3704, 3704, 3824, 3824
    .short 3824, 3696, 3696, 3696, 3696, 3696, 3816, 3816, 3816, 3688, 3688, 3688, 3688, 3688, 3808, 3808
    .short 3808, 3680, 3680, 3680, 3680, 3680, 3800, 3800, 3800, 3672, 3672, 3672, 3672, 3672, 3792, 3792
    .short 3792, 3664, 3664, 3664, 3664, 3664, 3784, 3784, 3784, 3656, 3656, 3656, 3656, 3656, 3776, 3776
    .short 3776, 3648, 3648, 3648, 3648, 3648, 3768, 3768, 3768, 3640, 3640, 3640, 3640, 3640, 3760, 3760
    .short 3760, 3632, 3632, 3632, 3632, 3632, 3752, 3752, 3752, 3624, 3624, 3624, 3624, 3624, 3744, 3744
    .short 3744, 3616, 3616, 3616, 3616, 3616, 3736, 3736, 3736, 3608, 3608, 3608, 3608, 3608, 3728, 3728
    .short 3728, 3600, 3600, 3600, 3600, 3600, 3720, 3720, 3720, 3592, 3592, 3592, 3592, 3592, 3712, 3712
    .short 3712, 3584, 3584, 3584, 3584, 3584, 3576, 3576, 3576, 3448, 3448, 3448, 3448, 3448, 3568, 3568
    .short 3568, 3440, 3440, 3440, 3440, 3440, 3560, 3560, 3560, 3432, 3432, 3432, 3432, 3432, 3552, 3552
    .short 3552, 3424, 3424, 3424, 3424, 3424, 3544, 3544, 3544, 3416, 3416, 3416, 3416, 3416, 3536, 3536
    .short 3536, 3408, 3408, 3408, 3408, 3408, 3528, 3528, 3528, 3400, 3400, 3400, 3400, 3400, 3520, 3520
    .short 3520, 3392, 3392, 3392, 3392, 3392, 3512, 3512, 3512, 3384, 3384, 3384, 3384, 3384, 3504, 3504
    .short 3504, 3376, 3376, 3376, 3376, 3376, 3496, 3496, 3496, 3368, 3368, 3368, 3368, 3368, 3488, 3488
    .short 3488, 3360, 3360, 3360, 3360, 3360, 3480, 3480, 3480, 3352, 3352, 3352, 3352, 3352, 3472, 3472
    .short 3472, 3344, 3344, 3344, 3344, 3344, 3464, 3464, 3464, 3336, 3336, 3336, 3336, 3336, 3456, 3456
    .short 3456, 3328, 3328, 3328, 3328, 3328, 3320, 3320, 3320, 3192, 3192, 3192, 3192, 3192, 3312, 3312
    .short 3312, 3184, 3184, 3184, 3184, 3184, 3304, 3304, 3304, 3176, 3176, 3176, 3176, 3176, 3296, 3296
    .short 3296, 3168, 3168, 3168, 3168, 3168, 3288, 3288, 3288, 3160, 3160, 3160, 3160, 3160, 3280, 3280
    .short 3280, 3152, 3152, 3152, 3152, 3152, 3272, 3272, 3272, 3144, 3144, 3144, 3144, 3144, 3264, 3264
    .short 3264, 3136, 3136, 3136, 3136, 3136, 3256, 3256, 3256, 3128, 3128, 3128, 3128, 3128, 3248, 3248
    .short 3248, 3120, 3120, 3120, 3120, 3120, 3240, 3240, 3240, 3112, 3112, 3112, 3112, 3112, 3232, 3232
    .short 3232, 3104, 3104, 3104, 3104, 3104, 3224, 3224, 3224, 3096, 3096, 3096, 3096, 3096, 3216, 3216
    .short 3216, 3088, 3088, 3088, 3088, 3088, 3208, 3208, 3208, 3080, 3080, 3080, 3080, 3080, 3200, 3200
    .short 3200, 3072, 3072, 3072, 3072, 3064, 2936, 2936, 2936, 2808, 2680, 2680, 2680, 3056, 2928, 2928
    .short 2928, 2800, 2672, 2672, 2672, 3048, 2920, 2920, 2920, 2792, 2664, 2664, 2664, 3040, 2912, 2912
    .short 2912, 2784, 2656, 2656, 2656, 3032, 2904, 2904, 2904, 2776, 2648, 2648, 2648, 3024, 2896, 2896
    .short 2896, 2768, 2640, 2640, 2640, 3016, 2888, 2888, 2888, 2760, 2632, 2632, 2632, 3008, 2880, 2880
    .short 2880, 2752, 2624, 2624, 2624, 3000, 2872, 2872, 2872, 2744, 2616, 2616, 2616, 2992, 2864, 2864
    .short 2864, 2736, 2608, 2608, 2608, 2984, 2856, 2856, 2856, 2728, 2600, 2600, 2600, 2976, 2848, 2848
    .short 2848, 2720, 2592, 2592, 2592, 2968, 2840, 2840, 2840, 2712, 2584, 2584, 2584, 2960, 2832, 2832
    .short 2832, 2704, 2576, 2576, 2576, 2952, 2824, 2824, 2824, 2696, 2568, 2568, 2568, 2944, 2816, 2816
    .short 2816, 2688, 2560, 2560, 2560, 2552, 2424, 2424, 2424, 2296, 2168, 2168, 2168, 2544, 2416, 2416
    .short 2416, 2288, 2160, 2160, 2160, 2536, 2408, 2408, 2408, 2280, 2152, 2152, 2152, 2528, 2400, 2400
    .short 2400, 2272, 2144, 2144, 2144, 2520, 2392, 2392, 2392, 2264, 2136, 2136, 2136, 2512, 2384, 2384
    .short 2384, 2256, 2128, 2128, 2128, 2504, 2376, 2376, 2376, 2248, 2120, 2120, 2120, 2496, 2368, 2368
    .short 2368, 2240, 2112, 2112, 2112, 2488, 2360, 2360, 2360, 2232, 2104, 2104, 2104, 2480, 2352, 2352
    .short 2352, 2224, 2096, 2096, 2096, 2472, 2344, 2344, 2344, 2216, 2088, 2088, 2088, 2464, 2336, 2336
    .short 2336, 2208, 2080, 2080, 2080, 2456, 2328, 2328, 2328, 2200, 2072, 2072, 2072, 2448, 2320, 2320
    .short 2320, 2192, 2064, 2064, 2064, 2440, 2312, 2312, 2312, 2184, 2056, 2056, 2056, 2432, 2304, 2304
    .short 2304, 2176, 2048, 2048, 2040, 1912, 1784, 1656, 1528, 1400, 1272, 1144, 2032, 1904, 1776, 1648
    .short 1520, 1392, 1264, 1136, 2024, 1896, 1768, 1640, 1512, 1384, 1256, 1128, 2016, 1888, 1760, 1632
    .short 1504, 1376, 1248, 1120, 2008, 1880, 1752, 1624, 1496, 1368, 1240, 1112, 2000, 1872, 1744, 1616
    .short 1488, 1360, 1232, 1104, 1992, 1864, 1736, 1608, 1480, 1352, 1224, 1096, 1984, 1856, 1728, 1600
    .short 1472, 1344, 1216, 1088, 1976, 1848, 1720, 1592, 1464, 1336, 1208, 1080, 1968, 1840, 1712, 1584
    .short 1456, 1328, 1200, 1072, 1960, 1832, 1704, 1576, 1448, 1320, 1192, 1064, 1952, 1824, 1696, 1568
    .short 1440, 1312, 1184, 1056, 1944, 1816, 1688, 1560, 1432, 1304, 1176, 1048, 1936, 1808, 1680, 1552
    .short 1424, 1296, 1168, 1040, 1928, 1800, 1672, 1544, 1416, 1288, 1160, 1032, 1920, 1792, 1664, 1536
    .short 1408, 1280, 1152, 1024, 1016, 888, 760, 632, 504, 376, 248, 120, 1008, 880, 752, 624
    .short 496, 368, 240, 112, 1000, 872, 744, 616, 488, 360, 232, 104, 992, 864, 736, 608
    .short 480, 352, 224, 96, 984, 856, 728, 600, 472, 344, 216, 88, 976, 848, 720, 592
    .short 464, 336, 208, 80, 968, 840, 712, 584, 456, 328, 200, 72, 960, 832, 704, 576
    .short 448, 320, 192, 64, 952, 824, 696, 568, 440, 312, 184, 56, 944, 816, 688, 560
    .short 432, 304, 176, 48, 936, 808, 680, 552, 424, 296, 168, 40, 928, 800, 672, 544
    .short 416, 288, 160, 32, 920, 792, 664, 536, 408, 280, 152, 24, 912, 784, 656, 528
    .short 400, 272, 144, 16, 904, 776, 648, 520, 392, 264, 136, 8, 896, 768, 640, 512
    .short 384, 256, 128, 0, 0, 0, 0, 0, 0, 0, 0, 0, 0, 0, 0, 0
L_tabend:
.section .rodata,"a"
.p2align 6
.amdhsa_kernel interleave_layers__ssm_conv_s4d__glu_gated_reglu__prompt_kernel
  .amdhsa_next_free_vgpr 512
  .amdhsa_next_free_sgpr 102
  .amdhsa_accum_offset 256
  .amdhsa_group_segment_fixed_size 0
  .amdhsa_kernarg_size 112
  .amdhsa_user_sgpr_count 2
  .amdhsa_user_sgpr_kernarg_segment_ptr 1
  .amdhsa_system_sgpr_workgroup_id_x 1
.end_amdhsa_kernel
```
